```python
import torch

def _softmax(x, axis=-1):
    return torch.softmax(x, dim=axis)
def _gelu(x):
    return torch.nn.functional.gelu(x, approximate="tanh")
def _silu(x):
    return torch.nn.functional.silu(x)
def _sigmoid(x):
    return torch.sigmoid(x)
def _layernorm(x, axis=-1, eps=1e-5):
    m = x.mean(dim=axis, keepdim=True)
    v = x.var(dim=axis, keepdim=True, unbiased=False)
    return (x - m) / torch.sqrt(v + eps)
def _scatter_add(tgt, idx, src, axis=0):
    return tgt.clone().index_add_(axis, idx, src)
def _segment_sum(src, seg, n):
    out = torch.zeros((n,) + src.shape[1:], dtype=src.dtype)
    return out.index_add_(0, seg, src)
def _pad(x, pw):
    flat = tuple(v for pair in reversed(pw) for v in pair)
    return torch.nn.functional.pad(x, flat)

kernel_name = 'interleave_layers__sliding_local_dilated__moe_arch_mod__prompt'

def setup_inputs():

    _w = (lambda a: (lambda t: t.to(torch.bfloat16) if t.is_floating_point() else t)(torch.as_tensor(a)))
    def _A_setup():
        B, S, D = 1, 2048, 512
        return {
            "x": _w((lambda *s: torch.randn(*s, dtype=torch.bfloat16) * 0.05)(B, S, D)),
            "wqkv": _w((lambda *s: torch.randn(*s, dtype=torch.bfloat16) * 0.05)(D, 3 * D)),
            "wo": _w((lambda *s: torch.randn(*s, dtype=torch.bfloat16) * 0.05)(D, D)),
        }
    _A_in = _A_setup()

    def _B_setup():
        B, S, D, F, C = 1, 2048, 512, 1376, 2
        return {
            "x": _w((lambda *s: torch.randn(*s, dtype=torch.bfloat16) * 0.05)(B, S, D)),
            "w_r": _w((lambda *s: torch.randn(*s, dtype=torch.bfloat16) * 0.05)(D)),
            "w_gate": _w((lambda *s: torch.randn(*s, dtype=torch.bfloat16) * 0.05)(D, F)),
            "w_up": _w((lambda *s: torch.randn(*s, dtype=torch.bfloat16) * 0.05)(D, F)),
            "w_down": _w((lambda *s: torch.randn(*s, dtype=torch.bfloat16) * 0.05)(F, D)),
        }
    _B_in = _B_setup()

    return {
        "A_x": _A_in["x"],
        "A_wqkv": _A_in["wqkv"],
        "A_wo": _A_in["wo"],
        "B_x": _B_in["x"],
        "B_w_r": _B_in["w_r"],
        "B_w_gate": _B_in["w_gate"],
        "B_w_up": _B_in["w_up"],
        "B_w_down": _B_in["w_down"],
    }

def reference(A_x, A_wqkv, A_wo, B_x, B_w_r, B_w_gate, B_w_up, B_w_down):
    def _A_ref(x, wqkv, wo):
        B, S, D = x.shape
        H = 32; Dh = D // H
        W, dil = 8, 2
        qkv = (lambda x, *d: x.permute(*d))((x @ wqkv).reshape(B, S, 3, H, Dh), 2, 0, 3, 1, 4)
        q, k, v = qkv[0], qkv[1], qkv[2]
        scale = Dh ** -0.5
        pos = torch.arange(S)
        off = torch.arange(W) * dil
        idx = pos[:, None] - off[None, :]
        mask = idx >= 0
        idx_c = torch.where(mask, idx, 0).reshape(-1)
        kg = k[:, :, idx_c, :].reshape(B, H, S, W, Dh)
        vg = v[:, :, idx_c, :].reshape(B, H, S, W, Dh)
        logits = torch.einsum("bhsd,bhswd->bhsw", q, kg) * scale
        logits = torch.where(mask[None, None, :, :], logits, -1e9)
        attn = _softmax(logits, axis=-1)
        o = torch.einsum("bhsw,bhswd->bhsd", attn, vg)
        return (lambda x, *d: x.permute(*d))(o, 0, 2, 1, 3).reshape(B, S, D) @ wo

    def _B_ref(x, w_r, w_gate, w_up, w_down):
        B, S, D = x.shape
        C = 2
        r = x @ w_r
        idx = torch.argsort(-r, axis=-1)[:, :C]
        idx_e = (lambda x, n, axis: torch.repeat_interleave(x, n, dim=axis))(idx.reshape(B, C, 1), D, axis=2)
        x_sel = (lambda x, i, axis: torch.take_along_dim(x, i, dim=axis))(x, idx_e, axis=1)
        g = _silu(x_sel @ w_gate)
        u = x_sel @ w_up
        y = (g * u) @ w_down
        r_sel = _sigmoid((lambda x, i, axis: torch.take_along_dim(x, i, dim=axis))(r, idx, axis=1))
        y = y * r_sel.reshape(B, C, 1)
        b_off = (torch.arange(B) * S).reshape(B, 1)
        flat_idx = (idx + b_off).reshape(B * C)
        zero = (x * 0.0).reshape(B * S, D)
        upd = _scatter_add(zero, flat_idx, y.reshape(B * C, D), axis=0)
        return x + upd.reshape(B, S, D)

    x = A_x
    x = x + _A_ref(_layernorm(x, axis=-1), A_wqkv, A_wo)
    x = x + _B_ref(_layernorm(x, axis=-1), B_w_r, B_w_gate, B_w_up, B_w_down)
    x = x + _A_ref(_layernorm(x, axis=-1), A_wqkv, A_wo)
    x = x + _B_ref(_layernorm(x, axis=-1), B_w_r, B_w_gate, B_w_up, B_w_down)
    return x
```

```asm
; @launch grid=(256,1,1) block=(256,1,1) lds=163840
.amdgcn_target "amdgcn-amd-amdhsa--gfx950"
.text
.globl interleave_layers__sliding_local_dilated__moe_arch_mod__prompt_kernel
.p2align 8
.type interleave_layers__sliding_local_dilated__moe_arch_mod__prompt_kernel,@function
interleave_layers__sliding_local_dilated__moe_arch_mod__prompt_kernel:
    s_getpc_b64 s[18:19]
    s_and_b32 s20, s2, 0xf8
    s_lshl_b32 s20, s20, 8
    v_and_b32 v3, 15, v0
    v_lshl_add_u32 v217, v3, 7, s20
    global_load_dword v218, v217, s[18:19]
    s_load_dwordx2 s[52:53], s[0:1], 80
    s_load_dwordx2 s[40:41], s[0:1], 0
    s_load_dwordx2 s[44:45], s[0:1], 8
    s_load_dwordx2 s[48:49], s[0:1], 16
    s_load_dwordx2 s[56:57], s[0:1], 64
    s_load_dwordx2 s[60:61], s[0:1], 32
    s_and_b32 s3, s2, 7
    s_lshr_b32 s4, s2, 3
    s_cmp_ge_u32 s2, 256
    s_cbranch_scc1 L_end
    v_lshrrev_b32 v1, 6, v0
    v_and_b32 v2, 63, v0
    v_readfirstlane_b32 s8, v1
    s_mov_b32 s54, 9732096
    s_mov_b32 s55, 0x20000
    s_mov_b32 s58, 2097152
    s_mov_b32 s59, 0x20000
    s_lshr_b32 s5, s4, 3
    s_lshl_b32 s6, s3, 2
    s_add_u32 s6, s6, s5
    s_and_b32 s7, s4, 7
    v_lshrrev_b32 v4, 4, v2
    s_cmp_gt_u32 s6, 28
    s_cbranch_scc1 L_ffn
    s_mov_b32 s46, 1572864
    s_mov_b32 s47, 0x20000
    v_and_b32 v201, 7, v2
    v_lshrrev_b32 v200, 3, v2
    v_bfe_u32 v206, v200, 1, 1
    v_and_b32 v203, 1, v1
    v_lshl_or_b32 v202, v203, 1, v206
    v_lshlrev_b32 v202, 1, v202
    v_xor_b32 v202, v202, v201
    v_lshl_add_u32 v204, v1, 3, v200
    s_lshl_b32 s10, s7, 7
    v_lshl_add_u32 v202, v202, 4, s10
    v_mul_u32_u24 v5, 3072, v204
    v_add_u32 v5, v5, v202
    s_mul_i32 s12, s8, 3072
    s_add_u32 s12, s12, 81920
    s_add_u32 s17, s3, 0
    s_and_b32 s17, s17, 7
    s_lshl_b32 s30, s17, 7
    s_mul_i32 s73, s17, 196608
    s_add_u32 s74, s73, 98304
    s_mov_b32 s42, 2097152
    s_mov_b32 s43, 0x20000
    s_mul_i32 s11, s6, 73
    s_waitcnt lgkmcnt(0)
    s_add_u32 m0, s12, 0
    s_nop 0
    buffer_load_dwordx4 v5, s[44:47], s73 offen offset:0 lds
    buffer_load_dwordx4 v5, s[44:47], s73 offen offset:1024 lds
    buffer_load_dwordx4 v5, s[44:47], s73 offen offset:2048 lds
    s_add_u32 m0, s12, 12288
    s_nop 0
    buffer_load_dwordx4 v5, s[44:47], s74 offen offset:0 lds
    buffer_load_dwordx4 v5, s[44:47], s74 offen offset:1024 lds
    buffer_load_dwordx4 v5, s[44:47], s74 offen offset:2048 lds
    s_lshl_b32 s9, s3, 1
    v_lshl_add_u32 v205, v203, 3, v200
    v_bfe_u32 v207, v204, 1, 3
    v_xor_b32 v207, v207, v201
    s_add_u32 s18, s11, 32
    s_add_u32 s19, s11, 64
    v_add_u32 v210, s11, v204
    v_add_u32 v211, s18, v204
    v_add_u32 v212, s19, v205
    v_and_b32 v208, 1023, v210
    v_lshlrev_b32 v208, 11, v208
    v_bfe_u32 v209, v210, 10, 1
    v_lshl_or_b32 v208, v209, 10, v208
    v_lshrrev_b32 v209, 11, v210
    v_lshl_or_b32 v6, v209, 30, v208
    v_lshl_or_b32 v6, v207, 4, v6
    v_and_b32 v208, 1023, v211
    v_lshlrev_b32 v208, 11, v208
    v_bfe_u32 v209, v211, 10, 1
    v_lshl_or_b32 v208, v209, 10, v208
    v_lshrrev_b32 v209, 11, v211
    v_lshl_or_b32 v7, v209, 30, v208
    v_lshl_or_b32 v7, v207, 4, v7
    v_and_b32 v208, 1023, v212
    v_lshlrev_b32 v208, 11, v208
    v_bfe_u32 v209, v212, 10, 1
    v_lshl_or_b32 v208, v209, 10, v208
    v_lshrrev_b32 v209, 11, v212
    v_lshl_or_b32 v8, v209, 30, v208
    v_lshl_or_b32 v8, v207, 4, v8
    s_lshl_b32 s13, s8, 10
    s_lshr_b32 s14, s8, 1
    s_mul_i32 s14, s14, 10240
    s_and_b32 s15, s8, 1
    s_lshl_b32 s15, s15, 10
    s_add_u32 s14, s14, s15
    s_add_u32 s14, s14, 8192
    s_add_u32 s17, s3, 1
    s_and_b32 s17, s17, 7
    s_lshl_b32 s31, s17, 7
    s_mul_i32 s75, s17, 196608
    s_add_u32 s76, s75, 98304
    s_cmp_ge_u32 s8, 2
    s_cselect_b32 s95, s31, s30
    s_add_u32 m0, s13, 0
    s_nop 0
    buffer_load_dwordx4 v6, s[40:43], s30 offen lds
    s_add_u32 m0, s13, 4096
    s_nop 0
    buffer_load_dwordx4 v7, s[40:43], s30 offen lds
    s_add_u32 m0, s14, 0
    s_nop 0
    buffer_load_dwordx4 v8, s[40:43], s95 offen lds
    s_mov_b32 s50, 524288
    s_mov_b32 s51, 0x20000
    s_mov_b32 s62, 1024
    s_mov_b32 s63, 0x20000
    v_lshlrev_b32 v206, 1, v206
    v_xor_b32 v206, v206, v201
    v_lshl_add_u32 v206, v206, 4, s10
    v_lshl_add_u32 v207, v1, 7, v200
    v_lshl_add_u32 v9, v207, 10, v206
    v_xor_b32 v23, 64, v9
    v_mov_b32 v213, 0
    buffer_load_dword v216, v213, s[52:55], 0 offen sc1
    s_mul_i32 s24, s7, 10
    s_add_u32 s24, s24, s11
    v_lshrrev_b32 v211, 3, v0
    v_add_u32 v211, s24, v211
    v_and_b32 v208, 1023, v211
    v_lshlrev_b32 v208, 11, v208
    v_bfe_u32 v209, v211, 10, 1
    v_lshl_or_b32 v208, v209, 10, v208
    v_lshrrev_b32 v209, 11, v211
    v_lshl_or_b32 v210, v209, 30, v208
    v_cmp_gt_u32 vcc, 80, v0
    v_mov_b32 v212, 1073741824
    v_lshl_or_b32 v210, v201, 7, v210
    v_cndmask_b32 v210, v212, v210, vcc
    buffer_load_dword v254, v210, s[40:43], 0 offen
    s_lshl_b32 s18, s6, 3
    s_add_u32 s18, s18, s7
    s_mul_i32 s18, s18, 2432
    v_mov_b32 v212, 1073741824
    v_subrev_u32 v210, 192, v0
    v_cmp_gt_u32 vcc, 19, v210
    v_lshl_add_u32 v210, v210, 7, s18
    s_nop 0
    v_cndmask_b32 v210, v212, v210, vcc
    buffer_load_dword v254, v210, s[48:51], 0 offen
    s_mul_i32 s18, s9, 96
    s_add_u32 s18, s18, s4
    v_lshl_add_u32 v227, v0, 5, s18
    v_subrev_u32 v228, 1536, v227
    v_min_u32 v227, v227, v228
    v_lshlrev_b32 v227, 10, v227
    v_cmp_gt_u32 vcc, 48, v0
    v_mov_b32 v228, 1073741824
    s_nop 0
    v_cndmask_b32 v227, v228, v227, vcc
    buffer_load_dword v254, v227, s[44:47], 0 offen offset:384
    s_add_u32 s17, s3, 2
    s_and_b32 s17, s17, 7
    s_lshl_b32 s32, s17, 7
    s_mul_i32 s77, s17, 196608
    s_add_u32 s78, s77, 98304
    s_add_u32 s17, s3, 3
    s_and_b32 s17, s17, 7
    s_lshl_b32 s33, s17, 7
    s_mul_i32 s79, s17, 196608
    s_add_u32 s80, s79, 98304
    s_cmp_ge_u32 s8, 2
    s_cselect_b32 s96, s33, s32
    v_bfe_u32 v200, v2, 2, 2
    v_and_b32 v201, 3, v2
    v_lshrrev_b32 v202, 1, v200
    v_and_b32 v203, 1, v4
    v_lshl_or_b32 v202, v203, 1, v202
    v_xor_b32 v202, v202, v1
    v_mul_u32_u24 v10, 3072, v4
    v_lshl_add_u32 v10, v200, 7, v10
    v_lshl_add_u32 v10, v202, 5, v10
    v_lshl_add_u32 v10, v201, 3, v10
    v_add_u32 v10, 81920, v10
    v_bfe_u32 v200, v3, 1, 3
    v_xor_b32 v200, v200, v4
    v_lshlrev_b32 v11, 7, v3
    v_lshl_add_u32 v11, v200, 4, v11
    v_xor_b32 v12, 64, v11
    v_add_u32 v13, 40960, v11
    v_add_u32 v14, 40960, v12
    v_and_b32 v200, 1, v1
    v_lshlrev_b32 v200, 6, v200
    v_xor_b32 v15, v200, v11
    v_lshrrev_b32 v200, 1, v1
    v_mul_u32_u24 v200, 10240, v200
    v_add_u32 v15, v15, v200
    v_add_u32 v16, 40960, v15
    v_lshlrev_b32 v17, 4, v2
    v_add_u32 v18, 65536, v17
    v_add_u32 v19, 131072, v17
    v_lshl_add_u32 v20, v1, 12, v17
    v_add_u32 v21, 65536, v20
    v_add_u32 v22, 131072, v20
    s_mul_i32 s23, s6, 81920
    v_mov_b32 v28, 0x3f803f80
    v_mov_b32 v29, 0x3f803f80
    v_mov_b32 v30, 0x3f803f80
    v_mov_b32 v31, 0x3f803f80
    s_lshl_b32 s18, s8, 2
    s_add_u32 s19, s18, s9
    s_add_u32 s19, s19, 0
    s_and_b32 s19, s19, 15
    s_sub_u32 s19, s19, s18
    s_lshl_b32 s84, s19, 10
    s_lshl_b32 s18, s8, 2
    s_add_u32 s19, s18, s9
    s_add_u32 s19, s19, 2
    s_and_b32 s19, s19, 15
    s_sub_u32 s19, s19, s18
    s_lshl_b32 s85, s19, 10
    s_lshl_b32 s88, s8, 12
    s_sub_u32 s89, s85, 2048
    s_lshl_b32 s10, s6, 3
    s_add_u32 s10, s10, s7
    s_lshl_b32 s10, s10, 7
    s_lshl_b32 s87, s7, 2
    s_add_u32 s87, s87, s8
    s_mul_i32 s87, s87, 3072
    s_add_u32 s87, s87, 851968
    s_lshl_b32 s18, s7, 11
    s_lshl_b32 s19, s8, 9
    s_add_u32 s18, s18, s19
    v_lshrrev_b32 v200, 1, v4
    v_lshlrev_b32 v200, 8, v200
    v_lshl_add_u32 v200, v3, 4, v200
    v_add_u32 v200, s18, v200
    v_and_b32 v201, 1, v4
    v_lshl_add_u32 v24, v201, 14, v200
    v_lshl_add_u32 v25, v201, 30, v200
    v_mov_b32 v202, 1073741824
    v_min_u32 v203, 79, v0
    v_and_b32 v204, 15, v203
    v_lshlrev_b32 v204, 4, v204
    v_bfe_u32 v205, v203, 4, 1
    v_lshl_add_u32 v204, v205, 3, v204
    v_lshrrev_b32 v205, 5, v203
    v_lshl_add_u32 v204, v205, 8, v204
    v_add_u32 v26, 155648, v204
    v_cmp_gt_u32 vcc, 9, v3
    v_subrev_u32 v203, 144, v25
    s_nop 0
    v_cndmask_b32 v27, v203, v202, vcc
    s_sub_u32 s19, s7, s3
    s_and_b32 s70, s19, 7
    s_mul_i32 s19, s70, 10240
    v_lshrrev_b32 v200, 1, v4
    v_lshl_add_u32 v200, v1, 1, v200
    v_bfe_u32 v201, v3, 1, 3
    v_xor_b32 v200, v200, v201
    v_lshlrev_b32 v200, 4, v200
    v_lshl_add_u32 v200, v3, 7, v200
    v_and_b32 v201, 1, v4
    v_lshl_add_u32 v200, v201, 3, v200
    v_add_u32 v64, s19, v200
    v_bfe_u32 v201, v2, 2, 2
    v_lshrrev_b32 v202, 1, v201
    v_and_b32 v203, 1, v4
    v_lshl_or_b32 v202, v203, 1, v202
    v_xor_b32 v202, v202, v1
    v_lshlrev_b32 v200, 10, v4
    v_lshl_add_u32 v200, v201, 7, v200
    v_lshl_add_u32 v200, v202, 5, v200
    v_and_b32 v201, 3, v2
    v_lshl_add_u32 v200, v201, 3, v200
    v_add_u32 v65, s88, v200
    s_cmp_ge_u32 s7, 5
    s_cselect_b32 s18, 5, 0
    s_cselect_b32 s26, 1073741824, 0
    s_sub_u32 s86, s7, s18
    s_mul_i32 s29, s6, 5
    s_add_u32 s29, s29, s86
    s_lshl_b32 s28, s86, 14
    s_lshl_b32 s27, s29, 4
    s_add_u32 s27, s27, 8192
    s_add_u32 s28, s28, s23
    s_lshl_b32 s86, s86, 4
    v_add_u32 v201, s86, v3
    v_add_u32 v200, s11, v201
    s_cmp_eq_u32 s6, 0
    s_cselect_b32 s15, 0, 7
    v_cmp_le_u32 s[20:21], s15, v201
    v_cmp_gt_u32 vcc, 0x800, v200
    s_nop 0
    s_and_b64 s[20:21], s[20:21], vcc
    v_and_b32 v200, 3, v3
    v_cmp_eq_u32 s[64:65], 1, v200
    v_cmp_lt_u32 s[68:69], 1, v200
    v_and_b32 v200, 1, v3
    v_cmp_eq_u32 s[66:67], 1, v200
    v_lshrrev_b32 v200, 2, v3
    v_cmp_eq_u32 s[0:1], v200, v4
    v_lshlrev_b32 v93, 2, v3
    v_add_u32 v93, 160768, v93
    v_lshlrev_b32 v94, 4, v4
    v_add_u32 v94, 160768, v94
    v_mul_u32_u24 v95, 1280, v1
    v_lshl_add_u32 v95, v3, 4, v95
    v_add_u32 v95, 155648, v95
    v_mov_b32 v240, 0xf149f2ca
    v_lshlrev_b32 v241, 2, v4
    v_sub_u32 v241, v3, v241
    v_add_u32 v242, s11, v3
    v_and_b32 v243, 1023, v242
    v_min_u32 v243, 7, v243
    v_add_u32 v242, 64, v242
    v_and_b32 v242, 1023, v242
    v_min_u32 v242, 7, v242
    v_subrev_u32 v236, 0, v241
    v_add_u32 v237, 16, v236
    v_cmp_lt_u32 s[24:25], v243, v236
    v_cmp_lt_u32 s[38:39], 7, v236
    v_cmp_lt_u32 vcc, 7, v237
    v_cndmask_b32 v32, 0, v240, s[24:25]
    v_cmp_lt_u32 s[24:25], v242, v236
    v_cndmask_b32 v36, 0, v240, s[38:39]
    v_cmp_lt_u32 s[38:39], v242, v237
    v_cndmask_b32 v40, 0, v240, vcc
    v_cndmask_b32 v44, 0, v240, s[24:25]
    v_ashrrev_i32 v244, 31, v236
    v_cndmask_b32 v48, 0, v240, s[38:39]
    v_subrev_u32 v236, 1, v241
    v_add_u32 v237, 16, v236
    v_cmp_lt_u32 s[24:25], v243, v236
    v_cmp_lt_u32 s[38:39], 7, v236
    v_cmp_lt_u32 vcc, 7, v237
    v_cndmask_b32 v33, 0, v240, s[24:25]
    v_cmp_lt_u32 s[24:25], v242, v236
    v_cndmask_b32 v37, 0, v240, s[38:39]
    v_cmp_lt_u32 s[38:39], v242, v237
    v_cndmask_b32 v41, 0, v240, vcc
    v_cndmask_b32 v45, 0, v240, s[24:25]
    v_ashrrev_i32 v245, 31, v236
    v_cndmask_b32 v49, 0, v240, s[38:39]
    v_subrev_u32 v236, 2, v241
    v_add_u32 v237, 16, v236
    v_cmp_lt_u32 s[24:25], v243, v236
    v_cmp_lt_u32 s[38:39], 7, v236
    v_cmp_lt_u32 vcc, 7, v237
    v_cndmask_b32 v34, 0, v240, s[24:25]
    v_cmp_lt_u32 s[24:25], v242, v236
    v_cndmask_b32 v38, 0, v240, s[38:39]
    v_cmp_lt_u32 s[38:39], v242, v237
    v_cndmask_b32 v42, 0, v240, vcc
    v_cndmask_b32 v46, 0, v240, s[24:25]
    v_ashrrev_i32 v246, 31, v236
    v_cndmask_b32 v50, 0, v240, s[38:39]
    v_subrev_u32 v236, 3, v241
    v_add_u32 v237, 16, v236
    v_cmp_lt_u32 s[24:25], v243, v236
    v_cmp_lt_u32 s[38:39], 7, v236
    v_cmp_lt_u32 vcc, 7, v237
    v_cndmask_b32 v35, 0, v240, s[24:25]
    v_cmp_lt_u32 s[24:25], v242, v236
    v_cndmask_b32 v39, 0, v240, s[38:39]
    v_cmp_lt_u32 s[38:39], v242, v237
    v_cndmask_b32 v43, 0, v240, vcc
    v_cndmask_b32 v47, 0, v240, s[24:25]
    v_ashrrev_i32 v247, 31, v236
    v_cndmask_b32 v51, 0, v240, s[38:39]
    v_mov_b32 v236, 0xffff
    v_bfi_b32 v52, v236, v244, v245
    v_bfi_b32 v53, v236, v246, v247
    v_not_b32 v52, v52
    v_not_b32 v53, v53
    v_and_b32 v200, 3, v3
    v_cmp_eq_u32 vcc, 0, v200
    v_lshlrev_b32 v201, 4, v4
    s_lshl_b32 s18, s8, 2
    s_add_u32 s18, s18, s9
    v_cndmask_b32 v76, 0, v28, vcc
    v_cndmask_b32 v77, 0, v28, vcc
    v_cndmask_b32 v78, 0, v28, vcc
    v_cndmask_b32 v79, 0, v28, vcc
    v_cndmask_b32 v80, 0, v28, vcc
    v_cndmask_b32 v81, 0, v28, vcc
    v_cndmask_b32 v82, 0, v28, vcc
    v_cndmask_b32 v83, 0, v28, vcc
    v_cndmask_b32 v84, 0, v28, vcc
    v_cndmask_b32 v85, 0, v28, vcc
    v_cndmask_b32 v86, 0, v28, vcc
    v_cndmask_b32 v87, 0, v28, vcc
    v_cndmask_b32 v88, 0, v28, vcc
    v_cndmask_b32 v89, 0, v28, vcc
    v_cndmask_b32 v90, 0, v28, vcc
    v_cndmask_b32 v91, 0, v28, vcc
    s_mov_b64 exec, s[64:65]
    s_add_u32 s19, s18, 0
    s_and_b32 s19, s19, 15
    s_lshl_b32 s19, s19, 6
    buffer_load_dwordx4 v[76:79], v201, s[60:63], s19 offen
    s_add_u32 s19, s18, 1
    s_and_b32 s19, s19, 15
    s_lshl_b32 s19, s19, 6
    buffer_load_dwordx4 v[80:83], v201, s[60:63], s19 offen
    s_add_u32 s19, s18, 2
    s_and_b32 s19, s19, 15
    s_lshl_b32 s19, s19, 6
    buffer_load_dwordx4 v[84:87], v201, s[60:63], s19 offen
    s_add_u32 s19, s18, 3
    s_and_b32 s19, s19, 15
    s_lshl_b32 s19, s19, 6
    buffer_load_dwordx4 v[88:91], v201, s[60:63], s19 offen
    s_mov_b64 exec, -1
    s_cmp_eq_u32 s6, 28
    s_cbranch_scc1 L_fix
    s_waitcnt vmcnt(8)
    s_barrier
    ds_read_b64_tr_b16 a[0:1], v10 offset:0
    ds_read_b64_tr_b16 a[2:3], v10 offset:512
    ds_read_b64_tr_b16 a[4:5], v10 offset:1024
    ds_read_b64_tr_b16 a[6:7], v10 offset:1536
    ds_read_b64_tr_b16 a[8:9], v10 offset:2048
    ds_read_b64_tr_b16 a[10:11], v10 offset:2560
    ds_read_b128 v[156:159], v11 offset:0
    ds_read_b128 v[160:163], v11 offset:2048
    ds_read_b128 v[164:167], v11 offset:4096
    ds_read_b128 v[168:171], v11 offset:6144
    ds_read_b128 v[172:175], v11 offset:8192
    s_add_u32 m0, s13, 10240
    s_nop 0
    buffer_load_dwordx4 v6, s[40:43], s31 offen lds
    s_add_u32 m0, s13, 14336
    s_nop 0
    buffer_load_dwordx4 v7, s[40:43], s31 offen lds
    s_add_u32 m0, s13, 20480
    s_nop 0
    buffer_load_dwordx4 v6, s[40:43], s32 offen lds
    s_add_u32 m0, s13, 24576
    s_nop 0
    buffer_load_dwordx4 v7, s[40:43], s32 offen lds
    s_add_u32 m0, s12, 24576
    s_nop 0
    buffer_load_dwordx4 v5, s[44:47], s75 offen offset:0 lds
    buffer_load_dwordx4 v5, s[44:47], s75 offen offset:1024 lds
    buffer_load_dwordx4 v5, s[44:47], s75 offen offset:2048 lds
    s_add_u32 m0, s12, 36864
    s_nop 0
    buffer_load_dwordx4 v5, s[44:47], s76 offen offset:0 lds
    buffer_load_dwordx4 v5, s[44:47], s76 offen offset:1024 lds
    buffer_load_dwordx4 v5, s[44:47], s76 offen offset:2048 lds
    s_add_u32 s17, s3, 4
    s_and_b32 s17, s17, 7
    s_lshl_b32 s34, s17, 7
    s_mul_i32 s81, s17, 196608
    s_add_u32 s82, s81, 98304
    s_add_u32 s17, s3, 5
    s_and_b32 s17, s17, 7
    s_lshl_b32 s35, s17, 7
    s_mul_i32 s83, s17, 196608
    s_add_u32 s90, s83, 98304
    v_mov_b32 v58, -1
    v_mov_b32 v59, -1
    v_mov_b32 v60, -1
    v_mov_b32 v61, -1
    s_add_u32 s18, s23, 1048576
    buffer_store_dwordx4 v[58:61], v24, s[52:55], s18 offen
    s_waitcnt lgkmcnt(0)
    v_mfma_f32_16x16x32_bf16 v[96:99], a[0:3], v[156:159], 0
    ds_read_b64_tr_b16 a[12:13], v10 offset:12288
    s_add_u32 s17, s3, 6
    s_and_b32 s17, s17, 7
    s_lshl_b32 s36, s17, 7
    v_mfma_f32_16x16x32_bf16 v[100:103], a[4:7], v[156:159], 0
    ds_read_b64_tr_b16 a[14:15], v10 offset:12800
    s_mul_i32 s91, s17, 196608
    s_add_u32 s92, s91, 98304
    v_mfma_f32_16x16x32_bf16 v[104:107], v[156:159], a[8:11], 0
    ds_read_b64_tr_b16 a[16:17], v10 offset:13312
    s_add_u32 s17, s3, 7
    s_and_b32 s17, s17, 7
    v_mfma_f32_16x16x32_bf16 v[108:111], a[0:3], v[160:163], 0
    ds_read_b64_tr_b16 a[18:19], v10 offset:13824
    s_lshl_b32 s37, s17, 7
    s_mul_i32 s93, s17, 196608
    v_mfma_f32_16x16x32_bf16 v[112:115], a[4:7], v[160:163], 0
    ds_read_b64_tr_b16 a[20:21], v10 offset:14336
    s_add_u32 s94, s93, 98304
    v_mfma_f32_16x16x32_bf16 v[116:119], v[160:163], a[8:11], 0
    ds_read_b64_tr_b16 a[22:23], v10 offset:14848
    s_cmp_ge_u32 s8, 2
    s_cselect_b32 s100, s35, s34
    s_cselect_b32 s101, s37, s36
    v_mfma_f32_16x16x32_bf16 v[120:123], a[0:3], v[164:167], 0
    ds_read_b128 v[176:179], v12 offset:0
    s_add_u32 m0, s14, 20480
    v_mfma_f32_16x16x32_bf16 v[124:127], a[4:7], v[164:167], 0
    ds_read_b128 v[180:183], v12 offset:2048
    buffer_load_dwordx4 v8, s[40:43], s96 offen lds
    v_mfma_f32_16x16x32_bf16 v[128:131], v[164:167], a[8:11], 0
    ds_read_b128 v[184:187], v12 offset:4096
    s_add_u32 m0, s13, 30720
    s_nop 0
    buffer_load_dwordx4 v6, s[40:43], s33 offen lds
    v_mfma_f32_16x16x32_bf16 v[132:135], a[0:3], v[168:171], 0
    ds_read_b128 v[188:191], v12 offset:6144
    s_add_u32 m0, s13, 34816
    s_nop 0
    buffer_load_dwordx4 v7, s[40:43], s33 offen lds
    v_mfma_f32_16x16x32_bf16 v[136:139], a[4:7], v[168:171], 0
    ds_read_b128 v[192:195], v12 offset:8192
    s_add_u32 m0, s12, 49152
    v_mfma_f32_16x16x32_bf16 v[140:143], v[168:171], a[8:11], 0
    buffer_load_dwordx4 v5, s[44:47], s77 offen offset:0 lds
    buffer_load_dwordx4 v5, s[44:47], s77 offen offset:1024 lds
    buffer_load_dwordx4 v5, s[44:47], s77 offen offset:2048 lds
    v_mfma_f32_16x16x32_bf16 v[144:147], a[0:3], v[172:175], 0
    s_add_u32 m0, s12, 61440
    s_nop 0
    buffer_load_dwordx4 v5, s[44:47], s78 offen offset:0 lds
    v_mfma_f32_16x16x32_bf16 v[148:151], a[4:7], v[172:175], 0
    buffer_load_dwordx4 v5, s[44:47], s78 offen offset:1024 lds
    buffer_load_dwordx4 v5, s[44:47], s78 offen offset:2048 lds
    s_add_u32 s18, s23, 1081344
    v_mfma_f32_16x16x32_bf16 v[152:155], v[172:175], a[8:11], 0
    buffer_store_dwordx4 v[58:61], v24, s[52:55], s18 offen
    s_waitcnt lgkmcnt(0)
    s_waitcnt vmcnt(11)
    s_barrier
    v_readfirstlane_b32 s72, v216
    s_nop 0
    s_mul_i32 s72, s72, 0x9e3779b1
    s_add_u32 s72, s72, 0x7f4a7c15
    s_getreg_b32 s5, hwreg(HW_REG_XCC_ID, 0, 4)
    s_add_u32 s5, s5, s72
    v_mfma_f32_16x16x32_bf16 v[96:99], a[12:15], v[176:179], v[96:99]
    ds_read_b64_tr_b16 a[24:25], v10 offset:24576
    s_add_u32 m0, s13, 40960
    s_nop 0
    buffer_load_dwordx4 v6, s[40:43], s34 offen lds
    v_mfma_f32_16x16x32_bf16 v[100:103], a[16:19], v[176:179], v[100:103]
    ds_read_b64_tr_b16 a[26:27], v10 offset:25088
    s_add_u32 m0, s13, 45056
    v_mfma_f32_16x16x32_bf16 v[104:107], v[176:179], a[20:23], v[104:107]
    ds_read_b64_tr_b16 a[28:29], v10 offset:25600
    buffer_load_dwordx4 v7, s[40:43], s34 offen lds
    v_mfma_f32_16x16x32_bf16 v[108:111], a[12:15], v[180:183], v[108:111]
    ds_read_b64_tr_b16 a[30:31], v10 offset:26112
    s_add_u32 m0, s14, 40960
    v_mfma_f32_16x16x32_bf16 v[112:115], a[16:19], v[180:183], v[112:115]
    ds_read_b64_tr_b16 a[32:33], v10 offset:26624
    buffer_load_dwordx4 v8, s[40:43], s100 offen lds
    v_mfma_f32_16x16x32_bf16 v[116:119], v[180:183], a[20:23], v[116:119]
    ds_read_b64_tr_b16 a[34:35], v10 offset:27136
    s_add_u32 m0, s13, 51200
    v_mfma_f32_16x16x32_bf16 v[120:123], a[12:15], v[184:187], v[120:123]
    ds_read_b128 v[156:159], v11 offset:10240
    v_mfma_f32_16x16x32_bf16 v[124:127], a[16:19], v[184:187], v[124:127]
    ds_read_b128 v[160:163], v11 offset:12288
    buffer_load_dwordx4 v6, s[40:43], s35 offen lds
    v_mfma_f32_16x16x32_bf16 v[128:131], v[184:187], a[20:23], v[128:131]
    ds_read_b128 v[164:167], v11 offset:14336
    s_add_u32 m0, s12, 0
    v_mfma_f32_16x16x32_bf16 v[132:135], a[12:15], v[188:191], v[132:135]
    ds_read_b128 v[168:171], v11 offset:16384
    buffer_load_dwordx4 v5, s[44:47], s79 offen offset:0 lds
    v_mfma_f32_16x16x32_bf16 v[136:139], a[16:19], v[188:191], v[136:139]
    ds_read_b128 v[172:175], v11 offset:18432
    s_add_u32 s18, s23, 1114112
    v_mfma_f32_16x16x32_bf16 v[140:143], v[188:191], a[20:23], v[140:143]
    ds_read_b128 v[236:239], v15 offset:0
    buffer_store_dwordx4 v[58:61], v25, s[52:55], s18 offen
    v_mfma_f32_16x16x32_bf16 v[144:147], a[12:15], v[192:195], v[144:147]
    ds_read_b128 v[240:243], v15 offset:2048
    v_mfma_f32_16x16x32_bf16 v[148:151], a[16:19], v[192:195], v[148:151]
    ds_read_b128 v[244:247], v15 offset:4096
    v_mfma_f32_16x16x32_bf16 v[152:155], v[192:195], a[20:23], v[152:155]
    ds_read_b128 v[248:251], v15 offset:6144
    ds_read_b128 v[54:57], v15 offset:8192
    s_waitcnt lgkmcnt(5)
    v_mfma_f32_16x16x32_bf16 v[96:99], a[24:27], v[156:159], v[96:99]
    ds_read_b64_tr_b16 a[36:37], v10 offset:36864
    buffer_load_dwordx4 v5, s[44:47], s79 offen offset:1024 lds
    v_mfma_f32_16x16x32_bf16 v[100:103], a[28:31], v[156:159], v[100:103]
    ds_read_b64_tr_b16 a[38:39], v10 offset:37376
    v_mfma_f32_16x16x32_bf16 v[104:107], v[156:159], a[32:35], v[104:107]
    ds_read_b64_tr_b16 a[40:41], v10 offset:37888
    v_mfma_f32_16x16x32_bf16 v[108:111], a[24:27], v[160:163], v[108:111]
    ds_read_b64_tr_b16 a[42:43], v10 offset:38400
    s_waitcnt lgkmcnt(4)
    v_mfma_f32_16x16x32_bf16 v[196:199], v[236:239], v[236:239], 0
    ds_read_b64_tr_b16 a[44:45], v10 offset:38912
    v_mfma_f32_16x16x32_bf16 v[216:219], v[28:31], v[236:239], 0
    ds_read_b64_tr_b16 a[46:47], v10 offset:39424
    v_mfma_f32_16x16x32_bf16 v[200:203], v[240:243], v[240:243], 0
    ds_read_b128 v[176:179], v12 offset:10240
    v_mfma_f32_16x16x32_bf16 v[220:223], v[28:31], v[240:243], 0
    ds_read_b128 v[180:183], v12 offset:12288
    v_mfma_f32_16x16x32_bf16 v[204:207], v[244:247], v[244:247], 0
    ds_read_b128 v[184:187], v12 offset:14336
    v_mfma_f32_16x16x32_bf16 v[224:227], v[28:31], v[244:247], 0
    ds_read_b128 v[188:191], v12 offset:16384
    v_mfma_f32_16x16x32_bf16 v[208:211], v[248:251], v[248:251], 0
    ds_read_b128 v[192:195], v12 offset:18432
    v_mfma_f32_16x16x32_bf16 v[228:231], v[28:31], v[248:251], 0
    v_mfma_f32_16x16x32_bf16 v[212:215], v[54:57], v[54:57], 0
    v_mfma_f32_16x16x32_bf16 v[232:235], v[28:31], v[54:57], 0
    buffer_load_dwordx4 v5, s[44:47], s79 offen offset:2048 lds
    v_mfma_f32_16x16x32_bf16 v[112:115], a[28:31], v[160:163], v[112:115]
    v_mfma_f32_16x16x32_bf16 v[116:119], v[160:163], a[32:35], v[116:119]
    s_add_u32 m0, s12, 12288
    v_mfma_f32_16x16x32_bf16 v[120:123], a[24:27], v[164:167], v[120:123]
    buffer_load_dwordx4 v5, s[44:47], s80 offen offset:0 lds
    v_mfma_f32_16x16x32_bf16 v[124:127], a[28:31], v[164:167], v[124:127]
    buffer_load_dwordx4 v5, s[44:47], s80 offen offset:1024 lds
    v_mfma_f32_16x16x32_bf16 v[128:131], v[164:167], a[32:35], v[128:131]
    buffer_load_dwordx4 v5, s[44:47], s80 offen offset:2048 lds
    v_mfma_f32_16x16x32_bf16 v[132:135], a[24:27], v[168:171], v[132:135]
    s_add_u32 s18, s23, 6045696
    v_mfma_f32_16x16x32_bf16 v[136:139], a[28:31], v[168:171], v[136:139]
    buffer_store_dwordx4 v[58:61], v27, s[52:55], s18 offen sc1
    v_mfma_f32_16x16x32_bf16 v[140:143], v[168:171], a[32:35], v[140:143]
    s_add_u32 s18, s23, 3506176
    v_mfma_f32_16x16x32_bf16 v[144:147], a[24:27], v[172:175], v[144:147]
    buffer_store_dwordx4 v[58:61], v24, s[52:55], s18 offen
    v_mfma_f32_16x16x32_bf16 v[148:151], a[28:31], v[172:175], v[148:151]
    v_mfma_f32_16x16x32_bf16 v[152:155], v[172:175], a[32:35], v[152:155]
    s_waitcnt lgkmcnt(0)
    s_waitcnt vmcnt(14)
    s_barrier
    v_mfma_f32_16x16x32_bf16 v[96:99], a[36:39], v[176:179], v[96:99]
    ds_read_b64_tr_b16 a[48:49], v10 offset:49152
    s_add_u32 m0, s13, 55296
    s_nop 0
    buffer_load_dwordx4 v7, s[40:43], s35 offen lds
    v_mfma_f32_16x16x32_bf16 v[100:103], a[40:43], v[176:179], v[100:103]
    ds_read_b64_tr_b16 a[50:51], v10 offset:49664
    s_add_u32 m0, s13, 61440
    v_mfma_f32_16x16x32_bf16 v[104:107], v[176:179], a[44:47], v[104:107]
    ds_read_b64_tr_b16 a[52:53], v10 offset:50176
    buffer_load_dwordx4 v6, s[40:43], s36 offen lds
    v_mfma_f32_16x16x32_bf16 v[108:111], a[36:39], v[180:183], v[108:111]
    ds_read_b64_tr_b16 a[54:55], v10 offset:50688
    s_add_u32 m0, s13, 65536
    v_mfma_f32_16x16x32_bf16 v[112:115], a[40:43], v[180:183], v[112:115]
    ds_read_b64_tr_b16 a[56:57], v10 offset:51200
    v_mfma_f32_16x16x32_bf16 v[116:119], v[180:183], a[44:47], v[116:119]
    ds_read_b64_tr_b16 a[58:59], v10 offset:51712
    buffer_load_dwordx4 v7, s[40:43], s36 offen lds
    v_mfma_f32_16x16x32_bf16 v[120:123], a[36:39], v[184:187], v[120:123]
    ds_read_b128 v[156:159], v11 offset:20480
    s_add_u32 m0, s12, 24576
    v_mfma_f32_16x16x32_bf16 v[124:127], a[40:43], v[184:187], v[124:127]
    ds_read_b128 v[160:163], v11 offset:22528
    buffer_load_dwordx4 v5, s[44:47], s81 offen offset:0 lds
    v_mfma_f32_16x16x32_bf16 v[128:131], v[184:187], a[44:47], v[128:131]
    ds_read_b128 v[164:167], v11 offset:24576
    buffer_load_dwordx4 v5, s[44:47], s81 offen offset:1024 lds
    v_mfma_f32_16x16x32_bf16 v[132:135], a[36:39], v[188:191], v[132:135]
    ds_read_b128 v[168:171], v11 offset:26624
    v_mfma_f32_16x16x32_bf16 v[136:139], a[40:43], v[188:191], v[136:139]
    ds_read_b128 v[172:175], v11 offset:28672
    s_add_u32 s18, s23, 3538944
    v_mfma_f32_16x16x32_bf16 v[140:143], v[188:191], a[44:47], v[140:143]
    ds_read_b128 v[236:239], v15 offset:20480
    buffer_store_dwordx4 v[58:61], v24, s[52:55], s18 offen
    v_mfma_f32_16x16x32_bf16 v[144:147], a[36:39], v[192:195], v[144:147]
    ds_read_b128 v[240:243], v15 offset:22528
    v_mfma_f32_16x16x32_bf16 v[148:151], a[40:43], v[192:195], v[148:151]
    ds_read_b128 v[244:247], v15 offset:24576
    v_mfma_f32_16x16x32_bf16 v[152:155], v[192:195], a[44:47], v[152:155]
    ds_read_b128 v[248:251], v15 offset:26624
    ds_read_b128 v[54:57], v15 offset:28672
    s_waitcnt lgkmcnt(5)
    v_mfma_f32_16x16x32_bf16 v[96:99], a[48:51], v[156:159], v[96:99]
    ds_read_b64_tr_b16 a[60:61], v10 offset:61440
    buffer_load_dwordx4 v5, s[44:47], s81 offen offset:2048 lds
    v_mfma_f32_16x16x32_bf16 v[100:103], a[52:55], v[156:159], v[100:103]
    ds_read_b64_tr_b16 a[62:63], v10 offset:61952
    v_mfma_f32_16x16x32_bf16 v[104:107], v[156:159], a[56:59], v[104:107]
    ds_read_b64_tr_b16 a[64:65], v10 offset:62464
    v_mfma_f32_16x16x32_bf16 v[108:111], a[48:51], v[160:163], v[108:111]
    ds_read_b64_tr_b16 a[66:67], v10 offset:62976
    s_waitcnt lgkmcnt(4)
    v_mfma_f32_16x16x32_bf16 v[196:199], v[236:239], v[236:239], v[196:199]
    ds_read_b64_tr_b16 a[68:69], v10 offset:63488
    v_mfma_f32_16x16x32_bf16 v[216:219], v[28:31], v[236:239], v[216:219]
    ds_read_b64_tr_b16 a[70:71], v10 offset:64000
    v_mfma_f32_16x16x32_bf16 v[200:203], v[240:243], v[240:243], v[200:203]
    ds_read_b128 v[176:179], v12 offset:20480
    v_mfma_f32_16x16x32_bf16 v[220:223], v[28:31], v[240:243], v[220:223]
    ds_read_b128 v[180:183], v12 offset:22528
    v_mfma_f32_16x16x32_bf16 v[204:207], v[244:247], v[244:247], v[204:207]
    ds_read_b128 v[184:187], v12 offset:24576
    v_mfma_f32_16x16x32_bf16 v[224:227], v[28:31], v[244:247], v[224:227]
    ds_read_b128 v[188:191], v12 offset:26624
    v_mfma_f32_16x16x32_bf16 v[208:211], v[248:251], v[248:251], v[208:211]
    ds_read_b128 v[192:195], v12 offset:28672
    v_mfma_f32_16x16x32_bf16 v[228:231], v[28:31], v[248:251], v[228:231]
    v_mfma_f32_16x16x32_bf16 v[212:215], v[54:57], v[54:57], v[212:215]
    v_mfma_f32_16x16x32_bf16 v[232:235], v[28:31], v[54:57], v[232:235]
    v_mfma_f32_16x16x32_bf16 v[112:115], a[52:55], v[160:163], v[112:115]
    v_mfma_f32_16x16x32_bf16 v[116:119], v[160:163], a[56:59], v[116:119]
    v_mfma_f32_16x16x32_bf16 v[120:123], a[48:51], v[164:167], v[120:123]
    s_add_u32 m0, s12, 36864
    v_mfma_f32_16x16x32_bf16 v[124:127], a[52:55], v[164:167], v[124:127]
    buffer_load_dwordx4 v5, s[44:47], s82 offen offset:0 lds
    v_mfma_f32_16x16x32_bf16 v[128:131], v[164:167], a[56:59], v[128:131]
    buffer_load_dwordx4 v5, s[44:47], s82 offen offset:1024 lds
    v_mfma_f32_16x16x32_bf16 v[132:135], a[48:51], v[168:171], v[132:135]
    v_mfma_f32_16x16x32_bf16 v[136:139], a[52:55], v[168:171], v[136:139]
    buffer_load_dwordx4 v5, s[44:47], s82 offen offset:2048 lds
    v_mfma_f32_16x16x32_bf16 v[140:143], v[168:171], a[56:59], v[140:143]
    s_add_u32 s18, s23, 3571712
    v_mfma_f32_16x16x32_bf16 v[144:147], a[48:51], v[172:175], v[144:147]
    buffer_store_dwordx4 v[58:61], v25, s[52:55], s18 offen
    v_mfma_f32_16x16x32_bf16 v[148:151], a[52:55], v[172:175], v[148:151]
    v_mfma_f32_16x16x32_bf16 v[152:155], v[172:175], a[56:59], v[152:155]
    s_waitcnt lgkmcnt(0)
    s_waitcnt vmcnt(13)
    s_barrier
    v_mfma_f32_16x16x32_bf16 v[96:99], a[60:63], v[176:179], v[96:99]
    ds_read_b64_tr_b16 a[72:73], v10 offset:0
    s_add_u32 m0, s14, 61440
    s_nop 0
    buffer_load_dwordx4 v8, s[40:43], s101 offen lds
    v_mfma_f32_16x16x32_bf16 v[100:103], a[64:67], v[176:179], v[100:103]
    ds_read_b64_tr_b16 a[74:75], v10 offset:512
    v_mfma_f32_16x16x32_bf16 v[104:107], v[176:179], a[68:71], v[104:107]
    ds_read_b64_tr_b16 a[76:77], v10 offset:1024
    v_mfma_f32_16x16x32_bf16 v[108:111], a[60:63], v[180:183], v[108:111]
    ds_read_b64_tr_b16 a[78:79], v10 offset:1536
    s_add_u32 m0, s13, 71680
    v_mfma_f32_16x16x32_bf16 v[112:115], a[64:67], v[180:183], v[112:115]
    ds_read_b64_tr_b16 a[80:81], v10 offset:2048
    v_mfma_f32_16x16x32_bf16 v[116:119], v[180:183], a[68:71], v[116:119]
    ds_read_b64_tr_b16 a[82:83], v10 offset:2560
    v_mfma_f32_16x16x32_bf16 v[120:123], a[60:63], v[184:187], v[120:123]
    ds_read_b128 v[156:159], v11 offset:30720
    buffer_load_dwordx4 v6, s[40:43], s37 offen lds
    v_mfma_f32_16x16x32_bf16 v[124:127], a[64:67], v[184:187], v[124:127]
    ds_read_b128 v[160:163], v11 offset:32768
    v_mfma_f32_16x16x32_bf16 v[128:131], v[184:187], a[68:71], v[128:131]
    ds_read_b128 v[164:167], v11 offset:34816
    v_mfma_f32_16x16x32_bf16 v[132:135], a[60:63], v[188:191], v[132:135]
    ds_read_b128 v[168:171], v11 offset:36864
    v_mfma_f32_16x16x32_bf16 v[136:139], a[64:67], v[188:191], v[136:139]
    ds_read_b128 v[172:175], v11 offset:38912
    s_add_u32 m0, s13, 75776
    v_mfma_f32_16x16x32_bf16 v[140:143], v[188:191], a[68:71], v[140:143]
    buffer_load_dwordx4 v7, s[40:43], s37 offen lds
    v_mfma_f32_16x16x32_bf16 v[144:147], a[60:63], v[192:195], v[144:147]
    s_add_u32 m0, s12, 49152
    s_nop 0
    buffer_load_dwordx4 v5, s[44:47], s83 offen offset:0 lds
    v_mfma_f32_16x16x32_bf16 v[148:151], a[64:67], v[192:195], v[148:151]
    buffer_load_dwordx4 v5, s[44:47], s83 offen offset:1024 lds
    v_mfma_f32_16x16x32_bf16 v[152:155], v[192:195], a[68:71], v[152:155]
    s_waitcnt lgkmcnt(0)
    v_mfma_f32_16x16x32_bf16 v[248:251], v[76:79], v[28:31], 0
    v_mfma_f32_16x16x32_bf16 v[248:251], v[80:83], v[28:31], v[248:251]
    v_mfma_f32_16x16x32_bf16 v[248:251], v[84:87], v[28:31], v[248:251]
    v_mfma_f32_16x16x32_bf16 v[248:251], v[88:91], v[28:31], v[248:251]
    v_mfma_f32_16x16x32_bf16 v[96:99], a[72:75], v[156:159], v[96:99]
    ds_read_b64_tr_b16 a[84:85], v10 offset:12288
    buffer_load_dwordx4 v5, s[44:47], s83 offen offset:2048 lds
    v_mfma_f32_16x16x32_bf16 v[100:103], a[76:79], v[156:159], v[100:103]
    ds_read_b64_tr_b16 a[86:87], v10 offset:12800
    v_mfma_f32_16x16x32_bf16 v[104:107], v[156:159], a[80:83], v[104:107]
    ds_read_b64_tr_b16 a[88:89], v10 offset:13312
    v_mfma_f32_16x16x32_bf16 v[108:111], a[72:75], v[160:163], v[108:111]
    ds_read_b64_tr_b16 a[90:91], v10 offset:13824
    v_mfma_f32_16x16x32_bf16 v[112:115], a[76:79], v[160:163], v[112:115]
    ds_read_b64_tr_b16 a[92:93], v10 offset:14336
    s_add_u32 m0, s12, 61440
    v_mfma_f32_16x16x32_bf16 v[116:119], v[160:163], a[80:83], v[116:119]
    ds_read_b64_tr_b16 a[94:95], v10 offset:14848
    v_mfma_f32_16x16x32_bf16 v[120:123], a[72:75], v[164:167], v[120:123]
    ds_read_b128 v[176:179], v12 offset:30720
    v_mfma_f32_16x16x32_bf16 v[124:127], a[76:79], v[164:167], v[124:127]
    ds_read_b128 v[180:183], v12 offset:32768
    v_mfma_f32_16x16x32_bf16 v[128:131], v[164:167], a[80:83], v[128:131]
    ds_read_b128 v[184:187], v12 offset:34816
    v_mfma_f32_16x16x32_bf16 v[132:135], a[72:75], v[168:171], v[132:135]
    ds_read_b128 v[188:191], v12 offset:36864
    v_mfma_f32_16x16x32_bf16 v[136:139], a[76:79], v[168:171], v[136:139]
    ds_read_b128 v[192:195], v12 offset:38912
    s_cmp_ge_u32 s70, 4
    s_cbranch_scc1 Lres_1
    ds_read_b64 v[66:67], v64 offset:0
    ds_read_b64 v[68:69], v64 offset:2048
    ds_read_b64 v[70:71], v64 offset:4096
    ds_read_b64 v[72:73], v64 offset:6144
    ds_read_b64 v[74:75], v64 offset:8192
Lres_1:
    v_mfma_f32_16x16x32_bf16 v[140:143], v[168:171], a[80:83], v[140:143]
    buffer_load_dwordx4 v5, s[44:47], s90 offen offset:0 lds
    v_mfma_f32_16x16x32_bf16 v[144:147], a[72:75], v[172:175], v[144:147]
    buffer_load_dwordx4 v5, s[44:47], s90 offen offset:1024 lds
    v_mfma_f32_16x16x32_bf16 v[148:151], a[76:79], v[172:175], v[148:151]
    buffer_load_dwordx4 v5, s[44:47], s90 offen offset:2048 lds
    v_mfma_f32_16x16x32_bf16 v[152:155], v[172:175], a[80:83], v[152:155]
    v_mov_b32 v92, v249
    s_waitcnt lgkmcnt(0)
    s_waitcnt vmcnt(10)
    s_barrier
    v_mfma_f32_16x16x32_bf16 v[96:99], a[84:87], v[176:179], v[96:99]
    ds_read_b64_tr_b16 a[96:97], v10 offset:24576
    s_add_u32 m0, s12, 0
    s_nop 0
    buffer_load_dwordx4 v5, s[44:47], s91 offen offset:0 lds
    v_mfma_f32_16x16x32_bf16 v[100:103], a[88:91], v[176:179], v[100:103]
    ds_read_b64_tr_b16 a[98:99], v10 offset:25088
    v_mfma_f32_16x16x32_bf16 v[104:107], v[176:179], a[92:95], v[104:107]
    ds_read_b64_tr_b16 a[100:101], v10 offset:25600
    buffer_load_dwordx4 v5, s[44:47], s91 offen offset:1024 lds
    v_mfma_f32_16x16x32_bf16 v[108:111], a[84:87], v[180:183], v[108:111]
    ds_read_b64_tr_b16 a[102:103], v10 offset:26112
    v_mfma_f32_16x16x32_bf16 v[112:115], a[88:91], v[180:183], v[112:115]
    ds_read_b64_tr_b16 a[104:105], v10 offset:26624
    buffer_load_dwordx4 v5, s[44:47], s91 offen offset:2048 lds
    v_mfma_f32_16x16x32_bf16 v[116:119], v[180:183], a[92:95], v[116:119]
    ds_read_b64_tr_b16 a[106:107], v10 offset:27136
    v_mfma_f32_16x16x32_bf16 v[120:123], a[84:87], v[184:187], v[120:123]
    ds_read_b128 v[156:159], v13 offset:0
    s_add_u32 m0, s12, 12288
    v_mfma_f32_16x16x32_bf16 v[124:127], a[88:91], v[184:187], v[124:127]
    ds_read_b128 v[160:163], v13 offset:2048
    v_mfma_f32_16x16x32_bf16 v[128:131], v[184:187], a[92:95], v[128:131]
    ds_read_b128 v[164:167], v13 offset:4096
    buffer_load_dwordx4 v5, s[44:47], s92 offen offset:0 lds
    v_mfma_f32_16x16x32_bf16 v[132:135], a[84:87], v[188:191], v[132:135]
    ds_read_b128 v[168:171], v13 offset:6144
    v_mfma_f32_16x16x32_bf16 v[136:139], a[88:91], v[188:191], v[136:139]
    ds_read_b128 v[172:175], v13 offset:8192
    v_mfma_f32_16x16x32_bf16 v[140:143], v[188:191], a[92:95], v[140:143]
    ds_read_b128 v[236:239], v16 offset:0
    v_mfma_f32_16x16x32_bf16 v[144:147], a[84:87], v[192:195], v[144:147]
    ds_read_b128 v[240:243], v16 offset:2048
    v_mfma_f32_16x16x32_bf16 v[148:151], a[88:91], v[192:195], v[148:151]
    ds_read_b128 v[244:247], v16 offset:4096
    v_mfma_f32_16x16x32_bf16 v[152:155], v[192:195], a[92:95], v[152:155]
    ds_read_b128 v[248:251], v16 offset:6144
    ds_read_b128 v[54:57], v16 offset:8192
    s_waitcnt lgkmcnt(5)
    v_mfma_f32_16x16x32_bf16 v[96:99], a[96:99], v[156:159], v[96:99]
    ds_read_b64_tr_b16 a[108:109], v10 offset:36864
    buffer_load_dwordx4 v5, s[44:47], s92 offen offset:1024 lds
    v_mfma_f32_16x16x32_bf16 v[100:103], a[100:103], v[156:159], v[100:103]
    ds_read_b64_tr_b16 a[110:111], v10 offset:37376
    v_mfma_f32_16x16x32_bf16 v[104:107], v[156:159], a[104:107], v[104:107]
    ds_read_b64_tr_b16 a[112:113], v10 offset:37888
    v_mfma_f32_16x16x32_bf16 v[108:111], a[96:99], v[160:163], v[108:111]
    ds_read_b64_tr_b16 a[114:115], v10 offset:38400
    s_waitcnt lgkmcnt(4)
    v_mfma_f32_16x16x32_bf16 v[196:199], v[236:239], v[236:239], v[196:199]
    ds_read_b64_tr_b16 a[116:117], v10 offset:38912
    v_mfma_f32_16x16x32_bf16 v[216:219], v[28:31], v[236:239], v[216:219]
    ds_read_b64_tr_b16 a[118:119], v10 offset:39424
    v_mfma_f32_16x16x32_bf16 v[200:203], v[240:243], v[240:243], v[200:203]
    ds_read_b128 v[176:179], v14 offset:0
    v_mfma_f32_16x16x32_bf16 v[220:223], v[28:31], v[240:243], v[220:223]
    ds_read_b128 v[180:183], v14 offset:2048
    v_mfma_f32_16x16x32_bf16 v[204:207], v[244:247], v[244:247], v[204:207]
    ds_read_b128 v[184:187], v14 offset:4096
    v_mfma_f32_16x16x32_bf16 v[224:227], v[28:31], v[244:247], v[224:227]
    ds_read_b128 v[188:191], v14 offset:6144
    v_mfma_f32_16x16x32_bf16 v[208:211], v[248:251], v[248:251], v[208:211]
    ds_read_b128 v[192:195], v14 offset:8192
    v_mfma_f32_16x16x32_bf16 v[228:231], v[28:31], v[248:251], v[228:231]
    v_mfma_f32_16x16x32_bf16 v[212:215], v[54:57], v[54:57], v[212:215]
    v_mfma_f32_16x16x32_bf16 v[232:235], v[28:31], v[54:57], v[232:235]
    v_mfma_f32_16x16x32_bf16 v[112:115], a[100:103], v[160:163], v[112:115]
    v_mfma_f32_16x16x32_bf16 v[116:119], v[160:163], a[104:107], v[116:119]
    buffer_load_dwordx4 v5, s[44:47], s92 offen offset:2048 lds
    v_mfma_f32_16x16x32_bf16 v[120:123], a[96:99], v[164:167], v[120:123]
    s_lshl_b32 s18, s4, 14
    v_mfma_f32_16x16x32_bf16 v[124:127], a[100:103], v[164:167], v[124:127]
    s_add_u32 s18, s18, 384
    v_mfma_f32_16x16x32_bf16 v[128:131], v[164:167], a[104:107], v[128:131]
    v_mfma_f32_16x16x32_bf16 v[132:135], a[96:99], v[168:171], v[132:135]
    v_lshlrev_b32 v252, 10, v0
    v_mfma_f32_16x16x32_bf16 v[136:139], a[100:103], v[168:171], v[136:139]
    v_lshrrev_b32 v253, 4, v0
    v_mfma_f32_16x16x32_bf16 v[140:143], v[168:171], a[104:107], v[140:143]
    v_lshl_or_b32 v252, v253, 24, v252
    v_mfma_f32_16x16x32_bf16 v[144:147], a[96:99], v[172:175], v[144:147]
    buffer_load_dword v254, v252, s[48:51], s18 offen
    v_mfma_f32_16x16x32_bf16 v[148:151], a[100:103], v[172:175], v[148:151]
    v_mfma_f32_16x16x32_bf16 v[152:155], v[172:175], a[104:107], v[152:155]
    s_waitcnt lgkmcnt(0)
    s_waitcnt vmcnt(7)
    s_barrier
    v_mfma_f32_16x16x32_bf16 v[96:99], a[108:111], v[176:179], v[96:99]
    ds_read_b64_tr_b16 a[120:121], v10 offset:49152
    s_add_u32 m0, s12, 24576
    s_nop 0
    buffer_load_dwordx4 v5, s[44:47], s93 offen offset:0 lds
    v_mfma_f32_16x16x32_bf16 v[100:103], a[112:115], v[176:179], v[100:103]
    ds_read_b64_tr_b16 a[122:123], v10 offset:49664
    v_mfma_f32_16x16x32_bf16 v[104:107], v[176:179], a[116:119], v[104:107]
    ds_read_b64_tr_b16 a[124:125], v10 offset:50176
    buffer_load_dwordx4 v5, s[44:47], s93 offen offset:1024 lds
    v_mfma_f32_16x16x32_bf16 v[108:111], a[108:111], v[180:183], v[108:111]
    ds_read_b64_tr_b16 a[126:127], v10 offset:50688
    v_mfma_f32_16x16x32_bf16 v[112:115], a[112:115], v[180:183], v[112:115]
    ds_read_b64_tr_b16 a[128:129], v10 offset:51200
    buffer_load_dwordx4 v5, s[44:47], s93 offen offset:2048 lds
    v_mfma_f32_16x16x32_bf16 v[116:119], v[180:183], a[116:119], v[116:119]
    ds_read_b64_tr_b16 a[130:131], v10 offset:51712
    v_mfma_f32_16x16x32_bf16 v[120:123], a[108:111], v[184:187], v[120:123]
    ds_read_b128 v[156:159], v13 offset:10240
    s_add_u32 m0, s12, 36864
    v_mfma_f32_16x16x32_bf16 v[124:127], a[112:115], v[184:187], v[124:127]
    ds_read_b128 v[160:163], v13 offset:12288
    v_mfma_f32_16x16x32_bf16 v[128:131], v[184:187], a[116:119], v[128:131]
    ds_read_b128 v[164:167], v13 offset:14336
    buffer_load_dwordx4 v5, s[44:47], s94 offen offset:0 lds
    v_mfma_f32_16x16x32_bf16 v[132:135], a[108:111], v[188:191], v[132:135]
    ds_read_b128 v[168:171], v13 offset:16384
    v_mfma_f32_16x16x32_bf16 v[136:139], a[112:115], v[188:191], v[136:139]
    ds_read_b128 v[172:175], v13 offset:18432
    v_mfma_f32_16x16x32_bf16 v[140:143], v[188:191], a[116:119], v[140:143]
    ds_read_b128 v[236:239], v16 offset:20480
    v_mfma_f32_16x16x32_bf16 v[144:147], a[108:111], v[192:195], v[144:147]
    ds_read_b128 v[240:243], v16 offset:22528
    v_mfma_f32_16x16x32_bf16 v[148:151], a[112:115], v[192:195], v[148:151]
    ds_read_b128 v[244:247], v16 offset:24576
    v_mfma_f32_16x16x32_bf16 v[152:155], v[192:195], a[116:119], v[152:155]
    ds_read_b128 v[248:251], v16 offset:26624
    ds_read_b128 v[54:57], v16 offset:28672
    s_waitcnt lgkmcnt(5)
    v_mfma_f32_16x16x32_bf16 v[96:99], a[120:123], v[156:159], v[96:99]
    ds_read_b64_tr_b16 a[132:133], v10 offset:61440
    buffer_load_dwordx4 v5, s[44:47], s94 offen offset:1024 lds
    v_mfma_f32_16x16x32_bf16 v[100:103], a[124:127], v[156:159], v[100:103]
    ds_read_b64_tr_b16 a[134:135], v10 offset:61952
    v_mfma_f32_16x16x32_bf16 v[104:107], v[156:159], a[128:131], v[104:107]
    ds_read_b64_tr_b16 a[136:137], v10 offset:62464
    v_mfma_f32_16x16x32_bf16 v[108:111], a[120:123], v[160:163], v[108:111]
    ds_read_b64_tr_b16 a[138:139], v10 offset:62976
    s_waitcnt lgkmcnt(4)
    v_mfma_f32_16x16x32_bf16 v[196:199], v[236:239], v[236:239], v[196:199]
    ds_read_b64_tr_b16 a[140:141], v10 offset:63488
    v_mfma_f32_16x16x32_bf16 v[216:219], v[28:31], v[236:239], v[216:219]
    ds_read_b64_tr_b16 a[142:143], v10 offset:64000
    v_mfma_f32_16x16x32_bf16 v[200:203], v[240:243], v[240:243], v[200:203]
    ds_read_b128 v[176:179], v14 offset:10240
    v_mfma_f32_16x16x32_bf16 v[220:223], v[28:31], v[240:243], v[220:223]
    ds_read_b128 v[180:183], v14 offset:12288
    v_mfma_f32_16x16x32_bf16 v[204:207], v[244:247], v[244:247], v[204:207]
    ds_read_b128 v[184:187], v14 offset:14336
    v_mfma_f32_16x16x32_bf16 v[224:227], v[28:31], v[244:247], v[224:227]
    ds_read_b128 v[188:191], v14 offset:16384
    v_mfma_f32_16x16x32_bf16 v[208:211], v[248:251], v[248:251], v[208:211]
    ds_read_b128 v[192:195], v14 offset:18432
    v_mfma_f32_16x16x32_bf16 v[228:231], v[28:31], v[248:251], v[228:231]
    v_mfma_f32_16x16x32_bf16 v[212:215], v[54:57], v[54:57], v[212:215]
    v_mfma_f32_16x16x32_bf16 v[232:235], v[28:31], v[54:57], v[232:235]
    v_cndmask_b32 v196, v196, v197, s[66:67]
    v_cndmask_b32 v198, v198, v199, s[66:67]
    v_cndmask_b32 v200, v200, v201, s[66:67]
    v_mfma_f32_16x16x32_bf16 v[112:115], a[124:127], v[160:163], v[112:115]
    v_cndmask_b32 v202, v202, v203, s[66:67]
    v_cndmask_b32 v196, v196, v198, s[68:69]
    v_mfma_f32_16x16x32_bf16 v[116:119], v[160:163], a[128:131], v[116:119]
    v_cndmask_b32 v204, v204, v205, s[66:67]
    v_cndmask_b32 v206, v206, v207, s[66:67]
    v_cndmask_b32 v200, v200, v202, s[68:69]
    v_mfma_f32_16x16x32_bf16 v[120:123], a[120:123], v[164:167], v[120:123]
    v_cndmask_b32 v208, v208, v209, s[66:67]
    v_cndmask_b32 v210, v210, v211, s[66:67]
    v_cndmask_b32 v204, v204, v206, s[68:69]
    v_mfma_f32_16x16x32_bf16 v[124:127], a[124:127], v[164:167], v[124:127]
    buffer_load_dwordx4 v5, s[44:47], s94 offen offset:2048 lds
    v_mfma_f32_16x16x32_bf16 v[128:131], v[164:167], a[128:131], v[128:131]
    s_add_u32 s18, s10, 786432
    v_mfma_f32_16x16x32_bf16 v[132:135], a[120:123], v[168:171], v[132:135]
    v_mov_b32 v62, s5
    v_mfma_f32_16x16x32_bf16 v[136:139], a[124:127], v[168:171], v[136:139]
    s_mov_b64 exec, s[0:1]
    ds_write2_b32 v95, v196, v216 offset0:0 offset1:1
    ds_write2_b32 v95, v200, v220 offset0:2 offset1:3
    ds_write2_b32 v95, v204, v224 offset0:64 offset1:65
    s_mov_b64 exec, -1
    v_mfma_f32_16x16x32_bf16 v[140:143], v[168:171], a[128:131], v[140:143]
    v_cndmask_b32 v212, v212, v213, s[66:67]
    v_lshlrev_b32 v63, 24, v0
    v_mfma_f32_16x16x32_bf16 v[144:147], a[120:123], v[172:175], v[144:147]
    v_cndmask_b32 v214, v214, v215, s[66:67]
    v_cndmask_b32 v208, v208, v210, s[68:69]
    buffer_store_dword v62, v63, s[52:55], s18 offen sc1
    v_mfma_f32_16x16x32_bf16 v[148:151], a[124:127], v[172:175], v[148:151]
    v_cndmask_b32 v212, v212, v214, s[68:69]
    v_mfma_f32_16x16x32_bf16 v[152:155], v[172:175], a[128:131], v[152:155]
    s_mov_b64 exec, s[0:1]
    ds_write2_b32 v95, v208, v228 offset0:66 offset1:67
    ds_write2_b32 v95, v212, v232 offset0:128 offset1:129
    s_mov_b64 exec, -1
    s_waitcnt lgkmcnt(0)
    s_waitcnt vmcnt(8)
    s_barrier
    v_mfma_f32_16x16x32_bf16 v[96:99], a[132:135], v[176:179], v[96:99]
    ds_read_b64_tr_b16 a[144:145], v10 offset:0
    v_lshlrev_b32 v249, 8, v4
    buffer_load_dwordx4 v[236:239], v249, s[52:55], s87 offen offset:0 sc1
    buffer_load_dwordx4 v[240:243], v249, s[52:55], s87 offen offset:1024 sc1
    v_mfma_f32_16x16x32_bf16 v[100:103], a[136:139], v[176:179], v[100:103]
    ds_read_b64_tr_b16 a[146:147], v10 offset:512
    buffer_load_dwordx4 v[244:247], v17, s[52:55], s87 offen offset:2048 sc1
    v_mfma_f32_16x16x32_bf16 v[104:107], v[176:179], a[140:143], v[104:107]
    ds_read_b64_tr_b16 a[148:149], v10 offset:1024
    v_mfma_f32_16x16x32_bf16 v[108:111], a[132:135], v[180:183], v[108:111]
    ds_read_b64 v[202:203], v26
    ds_read_b64_tr_b16 a[150:151], v10 offset:1536
    v_mfma_f32_16x16x32_bf16 v[112:115], a[136:139], v[180:183], v[112:115]
    ds_read_b64 v[204:205], v26 offset:1280
    ds_read_b64_tr_b16 a[152:153], v10 offset:2048
    v_mfma_f32_16x16x32_bf16 v[116:119], v[180:183], a[140:143], v[116:119]
    ds_read_b64_tr_b16 a[154:155], v10 offset:2560
    v_lshrrev_b32 v252, 4, v0
    v_lshlrev_b32 v252, 14, v252
    v_lshl_add_u32 v252, v3, 7, v252
    v_cmp_gt_u32 vcc, 80, v0
    v_mov_b32 v253, 1073741824
    s_nop 0
    v_cndmask_b32 v252, v253, v252, vcc
    s_lshl_b32 s18, s7, 11
    s_add_u32 s18, s18, s23
    s_add_u32 s19, s18, 1048576
    buffer_load_dword v254, v252, s[52:55], s19 offen sc1
    v_mfma_f32_16x16x32_bf16 v[120:123], a[132:135], v[184:187], v[120:123]
    ds_read_b128 v[156:159], v13 offset:20480
    v_mfma_f32_16x16x32_bf16 v[124:127], a[136:139], v[184:187], v[124:127]
    ds_read_b64 v[206:207], v26 offset:2560
    ds_read_b128 v[160:163], v13 offset:22528
    v_mfma_f32_16x16x32_bf16 v[128:131], v[184:187], a[140:143], v[128:131]
    ds_read_b64 v[208:209], v26 offset:3840
    s_movk_i32 s36, 80
    ds_read_b128 v[164:167], v13 offset:24576
    v_mfma_f32_16x16x32_bf16 v[132:135], a[132:135], v[188:191], v[132:135]
    v_cmp_gt_u32 s[36:37], s36, v0
    ds_read_b128 v[168:171], v13 offset:26624
    v_mfma_f32_16x16x32_bf16 v[136:139], a[136:139], v[188:191], v[136:139]
    v_lshlrev_b32 v200, 2, v0
    ds_read_b128 v[172:175], v13 offset:28672
    v_mfma_f32_16x16x32_bf16 v[140:143], v[188:191], a[140:143], v[140:143]
    s_mul_i32 s18, s6, 1280
    s_add_u32 s18, s18, 65536
    v_lshlrev_b32 v253, 7, v0
    v_min_u32 v253, 1152, v253
    buffer_load_dword v254, v253, s[52:55], s18 offen sc1
    v_mfma_f32_16x16x32_bf16 v[144:147], a[132:135], v[192:195], v[144:147]
    s_add_u32 m0, s88, 0
    s_mov_b32 s17, 65536
    buffer_load_dwordx4 v9, s[48:51], s17 offen offset:0 lds
    v_mfma_f32_16x16x32_bf16 v[148:151], a[136:139], v[192:195], v[148:151]
    s_add_u32 m0, s88, 0
    s_mov_b32 s17, 72704
    buffer_load_dwordx4 v23, s[48:51], s17 offen offset:1024 lds
    v_mfma_f32_16x16x32_bf16 v[152:155], v[192:195], a[140:143], v[152:155]
    v_add_u32 v201, 161728, v200
    v_add_u32 v200, 160768, v200
    s_waitcnt lgkmcnt(0)
    v_mfma_f32_16x16x32_bf16 v[96:99], a[144:147], v[156:159], v[96:99]
    ds_read_b64_tr_b16 a[156:157], v10 offset:12288
    s_add_u32 m0, s88, 0
    s_mov_b32 s17, 79872
    buffer_load_dwordx4 v9, s[48:51], s17 offen offset:2048 lds
    v_mfma_f32_16x16x32_bf16 v[100:103], a[148:151], v[156:159], v[100:103]
    ds_read_b64_tr_b16 a[158:159], v10 offset:12800
    v_mfma_f32_16x16x32_bf16 v[104:107], v[156:159], a[152:155], v[104:107]
    v_cndmask_b32 v200, v201, v200, s[36:37]
    ds_read_b64_tr_b16 a[160:161], v10 offset:13312
    v_mfma_f32_16x16x32_bf16 v[108:111], a[144:147], v[160:163], v[108:111]
    ds_read_b64_tr_b16 a[162:163], v10 offset:13824
    v_mfma_f32_16x16x32_bf16 v[112:115], a[148:151], v[160:163], v[112:115]
    ds_read_b64_tr_b16 a[164:165], v10 offset:14336
    v_mfma_f32_16x16x32_bf16 v[116:119], v[160:163], a[152:155], v[116:119]
    s_waitcnt lgkmcnt(8)
    ds_read_b64_tr_b16 a[166:167], v10 offset:14848
    v_mfma_f32_16x16x32_bf16 v[120:123], a[144:147], v[164:167], v[120:123]
    ds_read_b128 v[176:179], v14 offset:20480
    s_add_u32 m0, s88, 0
    s_mov_b32 s17, 87040
    buffer_load_dwordx4 v23, s[48:51], s17 offen offset:3072 lds
    v_mfma_f32_16x16x32_bf16 v[124:127], a[148:151], v[164:167], v[124:127]
    ds_read_b128 v[180:183], v14 offset:22528
    v_mfma_f32_16x16x32_bf16 v[128:131], v[164:167], a[152:155], v[128:131]
    v_add_f32 v202, v202, v204
    v_add_f32 v203, v203, v205
    ds_read_b128 v[184:187], v14 offset:24576
    v_mfma_f32_16x16x32_bf16 v[132:135], a[144:147], v[168:171], v[132:135]
    v_add_f32 v206, v206, v208
    ds_read_b128 v[188:191], v14 offset:26624
    v_mfma_f32_16x16x32_bf16 v[136:139], a[148:151], v[168:171], v[136:139]
    v_add_f32 v207, v207, v209
    v_add_f32 v202, v202, v206
    ds_read_b128 v[192:195], v14 offset:28672
    s_cmp_ge_u32 s70, 4
    s_cbranch_scc0 Lres_2
    ds_read_b64 v[66:67], v64 offset:0
    ds_read_b64 v[68:69], v64 offset:2048
    ds_read_b64 v[70:71], v64 offset:4096
    ds_read_b64 v[72:73], v64 offset:6144
    ds_read_b64 v[74:75], v64 offset:8192
Lres_2:
    v_mfma_f32_16x16x32_bf16 v[140:143], v[168:171], a[152:155], v[140:143]
    s_add_u32 m0, s88, 16384
    s_mov_b32 s17, 98304
    buffer_load_dwordx4 v9, s[48:51], s17 offen offset:0 lds
    v_mfma_f32_16x16x32_bf16 v[144:147], a[144:147], v[172:175], v[144:147]
    v_add_f32 v203, v203, v207
    v_mul_f32 v204, 0x3b000000, v203
    v_mfma_f32_16x16x32_bf16 v[148:151], a[148:151], v[172:175], v[148:151]
    s_add_u32 m0, s88, 16384
    s_mov_b32 s17, 105472
    buffer_load_dwordx4 v23, s[48:51], s17 offen offset:1024 lds
    v_mfma_f32_16x16x32_bf16 v[152:155], v[172:175], a[152:155], v[152:155]
    v_mul_f32 v205, 0x3b000000, v202
    v_fma_f32 v205, -v204, v204, v205
    v_max_f32 v205, 0, v205
    v_cvt_pk_bf16_f32 v207, v205, v205
    v_cvt_pk_bf16_f32 v206, v204, v204
    v_and_b32 v207, 0xffff0000, v207
    v_and_b32 v206, 0xffff0000, v206
    v_add_f32 v207, 0x3727c5ac, v207
    v_cvt_pk_bf16_f32 v207, v207, v207
    v_and_b32 v207, 0xffff0000, v207
    v_sqrt_f32 v207, v207
    s_nop 0
    v_cvt_pk_bf16_f32 v207, v207, v207
    v_and_b32 v207, 0xffff0000, v207
    v_rcp_f32 v208, v207
    v_sub_f32 v209, 0, v206
    ds_write2_b32 v200, v208, v209 offset0:0 offset1:80
    s_waitcnt lgkmcnt(0)
    s_waitcnt vmcnt(12)
    s_barrier
    v_mfma_f32_16x16x32_bf16 v[96:99], a[156:159], v[176:179], v[96:99]
    ds_read_b64_tr_b16 a[168:169], v10 offset:24576
    s_add_u32 m0, s88, 16384
    s_mov_b32 s17, 112640
    buffer_load_dwordx4 v9, s[48:51], s17 offen offset:2048 lds
    v_mfma_f32_16x16x32_bf16 v[100:103], a[160:163], v[176:179], v[100:103]
    ds_read_b64_tr_b16 a[170:171], v10 offset:25088
    v_mfma_f32_16x16x32_bf16 v[104:107], v[176:179], a[164:167], v[104:107]
    ds_read_b64_tr_b16 a[172:173], v10 offset:25600
    v_mfma_f32_16x16x32_bf16 v[108:111], a[156:159], v[180:183], v[108:111]
    ds_read_b64_tr_b16 a[174:175], v10 offset:26112
    v_mfma_f32_16x16x32_bf16 v[112:115], a[160:163], v[180:183], v[112:115]
    s_waitcnt vmcnt(9)
    ds_read_b64_tr_b16 a[176:177], v10 offset:26624
    v_mfma_f32_16x16x32_bf16 v[116:119], v[180:183], a[164:167], v[116:119]
    v_xor_b32 v252, s72, v239
    v_xor_b32 v253, s72, v243
    ds_read_b64_tr_b16 a[178:179], v10 offset:27136
    v_mfma_f32_16x16x32_bf16 v[120:123], a[156:159], v[184:187], v[120:123]
    ds_read_b128 v[156:159], v13 offset:30720
    s_add_u32 m0, s88, 16384
    s_mov_b32 s17, 119808
    buffer_load_dwordx4 v23, s[48:51], s17 offen offset:3072 lds
    v_mfma_f32_16x16x32_bf16 v[124:127], a[160:163], v[184:187], v[124:127]
    ds_read_b128 v[160:163], v13 offset:32768
    v_mfma_f32_16x16x32_bf16 v[128:131], v[184:187], a[164:167], v[128:131]
    v_xor_b32 v248, s72, v247
    v_or3_b32 v252, v252, v253, v248
    ds_read_b128 v[164:167], v13 offset:34816
    v_mfma_f32_16x16x32_bf16 v[132:135], a[156:159], v[188:191], v[132:135]
    v_cmp_ne_u32 vcc, 0, v252
    ds_read_b128 v[168:171], v13 offset:36864
    v_mfma_f32_16x16x32_bf16 v[136:139], a[160:163], v[188:191], v[136:139]
    s_cbranch_vccnz Lslow_3
Lback_4:
    ds_read_b128 v[172:175], v13 offset:38912
    v_mfma_f32_16x16x32_bf16 v[140:143], v[188:191], a[164:167], v[140:143]
    s_add_u32 m0, s88, 131072
    s_mov_b32 s17, 0
    buffer_load_dwordx4 v9, s[48:51], s17 offen offset:0 lds
    v_mfma_f32_16x16x32_bf16 v[144:147], a[156:159], v[192:195], v[144:147]
    v_mov_b32 v54, v236
    v_mov_b32 v55, v237
    v_mov_b32 v56, v238
    v_mfma_f32_16x16x32_bf16 v[148:151], a[160:163], v[192:195], v[148:151]
    s_add_u32 m0, s88, 131072
    s_mov_b32 s17, 7168
    buffer_load_dwordx4 v23, s[48:51], s17 offen offset:1024 lds
    v_mfma_f32_16x16x32_bf16 v[152:155], v[192:195], a[164:167], v[152:155]
    v_mov_b32 v57, v240
    v_mov_b32 v58, v241
    s_waitcnt lgkmcnt(0)
    v_mfma_f32_16x16x32_bf16 v[96:99], a[168:171], v[156:159], v[96:99]
    ds_read_b64_tr_b16 a[180:181], v10 offset:36864
    s_add_u32 m0, s88, 131072
    s_mov_b32 s17, 14336
    buffer_load_dwordx4 v9, s[48:51], s17 offen offset:2048 lds
    v_mfma_f32_16x16x32_bf16 v[100:103], a[172:175], v[156:159], v[100:103]
    ds_read_b64_tr_b16 a[182:183], v10 offset:37376
    v_mfma_f32_16x16x32_bf16 v[104:107], v[156:159], a[176:179], v[104:107]
    v_mov_b32 v59, v242
    v_mov_b32 v60, v244
    ds_read_b64_tr_b16 a[184:185], v10 offset:37888
    v_mfma_f32_16x16x32_bf16 v[108:111], a[168:171], v[160:163], v[108:111]
    ds_read_b64_tr_b16 a[186:187], v10 offset:38400
    s_add_u32 m0, s88, 131072
    s_mov_b32 s17, 21504
    buffer_load_dwordx4 v23, s[48:51], s17 offen offset:3072 lds
    v_mfma_f32_16x16x32_bf16 v[112:115], a[172:175], v[160:163], v[112:115]
    ds_read_b64_tr_b16 a[188:189], v10 offset:38912
    v_mfma_f32_16x16x32_bf16 v[116:119], v[160:163], a[176:179], v[116:119]
    v_mov_b32 v61, v245
    v_mov_b32 v62, v246
    ds_read_b64_tr_b16 a[190:191], v10 offset:39424
    v_mfma_f32_16x16x32_bf16 v[120:123], a[168:171], v[164:167], v[120:123]
    v_mov_b32 v63, v246
    ds_read_b128 v[176:179], v14 offset:30720
    v_mfma_f32_16x16x32_bf16 v[124:127], a[172:175], v[164:167], v[124:127]
    ds_read_b128 v[180:183], v14 offset:32768
    s_add_u32 m0, s88, 81920
    s_mov_b32 s17, 32768
    buffer_load_dwordx4 v9, s[48:51], s17 offen offset:0 lds
    v_mfma_f32_16x16x32_bf16 v[128:131], v[164:167], a[176:179], v[128:131]
    ds_read_b128 v[184:187], v14 offset:34816
    v_mfma_f32_16x16x32_bf16 v[132:135], a[168:171], v[168:171], v[132:135]
    ds_read_b128 v[188:191], v14 offset:36864
    s_cmp_eq_u32 s6, 0
    v_mfma_f32_16x16x32_bf16 v[136:139], a[172:175], v[168:171], v[136:139]
    ds_read_b128 v[192:195], v14 offset:38912
    s_cselect_b32 s18, 7, 15
    v_mfma_f32_16x16x32_bf16 v[140:143], v[168:171], a[176:179], v[140:143]
    s_cselect_b32 s19, 0, 1024
    v_and_b32 v251, s18, v2
    v_mfma_f32_16x16x32_bf16 v[144:147], a[168:171], v[172:175], v[144:147]
    s_lshl_b32 s38, s6, 10
    s_sub_u32 s38, s38, s19
    v_mfma_f32_16x16x32_bf16 v[148:151], a[172:175], v[172:175], v[148:151]
    v_lshlrev_b32 v251, 7, v251
    s_add_u32 s38, s38, 786432
    v_mfma_f32_16x16x32_bf16 v[152:155], v[172:175], a[176:179], v[152:155]
    buffer_load_dword v250, v251, s[52:55], s38 offen sc1
    s_waitcnt lgkmcnt(0)
    v_mfma_f32_16x16x32_bf16 v[96:99], a[180:183], v[176:179], v[96:99]
    ds_read2_b32 v[196:197], v93 offset0:0 offset1:80
    ds_read_b128 v[198:201], v94 offset:0
    v_mfma_f32_16x16x32_bf16 v[100:103], a[184:187], v[176:179], v[100:103]
    ds_read_b128 v[202:205], v94 offset:320
    v_mfma_f32_16x16x32_bf16 v[104:107], v[176:179], a[188:191], v[104:107]
    s_add_u32 m0, s88, 81920
    s_mov_b32 s17, 39936
    buffer_load_dwordx4 v23, s[48:51], s17 offen offset:1024 lds
    ds_read2_b32 v[206:207], v93 offset0:16 offset1:96
    ds_read_b128 v[208:211], v94 offset:64
    v_mfma_f32_16x16x32_bf16 v[108:111], a[180:183], v[180:183], v[108:111]
    ds_read_b128 v[212:215], v94 offset:384
    v_mfma_f32_16x16x32_bf16 v[112:115], a[184:187], v[180:183], v[112:115]
    ds_read2_b32 v[216:217], v93 offset0:32 offset1:112
    ds_read_b128 v[218:221], v94 offset:128
    v_mfma_f32_16x16x32_bf16 v[116:119], v[180:183], a[188:191], v[116:119]
    ds_read_b128 v[222:225], v94 offset:448
    v_mfma_f32_16x16x32_bf16 v[120:123], a[180:183], v[184:187], v[120:123]
    ds_read2_b32 v[226:227], v93 offset0:48 offset1:128
    ds_read_b128 v[228:231], v94 offset:192
    v_mfma_f32_16x16x32_bf16 v[124:127], a[184:187], v[184:187], v[124:127]
    s_add_u32 m0, s88, 81920
    s_mov_b32 s17, 47104
    buffer_load_dwordx4 v9, s[48:51], s17 offen offset:2048 lds
    ds_read_b128 v[232:235], v94 offset:512
    v_mfma_f32_16x16x32_bf16 v[128:131], v[184:187], a[188:191], v[128:131]
    ds_read2_b32 v[236:237], v93 offset0:64 offset1:144
    ds_read_b128 v[238:241], v94 offset:256
    v_mfma_f32_16x16x32_bf16 v[132:135], a[180:183], v[188:191], v[132:135]
    ds_read_b128 v[242:245], v94 offset:576
    v_mfma_f32_16x16x32_bf16 v[136:139], a[184:187], v[188:191], v[136:139]
    v_mfma_f32_16x16x32_bf16 v[140:143], v[188:191], a[188:191], v[140:143]
    v_mfma_f32_16x16x32_bf16 v[144:147], a[180:183], v[192:195], v[144:147]
    s_add_u32 m0, s88, 81920
    s_mov_b32 s17, 54272
    buffer_load_dwordx4 v23, s[48:51], s17 offen offset:3072 lds
    v_mfma_f32_16x16x32_bf16 v[148:151], a[184:187], v[192:195], v[148:151]
    v_mfma_f32_16x16x32_bf16 v[152:155], v[192:195], a[188:191], v[152:155]
    s_waitcnt lgkmcnt(12)
    v_lshrrev_b32 v252, 4, v0
    v_lshlrev_b32 v252, 14, v252
    v_lshl_add_u32 v252, v3, 7, v252
    v_cmp_gt_u32 vcc, 80, v0
    v_mov_b32 v253, 1073741824
    s_nop 0
    v_cndmask_b32 v252, v253, v252, vcc
    s_lshl_b32 s18, s7, 11
    s_add_u32 s18, s18, s23
    s_add_u32 s19, s18, 3506176
    buffer_load_dword v254, v252, s[52:55], s19 offen sc1
    v_pk_fma_f32 v[100:101], v[58:59], v[196:197], v[100:101] op_sel:[0,1,0] op_sel_hi:[1,1,1]
    v_pk_fma_f32 v[102:103], v[60:61], v[196:197], v[102:103] op_sel:[0,1,0] op_sel_hi:[1,1,1]
    v_pk_fma_f32 v[96:97], v[54:55], v[196:197], v[96:97] op_sel:[0,1,0] op_sel_hi:[1,1,1]
    v_pk_fma_f32 v[98:99], v[56:57], v[196:197], v[98:99] op_sel:[0,1,0] op_sel_hi:[1,1,1]
    v_pk_fma_f32 v[104:105], v[62:63], v[202:203], v[104:105]
    v_pk_fma_f32 v[106:107], v[62:63], v[204:205], v[106:107]
    v_pk_mul_f32 v[100:101], v[100:101], v[196:197] op_sel_hi:[1,0]
    v_pk_mul_f32 v[102:103], v[102:103], v[196:197] op_sel_hi:[1,0]
    v_pk_mul_f32 v[104:105], v[104:105], v[198:199]
    v_pk_mul_f32 v[106:107], v[106:107], v[200:201]
    v_cvt_pk_bf16_f32 v156, v96, v97
    v_cvt_pk_bf16_f32 v157, v98, v99
    v_cvt_pk_bf16_f32 v166, v100, v101
    v_cvt_pk_bf16_f32 v167, v102, v103
    v_cvt_pk_bf16_f32 v176, v104, v105
    v_cvt_pk_bf16_f32 v177, v106, v107
    v_mul_f32 v196, 0x3eb8aa3b, v196
    s_waitcnt lgkmcnt(9)
    v_pk_fma_f32 v[112:113], v[58:59], v[206:207], v[112:113] op_sel:[0,1,0] op_sel_hi:[1,1,1]
    v_pk_fma_f32 v[114:115], v[60:61], v[206:207], v[114:115] op_sel:[0,1,0] op_sel_hi:[1,1,1]
    v_pk_fma_f32 v[108:109], v[54:55], v[206:207], v[108:109] op_sel:[0,1,0] op_sel_hi:[1,1,1]
    v_pk_fma_f32 v[110:111], v[56:57], v[206:207], v[110:111] op_sel:[0,1,0] op_sel_hi:[1,1,1]
    v_pk_fma_f32 v[116:117], v[62:63], v[212:213], v[116:117]
    v_pk_fma_f32 v[118:119], v[62:63], v[214:215], v[118:119]
    v_pk_mul_f32 v[112:113], v[112:113], v[206:207] op_sel_hi:[1,0]
    v_pk_mul_f32 v[114:115], v[114:115], v[206:207] op_sel_hi:[1,0]
    v_pk_mul_f32 v[116:117], v[116:117], v[208:209]
    v_pk_mul_f32 v[118:119], v[118:119], v[210:211]
    v_cvt_pk_bf16_f32 v158, v108, v109
    v_cvt_pk_bf16_f32 v159, v110, v111
    v_cvt_pk_bf16_f32 v168, v112, v113
    v_cvt_pk_bf16_f32 v169, v114, v115
    v_cvt_pk_bf16_f32 v178, v116, v117
    v_cvt_pk_bf16_f32 v179, v118, v119
    v_mul_f32 v206, 0x3eb8aa3b, v206
    s_waitcnt lgkmcnt(3)
    v_pk_fma_f32 v[136:137], v[58:59], v[226:227], v[136:137] op_sel:[0,1,0] op_sel_hi:[1,1,1]
    v_pk_fma_f32 v[138:139], v[60:61], v[226:227], v[138:139] op_sel:[0,1,0] op_sel_hi:[1,1,1]
    v_pk_fma_f32 v[132:133], v[54:55], v[226:227], v[132:133] op_sel:[0,1,0] op_sel_hi:[1,1,1]
    v_pk_fma_f32 v[134:135], v[56:57], v[226:227], v[134:135] op_sel:[0,1,0] op_sel_hi:[1,1,1]
    v_pk_fma_f32 v[140:141], v[62:63], v[232:233], v[140:141]
    v_pk_fma_f32 v[142:143], v[62:63], v[234:235], v[142:143]
    v_pk_mul_f32 v[136:137], v[136:137], v[226:227] op_sel_hi:[1,0]
    v_pk_mul_f32 v[138:139], v[138:139], v[226:227] op_sel_hi:[1,0]
    v_pk_mul_f32 v[140:141], v[140:141], v[228:229]
    v_pk_mul_f32 v[142:143], v[142:143], v[230:231]
    v_cvt_pk_bf16_f32 v162, v132, v133
    v_cvt_pk_bf16_f32 v163, v134, v135
    v_cvt_pk_bf16_f32 v172, v136, v137
    v_cvt_pk_bf16_f32 v173, v138, v139
    v_cvt_pk_bf16_f32 v182, v140, v141
    v_cvt_pk_bf16_f32 v183, v142, v143
    v_mul_f32 v226, 0x3eb8aa3b, v226
    s_waitcnt lgkmcnt(0)
    v_pk_fma_f32 v[148:149], v[58:59], v[236:237], v[148:149] op_sel:[0,1,0] op_sel_hi:[1,1,1]
    v_pk_fma_f32 v[150:151], v[60:61], v[236:237], v[150:151] op_sel:[0,1,0] op_sel_hi:[1,1,1]
    v_pk_fma_f32 v[144:145], v[54:55], v[236:237], v[144:145] op_sel:[0,1,0] op_sel_hi:[1,1,1]
    v_pk_fma_f32 v[146:147], v[56:57], v[236:237], v[146:147] op_sel:[0,1,0] op_sel_hi:[1,1,1]
    v_pk_fma_f32 v[152:153], v[62:63], v[242:243], v[152:153]
    v_pk_fma_f32 v[154:155], v[62:63], v[244:245], v[154:155]
    v_pk_mul_f32 v[148:149], v[148:149], v[236:237] op_sel_hi:[1,0]
    v_pk_mul_f32 v[150:151], v[150:151], v[236:237] op_sel_hi:[1,0]
    v_pk_mul_f32 v[152:153], v[152:153], v[238:239]
    v_pk_mul_f32 v[154:155], v[154:155], v[240:241]
    v_cvt_pk_bf16_f32 v164, v144, v145
    v_cvt_pk_bf16_f32 v165, v146, v147
    v_cvt_pk_bf16_f32 v174, v148, v149
    v_cvt_pk_bf16_f32 v175, v150, v151
    v_cvt_pk_bf16_f32 v184, v152, v153
    v_cvt_pk_bf16_f32 v185, v154, v155
    v_mul_f32 v236, 0x3eb8aa3b, v236
    v_mfma_f32_16x16x16_bf16 v[96:99], v[166:167], v[156:157], v[32:35]
    v_fmac_f32 v120, v54, v217
    v_fmac_f32 v121, v55, v217
    v_fmac_f32 v122, v56, v217
    v_mfma_f32_16x16x16_bf16 v[112:115], v[166:167], v[158:159], v[40:43]
    v_fmac_f32 v123, v57, v217
    v_fmac_f32 v124, v58, v217
    v_fmac_f32 v125, v59, v217
    v_mfma_f32_16x16x16_bf16 v[108:111], v[168:169], v[158:159], v[36:39]
    v_fmac_f32 v126, v60, v217
    v_fmac_f32 v127, v61, v217
    v_mfma_f32_16x16x16_bf16 v[148:151], v[172:173], v[164:165], v[48:51]
    v_mul_f32 v124, v124, v216
    v_mul_f32 v125, v125, v216
    v_mul_f32 v126, v126, v216
    v_mfma_f32_16x16x16_bf16 v[144:147], v[174:175], v[164:165], v[44:47]
    v_mul_f32 v127, v127, v216
    v_fmac_f32 v128, v62, v222
    v_fmac_f32 v129, v62, v223
    v_max3_f32 v198, v96, v97, v98
    v_max_f32 v198, v198, v99
    v_max_f32 v108, v108, v112
    v_max_f32 v109, v109, v113
    v_max_f32 v110, v110, v114
    v_max_f32 v111, v111, v115
    v_max3_f32 v208, v108, v109, v110
    v_max_f32 v208, v208, v111
    v_max_f32 v144, v144, v148
    v_max_f32 v145, v145, v149
    v_max_f32 v146, v146, v150
    v_max_f32 v147, v147, v151
    v_max3_f32 v238, v144, v145, v146
    v_max_f32 v238, v238, v147
    v_mov_b32 v239, v238
    v_permlane16_swap_b32 v198, v208
    s_nop 0
    v_permlane16_swap_b32 v238, v239
    v_max_f32 v198, v198, v208
    v_mov_b32 v208, v198
    v_max_f32 v238, v238, v239
    v_mov_b32 v239, v238
    v_permlane32_swap_b32 v198, v208
    s_nop 0
    v_permlane32_swap_b32 v238, v239
    v_max_f32 v198, v198, v208
    v_mov_b32 v208, v198
    v_max_f32 v238, v238, v239
    s_nop 0
    v_permlane16_swap_b32 v198, v208
    v_mul_f32 v237, v236, v238
    v_pk_fma_f32 v[144:145], v[144:145], v[236:237], v[236:237] op_sel:[0,0,1] op_sel_hi:[1,0,1] neg_lo:[0,0,1] neg_hi:[0,0,1]
    v_pk_fma_f32 v[146:147], v[146:147], v[236:237], v[236:237] op_sel:[0,0,1] op_sel_hi:[1,0,1] neg_lo:[0,0,1] neg_hi:[0,0,1]
    v_exp_f32 v144, v144
    v_exp_f32 v145, v145
    v_exp_f32 v146, v146
    v_exp_f32 v147, v147
    v_mul_f32 v197, v196, v198
    v_pk_fma_f32 v[96:97], v[96:97], v[196:197], v[196:197] op_sel:[0,0,1] op_sel_hi:[1,0,1] neg_lo:[0,0,1] neg_hi:[0,0,1]
    v_pk_fma_f32 v[98:99], v[98:99], v[196:197], v[196:197] op_sel:[0,0,1] op_sel_hi:[1,0,1] neg_lo:[0,0,1] neg_hi:[0,0,1]
    v_exp_f32 v96, v96
    v_exp_f32 v97, v97
    v_exp_f32 v98, v98
    v_exp_f32 v99, v99
    v_mul_f32 v207, v206, v208
    v_pk_fma_f32 v[108:109], v[108:109], v[206:207], v[206:207] op_sel:[0,0,1] op_sel_hi:[1,0,1] neg_lo:[0,0,1] neg_hi:[0,0,1]
    v_pk_fma_f32 v[110:111], v[110:111], v[206:207], v[206:207] op_sel:[0,0,1] op_sel_hi:[1,0,1] neg_lo:[0,0,1] neg_hi:[0,0,1]
    v_exp_f32 v108, v108
    v_exp_f32 v109, v109
    v_exp_f32 v110, v110
    v_exp_f32 v111, v111
    v_cvt_pk_bf16_f32 v240, v144, v145
    v_cvt_pk_bf16_f32 v241, v146, v147
    v_and_b32 v154, v52, v240
    v_and_b32 v155, v53, v241
    v_mfma_f32_16x16x16_bf16 v[148:151], v[28:29], v[240:241], 0
    v_xor_b32 v152, v154, v240
    v_xor_b32 v153, v155, v241
    s_nop 1
    v_mfma_f32_16x16x32_bf16 v[144:147], v[182:185], v[152:155], 0
    v_cvt_pk_bf16_f32 v200, v96, v97
    v_cvt_pk_bf16_f32 v201, v98, v99
    s_nop 1
    v_mfma_f32_16x16x16_bf16 v[100:103], v[28:29], v[200:201], 0
    v_mfma_f32_16x16x16_bf16 v[96:99], v[176:177], v[200:201], 0
    v_cvt_pk_bf16_f32 v210, v108, v109
    v_cvt_pk_bf16_f32 v211, v110, v111
    v_and_b32 v118, v52, v210
    v_and_b32 v119, v53, v211
    v_mfma_f32_16x16x16_bf16 v[112:115], v[28:29], v[210:211], 0
    v_xor_b32 v116, v118, v210
    v_xor_b32 v117, v119, v211
    s_nop 1
    v_mfma_f32_16x16x32_bf16 v[108:111], v[176:179], v[116:119], 0
    s_waitcnt vmcnt(4)
    v_subrev_u32 v252, s72, v250
    v_cmp_lt_u32 vcc, 15, v252
    s_cbranch_vccnz Lslow_8
Lback_9:
    v_cmp_ne_u32 vcc, s5, v250
    s_nop 0
    s_and_b32 s71, vcc_lo, 0xff00
    s_cbranch_scc1 L_safeclr
L_safeclr_done:
    v_rcp_f32 v148, v148
    v_rcp_f32 v100, v100
    v_rcp_f32 v112, v112
    v_pk_mul_f32 v[144:145], v[144:145], v[148:149] op_sel_hi:[1,0]
    v_pk_mul_f32 v[146:147], v[146:147], v[148:149] op_sel_hi:[1,0]
    v_cvt_pk_bf16_f32 v152, v144, v145
    v_cvt_pk_bf16_f32 v153, v146, v147
    s_add_u32 s18, s23, 1114112
    v_permlane16_swap_b32 v152, v154
    v_permlane16_swap_b32 v153, v155
    v_min_u32 v152, -2, v152
    s_cmp_lg_u32 s71, 0
    s_cbranch_scc1 Lwt_11
    buffer_store_dwordx4 v[152:155], v25, s[52:55], s18 offen
Lst_12:
    v_pk_mul_f32 v[96:97], v[96:97], v[100:101] op_sel_hi:[1,0]
    v_pk_mul_f32 v[98:99], v[98:99], v[100:101] op_sel_hi:[1,0]
    v_cvt_pk_bf16_f32 v104, v96, v97
    v_cvt_pk_bf16_f32 v105, v98, v99
    v_pk_mul_f32 v[108:109], v[108:109], v[112:113] op_sel_hi:[1,0]
    v_pk_mul_f32 v[110:111], v[110:111], v[112:113] op_sel_hi:[1,0]
    v_cvt_pk_bf16_f32 v106, v108, v109
    v_cvt_pk_bf16_f32 v107, v110, v111
    s_add_u32 s18, s23, 1048576
    v_permlane16_swap_b32 v104, v106
    v_permlane16_swap_b32 v105, v107
    v_min_u32 v104, -2, v104
    s_cmp_lg_u32 s71, 0
    s_cbranch_scc1 Lwt_13
    buffer_store_dwordx4 v[104:107], v24, s[52:55], s18 offen
Lst_14:
    v_fmac_f32 v130, v62, v224
    v_fmac_f32 v131, v62, v225
    v_mul_f32 v128, v128, v218
    v_mul_f32 v129, v129, v219
    v_mul_f32 v130, v130, v220
    v_mul_f32 v131, v131, v221
    v_cvt_pk_bf16_f32 v160, v120, v121
    v_cvt_pk_bf16_f32 v161, v122, v123
    v_cvt_pk_bf16_f32 v170, v124, v125
    v_cvt_pk_bf16_f32 v171, v126, v127
    v_cvt_pk_bf16_f32 v180, v128, v129
    v_cvt_pk_bf16_f32 v181, v130, v131
    v_mul_f32 v216, 0x3eb8aa3b, v216
    s_waitcnt vmcnt(12)
    v_mfma_f32_16x16x16_bf16 v[124:127], v[168:169], v[160:161], v[40:43]
    v_add_u32 v186, 0, v65
    v_xor_b32 v187, 32, v186
    v_xor_b32 v188, 64, v186
    v_xor_b32 v189, 96, v186
    ds_read_b64_tr_b16 a[224:225], v186 offset:0
    ds_read_b64_tr_b16 a[226:227], v186 offset:512
    v_mfma_f32_16x16x16_bf16 v[120:123], v[170:171], v[160:161], v[36:39]
    ds_read_b64_tr_b16 a[228:229], v187 offset:0
    ds_read_b64_tr_b16 a[230:231], v187 offset:512
    ds_read_b64_tr_b16 a[232:233], v188 offset:0
    ds_read_b64_tr_b16 a[234:235], v188 offset:512
    ds_read_b64_tr_b16 a[236:237], v189 offset:0
    v_mfma_f32_16x16x16_bf16 v[136:139], v[170:171], v[162:163], v[40:43]
    ds_read_b64_tr_b16 a[238:239], v189 offset:512
    ds_read_b64_tr_b16 a[240:241], v186 offset:16384
    ds_read_b64_tr_b16 a[242:243], v186 offset:16896
    s_waitcnt lgkmcnt(6)
    ds_read_b64_tr_b16 a[244:245], v187 offset:16384
    v_mfma_f32_16x16x16_bf16 v[132:135], v[172:173], v[162:163], v[36:39]
    ds_read_b64_tr_b16 a[246:247], v187 offset:16896
    ds_read_b64_tr_b16 a[248:249], v188 offset:16384
    ds_read_b64_tr_b16 a[250:251], v188 offset:16896
    ds_read_b64_tr_b16 a[252:253], v189 offset:16384
    ds_read_b64_tr_b16 a[254:255], v189 offset:16896
    v_max_f32 v120, v120, v124
    v_max_f32 v121, v121, v125
    v_max_f32 v122, v122, v126
    v_max_f32 v123, v123, v127
    v_max3_f32 v218, v120, v121, v122
    v_max_f32 v218, v218, v123
    v_max_f32 v132, v132, v136
    v_max_f32 v133, v133, v137
    v_max_f32 v134, v134, v138
    v_max_f32 v135, v135, v139
    v_max3_f32 v228, v132, v133, v134
    v_max_f32 v228, v228, v135
    s_nop 1
    v_permlane16_swap_b32 v218, v228
    v_max_f32 v218, v218, v228
    v_mov_b32 v228, v218
    s_nop 1
    v_permlane32_swap_b32 v218, v228
    v_max_f32 v218, v218, v228
    v_mov_b32 v228, v218
    s_nop 1
    v_permlane16_swap_b32 v218, v228
    v_mul_f32 v217, v216, v218
    v_pk_fma_f32 v[120:121], v[120:121], v[216:217], v[216:217] op_sel:[0,0,1] op_sel_hi:[1,0,1] neg_lo:[0,0,1] neg_hi:[0,0,1]
    v_pk_fma_f32 v[122:123], v[122:123], v[216:217], v[216:217] op_sel:[0,0,1] op_sel_hi:[1,0,1] neg_lo:[0,0,1] neg_hi:[0,0,1]
    v_exp_f32 v120, v120
    v_exp_f32 v121, v121
    v_exp_f32 v122, v122
    v_exp_f32 v123, v123
    v_mul_f32 v227, v226, v228
    v_pk_fma_f32 v[132:133], v[132:133], v[226:227], v[226:227] op_sel:[0,0,1] op_sel_hi:[1,0,1] neg_lo:[0,0,1] neg_hi:[0,0,1]
    v_pk_fma_f32 v[134:135], v[134:135], v[226:227], v[226:227] op_sel:[0,0,1] op_sel_hi:[1,0,1] neg_lo:[0,0,1] neg_hi:[0,0,1]
    v_exp_f32 v132, v132
    v_exp_f32 v133, v133
    v_exp_f32 v134, v134
    v_exp_f32 v135, v135
    v_cvt_pk_bf16_f32 v220, v120, v121
    v_cvt_pk_bf16_f32 v221, v122, v123
    v_and_b32 v130, v52, v220
    v_and_b32 v131, v53, v221
    v_mfma_f32_16x16x16_bf16 v[124:127], v[28:29], v[220:221], 0
    v_xor_b32 v128, v130, v220
    v_xor_b32 v129, v131, v221
    s_nop 1
    v_mfma_f32_16x16x32_bf16 v[120:123], v[178:181], v[128:131], 0
    v_cvt_pk_bf16_f32 v230, v132, v133
    s_add_u32 s24, s23, 1114112
    v_cvt_pk_bf16_f32 v231, v134, v135
    v_and_b32 v142, v52, v230
    v_and_b32 v143, v53, v231
    buffer_load_dwordx4 v[96:99], v20, s[52:55], s24 offen offset:0 sc1
    v_mfma_f32_16x16x16_bf16 v[136:139], v[28:29], v[230:231], 0
    v_xor_b32 v140, v142, v230
    v_xor_b32 v141, v143, v231
    buffer_load_dwordx4 v[100:103], v20, s[52:55], s24 offen offset:1024 sc1
    s_nop 0
    v_mfma_f32_16x16x32_bf16 v[132:135], v[180:183], v[140:143], 0
    v_rcp_f32 v124, v124
    buffer_load_dwordx4 v[104:107], v20, s[52:55], s24 offen offset:2048 sc1
    s_nop 0
    v_rcp_f32 v136, v136
    s_waitcnt vmcnt(6)
    v_add_u32 v186, 81920, v65
    buffer_load_dwordx4 v[108:111], v20, s[52:55], s24 offen offset:3072 sc1
    v_xor_b32 v187, 32, v186
    v_xor_b32 v188, 64, v186
    v_xor_b32 v189, 96, v186
    s_add_u32 s24, s23, 1048576
    ds_read_b64_tr_b16 a[192:193], v186 offset:49152
    ds_read_b64_tr_b16 a[194:195], v186 offset:49664
    ds_read_b64_tr_b16 a[196:197], v187 offset:49152
    buffer_load_dwordx4 v[112:115], v20, s[52:55], s24 offen offset:0 sc1
    ds_read_b64_tr_b16 a[198:199], v187 offset:49664
    ds_read_b64_tr_b16 a[200:201], v188 offset:49152
    ds_read_b64_tr_b16 a[202:203], v188 offset:49664
    buffer_load_dwordx4 v[116:119], v20, s[52:55], s24 offen offset:1024 sc1
    ds_read_b64_tr_b16 a[204:205], v189 offset:49152
    ds_read_b64_tr_b16 a[206:207], v189 offset:49664
    ds_read_b64_tr_b16 a[208:209], v186 offset:0
    buffer_load_dwordx4 v[144:147], v20, s[52:55], s24 offen offset:2048 sc1
    ds_read_b64_tr_b16 a[210:211], v186 offset:512
    s_waitcnt lgkmcnt(6)
    ds_read_b64_tr_b16 a[212:213], v187 offset:0
    buffer_load_dwordx4 v[148:151], v20, s[52:55], s24 offen offset:3072 sc1
    ds_read_b64_tr_b16 a[214:215], v187 offset:512
    ds_read_b64_tr_b16 a[216:217], v188 offset:0
    ds_read_b64_tr_b16 a[218:219], v188 offset:512
    s_add_u32 s24, s23, 1064960
    ds_read_b64_tr_b16 a[220:221], v189 offset:0
    ds_read_b64_tr_b16 a[222:223], v189 offset:512
    v_pk_mul_f32 v[120:121], v[120:121], v[124:125] op_sel_hi:[1,0]
    buffer_load_dwordx4 v[152:155], v20, s[52:55], s24 offen offset:0 sc1
    v_pk_mul_f32 v[122:123], v[122:123], v[124:125] op_sel_hi:[1,0]
    v_cvt_pk_bf16_f32 v128, v120, v121
    v_cvt_pk_bf16_f32 v129, v122, v123
    buffer_load_dwordx4 v[196:199], v20, s[52:55], s24 offen offset:1024 sc1
    v_pk_mul_f32 v[132:133], v[132:133], v[136:137] op_sel_hi:[1,0]
    v_pk_mul_f32 v[134:135], v[134:135], v[136:137] op_sel_hi:[1,0]
    v_cvt_pk_bf16_f32 v130, v132, v133
    buffer_load_dwordx4 v[200:203], v20, s[52:55], s24 offen offset:2048 sc1
    v_cvt_pk_bf16_f32 v131, v134, v135
    s_add_u32 s18, s23, 1081344
    v_permlane16_swap_b32 v128, v130
    buffer_load_dwordx4 v[190:193], v20, s[52:55], s24 offen offset:3072 sc1
    v_permlane16_swap_b32 v129, v131
    v_min_u32 v128, -2, v128
    s_cmp_lg_u32 s71, 0
    s_cbranch_scc1 Lwt_15
    buffer_store_dwordx4 v[128:131], v24, s[52:55], s18 offen
Lst_16:
    v_lshlrev_b32 v236, 16, v74
    v_and_b32 v237, 0xffff0000, v74
    v_lshlrev_b32 v238, 16, v75
    v_and_b32 v239, 0xffff0000, v75
    v_xor_b32 v12, 4096, v20
    v_xor_b32 v13, 8192, v20
    v_xor_b32 v14, 12288, v20
    s_waitcnt lgkmcnt(0)
    s_barrier
    s_waitcnt vmcnt(9)
    v_max3_u32 v252, v96, v100, v104
    v_max_u32 v252, v252, v108
    v_cmp_eq_u32 vcc, -1, v252
    s_cbranch_vccnz Lslow_17
Lback_18:
    v_mfma_f32_16x16x32_bf16 v[204:207], a[196:199], v[96:99], 0
    v_lshlrev_b32 v240, 16, v66
    v_and_b32 v241, 0xffff0000, v66
    v_mfma_f32_16x16x32_bf16 v[204:207], a[212:215], v[100:103], v[204:207]
    v_lshlrev_b32 v242, 16, v67
    v_and_b32 v243, 0xffff0000, v67
    s_add_u32 s34, s84, s23
    v_mfma_f32_16x16x32_bf16 v[204:207], a[228:231], v[104:107], v[204:207]
    s_add_u32 s35, s89, s23
    s_mul_i32 s32, s8, 1280
    s_add_u32 s32, s32, 147456
    v_mfma_f32_16x16x32_bf16 v[204:207], a[244:247], v[108:111], v[204:207]
    s_mul_i32 s33, s6, 1280
    s_add_u32 s33, s33, 65536
    v_mfma_f32_16x16x32_bf16 v[208:211], a[200:203], v[96:99], 0
    v_and_b32 v253, 31, v2
    v_cmp_gt_u32 vcc, s15, v253
    v_mov_b32 v253, 1073741824
    v_mfma_f32_16x16x32_bf16 v[208:211], a[216:219], v[100:103], v[208:211]
    v_cndmask_b32 v26, v24, v253, vcc
    v_lshlrev_b32 v16, 4, v0
    v_mfma_f32_16x16x32_bf16 v[208:211], a[232:235], v[104:107], v[208:211]
    v_or_b32 v16, s26, v16
    v_cmp_gt_u32 vcc, s15, v3
    v_add_u32 v253, 2457600, v20
    ds_write_b128 v12, v[204:207] offset:1024
    v_mfma_f32_16x16x32_bf16 v[208:211], a[248:251], v[108:111], v[208:211]
    v_cndmask_b32 v10, v20, v253, vcc
    v_cmp_gt_u32 vcc, s15, v2
    v_add_u32 v253, 65424, v17
    v_mfma_f32_16x16x32_bf16 v[212:215], a[204:207], v[96:99], 0
    v_cndmask_b32 v15, v17, v253, vcc
    v_lshlrev_b32 v244, 16, v68
    v_mfma_f32_16x16x32_bf16 v[212:215], a[220:223], v[100:103], v[212:215]
    v_and_b32 v245, 0xffff0000, v68
    v_lshlrev_b32 v246, 16, v69
    v_mfma_f32_16x16x32_bf16 v[212:215], a[236:239], v[104:107], v[212:215]
    v_and_b32 v247, 0xffff0000, v69
    v_bfe_u32 v253, v0, 3, 4
    v_subrev_u32 v253, s9, v253
    ds_write_b128 v13, v[208:211] offset:2048
    v_mfma_f32_16x16x32_bf16 v[212:215], a[252:255], v[108:111], v[212:215]
    v_and_b32 v253, 15, v253
    v_lshlrev_b32 v11, 10, v253
    v_mfma_f32_16x16x32_bf16 v[236:239], a[192:195], v[96:99], v[236:239]
    v_bfe_u32 v253, v0, 1, 2
    v_lshl_add_u32 v11, v253, 8, v11
    v_mfma_f32_16x16x32_bf16 v[236:239], a[208:211], v[100:103], v[236:239]
    v_and_b32 v253, 1, v0
    v_lshl_add_u32 v11, v253, 3, v11
    v_add_u32 v11, 49152, v11
    v_mfma_f32_16x16x32_bf16 v[236:239], a[224:227], v[104:107], v[236:239]
    s_waitcnt vmcnt(5)
    v_max3_u32 v252, v112, v116, v144
    ds_write_b128 v14, v[212:215] offset:3072
    v_mfma_f32_16x16x32_bf16 v[236:239], a[240:243], v[108:111], v[236:239]
    v_max_u32 v252, v252, v148
    v_cmp_eq_u32 vcc, -1, v252
    s_cbranch_vccnz Lslow_20
Lback_21:
    v_mfma_f32_16x16x32_bf16 v[204:207], a[196:199], v[112:115], 0
    v_lshlrev_b32 v248, 16, v70
    v_mfma_f32_16x16x32_bf16 v[204:207], a[212:215], v[116:119], v[204:207]
    v_and_b32 v249, 0xffff0000, v70
    v_mfma_f32_16x16x32_bf16 v[204:207], a[228:231], v[144:147], v[204:207]
    v_lshlrev_b32 v250, 16, v71
    v_mfma_f32_16x16x32_bf16 v[204:207], a[244:247], v[148:151], v[204:207]
    v_and_b32 v251, 0xffff0000, v71
    v_lshlrev_b32 v140, 16, v72
    v_mfma_f32_16x16x32_bf16 v[208:211], a[200:203], v[112:115], 0
    v_and_b32 v141, 0xffff0000, v72
    v_mfma_f32_16x16x32_bf16 v[208:211], a[216:219], v[116:119], v[208:211]
    v_lshlrev_b32 v142, 16, v73
    v_mfma_f32_16x16x32_bf16 v[208:211], a[232:235], v[144:147], v[208:211]
    v_and_b32 v143, 0xffff0000, v73
    ds_write_b128 v12, v[204:207] offset:17408
    v_mfma_f32_16x16x32_bf16 v[208:211], a[248:251], v[148:151], v[208:211]
    s_add_u32 s24, s23, 1081344
    v_mfma_f32_16x16x32_bf16 v[212:215], a[204:207], v[112:115], 0
    buffer_load_dwordx4 v[120:123], v20, s[52:55], s24 offen offset:0 sc1
    v_mfma_f32_16x16x32_bf16 v[212:215], a[220:223], v[116:119], v[212:215]
    buffer_load_dwordx4 v[124:127], v20, s[52:55], s24 offen offset:1024 sc1
    v_mfma_f32_16x16x32_bf16 v[212:215], a[236:239], v[144:147], v[212:215]
    buffer_load_dwordx4 v[128:131], v20, s[52:55], s24 offen offset:2048 sc1
    s_nop 0
    ds_write_b128 v13, v[208:211] offset:18432
    v_mfma_f32_16x16x32_bf16 v[212:215], a[252:255], v[148:151], v[212:215]
    buffer_load_dwordx4 v[132:135], v20, s[52:55], s24 offen offset:3072 sc1
    v_mfma_f32_16x16x32_bf16 v[240:243], a[192:195], v[112:115], v[240:243]
    s_waitcnt vmcnt(5)
    v_mfma_f32_16x16x32_bf16 v[240:243], a[208:211], v[116:119], v[240:243]
    v_max3_u32 v252, v152, v196, v200
    v_mfma_f32_16x16x32_bf16 v[240:243], a[224:227], v[144:147], v[240:243]
    v_max_u32 v252, v252, v190
    v_cmp_eq_u32 vcc, -1, v252
    ds_write_b128 v14, v[212:215] offset:19456
    v_mfma_f32_16x16x32_bf16 v[240:243], a[240:243], v[148:151], v[240:243]
    s_cbranch_vccnz Lslow_23
Lback_24:
    v_mfma_f32_16x16x32_bf16 v[204:207], a[196:199], v[152:155], 0
    s_add_u32 s24, s23, 1097728
    buffer_load_dwordx4 v[156:159], v20, s[52:55], s24 offen offset:0 sc1
    buffer_load_dwordx4 v[160:163], v20, s[52:55], s24 offen offset:1024 sc1
    v_mfma_f32_16x16x32_bf16 v[204:207], a[212:215], v[196:199], v[204:207]
    buffer_load_dwordx4 v[164:167], v20, s[52:55], s24 offen offset:2048 sc1
    buffer_load_dwordx4 v[168:171], v20, s[52:55], s24 offen offset:3072 sc1
    v_mfma_f32_16x16x32_bf16 v[204:207], a[228:231], v[200:203], v[204:207]
    v_mfma_f32_16x16x32_bf16 v[204:207], a[244:247], v[190:193], v[204:207]
    s_waitcnt lgkmcnt(0)
    s_barrier
    v_mfma_f32_16x16x32_bf16 v[208:211], a[200:203], v[152:155], 0
    ds_read_b128 v[172:175], v20 offset:1024
    ds_read_b128 v[176:179], v20 offset:2048
    ds_read_b128 v[180:183], v20 offset:3072
    v_mfma_f32_16x16x32_bf16 v[208:211], a[216:219], v[196:199], v[208:211]
    ds_read_b128 v[216:219], v20 offset:17408
    ds_read_b128 v[220:223], v20 offset:18432
    v_mfma_f32_16x16x32_bf16 v[208:211], a[232:235], v[200:203], v[208:211]
    ds_read_b128 v[224:227], v20 offset:19456
    s_waitcnt lgkmcnt(3)
    v_add_f32 v236, v236, v172
    v_add_f32 v237, v237, v173
    ds_write_b128 v12, v[204:207] offset:33792
    v_mfma_f32_16x16x32_bf16 v[208:211], a[248:251], v[190:193], v[208:211]
    v_add_f32 v238, v238, v174
    v_add_f32 v239, v239, v175
    v_add_f32 v176, v176, v180
    v_mfma_f32_16x16x32_bf16 v[212:215], a[204:207], v[152:155], 0
    v_add_f32 v177, v177, v181
    v_add_f32 v178, v178, v182
    v_add_f32 v179, v179, v183
    v_add_f32 v236, v236, v176
    v_mfma_f32_16x16x32_bf16 v[212:215], a[220:223], v[196:199], v[212:215]
    v_add_f32 v237, v237, v177
    v_add_f32 v238, v238, v178
    v_add_f32 v239, v239, v179
    v_mfma_f32_16x16x32_bf16 v[212:215], a[236:239], v[200:203], v[212:215]
    v_cvt_pk_bf16_f32 v236, v236, v237
    v_cvt_pk_bf16_f32 v237, v238, v239
    v_mov_b32 v74, v236
    ds_write_b128 v13, v[208:211] offset:34816
    v_mfma_f32_16x16x32_bf16 v[212:215], a[252:255], v[190:193], v[212:215]
    v_mov_b32 v75, v237
    s_add_u32 s18, s23, 3571712
    v_permlane16_swap_b32 v236, v238
    v_mfma_f32_16x16x32_bf16 v[244:247], a[192:195], v[152:155], v[244:247]
    v_permlane16_swap_b32 v237, v239
    v_min_u32 v236, -2, v236
    v_mfma_f32_16x16x32_bf16 v[244:247], a[208:211], v[196:199], v[244:247]
    s_cmp_lg_u32 s71, 0
    s_cbranch_scc1 Lwt_26
    buffer_store_dwordx4 v[236:239], v25, s[52:55], s18 offen
Lst_27:
    s_add_u32 s18, s23, 6045696
    v_mfma_f32_16x16x32_bf16 v[244:247], a[224:227], v[200:203], v[244:247]
    buffer_store_dwordx4 v[236:239], v27, s[52:55], s18 offen sc1
    s_waitcnt vmcnt(6)
    v_max3_u32 v252, v120, v124, v128
    ds_write_b128 v14, v[212:215] offset:35840
    v_mfma_f32_16x16x32_bf16 v[244:247], a[240:243], v[190:193], v[244:247]
    v_max_u32 v252, v252, v132
    v_cmp_eq_u32 vcc, -1, v252
    s_cbranch_vccnz Lslow_28
Lback_29:
    v_mfma_f32_16x16x32_bf16 v[204:207], a[196:199], v[120:123], 0
    s_waitcnt lgkmcnt(3)
    v_add_f32 v240, v240, v216
    v_mfma_f32_16x16x32_bf16 v[204:207], a[212:215], v[124:127], v[204:207]
    v_add_f32 v241, v241, v217
    v_add_f32 v242, v242, v218
    v_mfma_f32_16x16x32_bf16 v[204:207], a[228:231], v[128:131], v[204:207]
    v_add_f32 v243, v243, v219
    v_add_f32 v220, v220, v224
    v_mfma_f32_16x16x32_bf16 v[204:207], a[244:247], v[132:135], v[204:207]
    v_add_f32 v221, v221, v225
    v_add_f32 v222, v222, v226
    v_mfma_f32_16x16x32_bf16 v[208:211], a[200:203], v[120:123], 0
    v_add_f32 v223, v223, v227
    v_add_f32 v240, v240, v220
    v_mfma_f32_16x16x32_bf16 v[208:211], a[216:219], v[124:127], v[208:211]
    v_add_f32 v241, v241, v221
    v_add_f32 v242, v242, v222
    v_mfma_f32_16x16x32_bf16 v[208:211], a[232:235], v[128:131], v[208:211]
    v_add_f32 v243, v243, v223
    v_cvt_pk_bf16_f32 v240, v240, v241
    ds_write_b128 v12, v[204:207] offset:50176
    v_mfma_f32_16x16x32_bf16 v[208:211], a[248:251], v[132:135], v[208:211]
    v_cvt_pk_bf16_f32 v241, v242, v243
    v_mov_b32 v66, v240
    v_mfma_f32_16x16x32_bf16 v[212:215], a[204:207], v[120:123], 0
    v_mov_b32 v67, v241
    s_add_u32 s18, s23, 3506176
    v_mfma_f32_16x16x32_bf16 v[212:215], a[220:223], v[124:127], v[212:215]
    v_permlane16_swap_b32 v240, v242
    v_mfma_f32_16x16x32_bf16 v[212:215], a[236:239], v[128:131], v[212:215]
    v_permlane16_swap_b32 v241, v243
    ds_write_b128 v13, v[208:211] offset:51200
    v_mfma_f32_16x16x32_bf16 v[212:215], a[252:255], v[132:135], v[212:215]
    v_min_u32 v240, -2, v240
    v_mfma_f32_16x16x32_bf16 v[248:251], a[192:195], v[120:123], v[248:251]
    s_cmp_lg_u32 s71, 0
    s_cbranch_scc1 Lwt_31
    buffer_store_dwordx4 v[240:243], v25, s[52:55], s18 offen
Lst_32:
    v_mfma_f32_16x16x32_bf16 v[248:251], a[208:211], v[124:127], v[248:251]
    s_waitcnt vmcnt(3)
    v_mfma_f32_16x16x32_bf16 v[248:251], a[224:227], v[128:131], v[248:251]
    v_max3_u32 v252, v156, v160, v164
    v_max_u32 v252, v252, v168
    ds_write_b128 v14, v[212:215] offset:52224
    v_mfma_f32_16x16x32_bf16 v[248:251], a[240:243], v[132:135], v[248:251]
    v_cmp_eq_u32 vcc, -1, v252
    s_cbranch_vccnz Lslow_33
Lback_34:
    v_mfma_f32_16x16x32_bf16 v[204:207], a[196:199], v[156:159], 0
    s_add_u32 m0, s88, 65536
    s_add_u32 s24, s34, 3571712
    s_add_u32 s25, s35, 3571712
    v_mfma_f32_16x16x32_bf16 v[204:207], a[212:215], v[160:163], v[204:207]
    buffer_load_dwordx4 v20, s[52:55], s24 offen offset:0 sc1 lds
    buffer_load_dwordx4 v20, s[52:55], s24 offen offset:1024 sc1 lds
    v_mfma_f32_16x16x32_bf16 v[204:207], a[228:231], v[164:167], v[204:207]
    buffer_load_dwordx4 v20, s[52:55], s25 offen offset:2048 sc1 lds
    buffer_load_dwordx4 v20, s[52:55], s25 offen offset:3072 sc1 lds
    v_mfma_f32_16x16x32_bf16 v[204:207], a[244:247], v[168:171], v[204:207]
    s_waitcnt lgkmcnt(0)
    s_barrier
    ds_read_b128 v[96:99], v20 offset:33792
    v_mfma_f32_16x16x32_bf16 v[208:211], a[200:203], v[156:159], 0
    ds_read_b128 v[100:103], v20 offset:34816
    ds_read_b128 v[104:107], v20 offset:35840
    v_mfma_f32_16x16x32_bf16 v[208:211], a[216:219], v[160:163], v[208:211]
    ds_read_b128 v[172:175], v20 offset:50176
    ds_read_b128 v[176:179], v20 offset:51200
    v_mfma_f32_16x16x32_bf16 v[208:211], a[232:235], v[164:167], v[208:211]
    ds_read_b128 v[180:183], v20 offset:52224
    s_waitcnt lgkmcnt(3)
    v_add_f32 v244, v244, v96
    ds_write_b128 v12, v[204:207] offset:0
    v_mfma_f32_16x16x32_bf16 v[208:211], a[248:251], v[168:171], v[208:211]
    v_add_f32 v245, v245, v97
    v_add_f32 v246, v246, v98
    v_mfma_f32_16x16x32_bf16 v[212:215], a[204:207], v[156:159], 0
    v_add_f32 v247, v247, v99
    v_add_f32 v100, v100, v104
    v_add_f32 v101, v101, v105
    v_mfma_f32_16x16x32_bf16 v[212:215], a[220:223], v[160:163], v[212:215]
    v_add_f32 v102, v102, v106
    v_add_f32 v103, v103, v107
    v_add_f32 v244, v244, v100
    v_mfma_f32_16x16x32_bf16 v[212:215], a[236:239], v[164:167], v[212:215]
    v_add_f32 v245, v245, v101
    v_add_f32 v246, v246, v102
    v_add_f32 v247, v247, v103
    ds_write_b128 v13, v[208:211] offset:16384
    v_mfma_f32_16x16x32_bf16 v[212:215], a[252:255], v[168:171], v[212:215]
    v_cvt_pk_bf16_f32 v244, v244, v245
    v_cvt_pk_bf16_f32 v245, v246, v247
    v_mfma_f32_16x16x32_bf16 v[140:143], a[192:195], v[156:159], v[140:143]
    v_mov_b32 v68, v244
    v_mov_b32 v69, v245
    s_add_u32 s18, s23, 3522560
    v_mfma_f32_16x16x32_bf16 v[140:143], a[208:211], v[160:163], v[140:143]
    v_permlane16_swap_b32 v244, v246
    v_mfma_f32_16x16x32_bf16 v[140:143], a[224:227], v[164:167], v[140:143]
    v_permlane16_swap_b32 v245, v247
    v_min_u32 v244, -2, v244
    ds_write_b128 v14, v[212:215] offset:32768
    v_mfma_f32_16x16x32_bf16 v[140:143], a[240:243], v[168:171], v[140:143]
    s_cmp_lg_u32 s71, 0
    s_cbranch_scc1 Lwt_36
    buffer_store_dwordx4 v[244:247], v25, s[52:55], s18 offen
Lst_37:
    s_waitcnt lgkmcnt(3)
    v_pk_add_f32 v[248:249], v[248:249], v[172:173]
    v_pk_add_f32 v[250:251], v[250:251], v[174:175]
    v_pk_add_f32 v[176:177], v[176:177], v[180:181]
    v_pk_add_f32 v[178:179], v[178:179], v[182:183]
    v_pk_add_f32 v[248:249], v[248:249], v[176:177]
    v_pk_add_f32 v[250:251], v[250:251], v[178:179]
    v_cvt_pk_bf16_f32 v248, v248, v249
    v_cvt_pk_bf16_f32 v249, v250, v251
    s_waitcnt lgkmcnt(0)
    s_barrier
    ds_read_b128 v[216:219], v20 offset:0
    ds_read_b128 v[220:223], v20 offset:16384
    ds_read_b128 v[224:227], v20 offset:32768
    v_mov_b32 v70, v248
    v_mov_b32 v71, v249
    s_add_u32 s18, s23, 3538944
    v_permlane16_swap_b32 v248, v250
    v_permlane16_swap_b32 v249, v251
    v_min_u32 v248, -2, v248
    s_cmp_lg_u32 s71, 0
    s_cbranch_scc1 Lwt_38
    buffer_store_dwordx4 v[248:251], v25, s[52:55], s18 offen
Lst_39:
    s_waitcnt lgkmcnt(0)
    v_pk_add_f32 v[140:141], v[140:141], v[216:217]
    v_pk_add_f32 v[142:143], v[142:143], v[218:219]
    v_pk_add_f32 v[220:221], v[220:221], v[224:225]
    v_pk_add_f32 v[222:223], v[222:223], v[226:227]
    v_pk_add_f32 v[140:141], v[140:141], v[220:221]
    v_pk_add_f32 v[142:143], v[142:143], v[222:223]
    v_cvt_pk_bf16_f32 v140, v140, v141
    v_cvt_pk_bf16_f32 v141, v142, v143
    v_mov_b32 v72, v140
    v_mov_b32 v73, v141
    s_add_u32 s18, s23, 3555328
    v_permlane16_swap_b32 v140, v142
    v_permlane16_swap_b32 v141, v143
    v_min_u32 v140, -2, v140
    s_cmp_lg_u32 s71, 0
    s_cbranch_scc1 Lwt_40
    buffer_store_dwordx4 v[140:143], v25, s[52:55], s18 offen
Lst_41:
    s_waitcnt vmcnt(3)
    ds_read2st64_b32 v[228:229], v21 offset0:0 offset1:4
    ds_read2st64_b32 v[230:231], v21 offset0:8 offset1:12
    s_waitcnt lgkmcnt(0)
    v_max3_u32 v228, v228, v229, v230
    v_max_u32 v228, v228, v231
    v_cmp_eq_u32 vcc, -1, v228
    s_cbranch_vccnz Lslow_42
Lback_43:
    s_barrier
    ds_read_b128 v[156:159], v18 offset:0
    ds_read_b128 v[160:163], v18 offset:1024
    ds_read_b128 v[164:167], v18 offset:2048
    ds_read_b128 v[168:171], v18 offset:3072
    s_waitcnt lgkmcnt(2)
    v_mfma_f32_16x16x32_bf16 v[144:147], a[0:3], v[156:159], 0
    s_add_u32 m0, s88, 49152
    s_add_u32 s24, s28, 3506176
    s_add_u32 s25, s24, s89
    ds_read_b128 v[172:175], v18 offset:4096
    v_mfma_f32_16x16x32_bf16 v[148:151], a[4:7], v[156:159], 0
    s_add_u32 s24, s24, s84
    buffer_load_dwordx4 v20, s[52:55], s24 offen offset:0 sc1 lds
    buffer_load_dwordx4 v20, s[52:55], s24 offen offset:1024 sc1 lds
    v_mfma_f32_16x16x32_bf16 v[152:155], v[156:159], a[8:11], 0
    buffer_load_dwordx4 v20, s[52:55], s25 offen offset:2048 sc1 lds
    buffer_load_dwordx4 v20, s[52:55], s25 offen offset:3072 sc1 lds
    s_add_u32 m0, s88, 98304
    v_mfma_f32_16x16x32_bf16 v[144:147], a[12:15], v[160:163], v[144:147]
    s_add_u32 s24, s34, 3522560
    s_add_u32 s25, s35, 3522560
    buffer_load_dwordx4 v20, s[52:55], s24 offen offset:0 sc1 lds
    ds_read_b128 v[156:159], v18 offset:5120
    v_mfma_f32_16x16x32_bf16 v[148:151], a[16:19], v[160:163], v[148:151]
    buffer_load_dwordx4 v20, s[52:55], s24 offen offset:1024 sc1 lds
    buffer_load_dwordx4 v20, s[52:55], s25 offen offset:2048 sc1 lds
    buffer_load_dwordx4 v20, s[52:55], s25 offen offset:3072 sc1 lds
    v_mfma_f32_16x16x32_bf16 v[152:155], v[160:163], a[20:23], v[152:155]
    s_waitcnt lgkmcnt(2)
    v_mfma_f32_16x16x32_bf16 v[144:147], a[24:27], v[164:167], v[144:147]
    ds_read_b128 v[160:163], v18 offset:6144
    v_mfma_f32_16x16x32_bf16 v[148:151], a[28:31], v[164:167], v[148:151]
    v_mfma_f32_16x16x32_bf16 v[152:155], v[164:167], a[32:35], v[152:155]
    v_mfma_f32_16x16x32_bf16 v[144:147], a[36:39], v[168:171], v[144:147]
    ds_read_b128 v[164:167], v18 offset:7168
    v_mfma_f32_16x16x32_bf16 v[148:151], a[40:43], v[168:171], v[148:151]
    v_mfma_f32_16x16x32_bf16 v[152:155], v[168:171], a[44:47], v[152:155]
    s_waitcnt lgkmcnt(2)
    v_mfma_f32_16x16x32_bf16 v[144:147], a[48:51], v[172:175], v[144:147]
    ds_read_b128 v[168:171], v18 offset:8192
    v_mfma_f32_16x16x32_bf16 v[148:151], a[52:55], v[172:175], v[148:151]
    v_mfma_f32_16x16x32_bf16 v[152:155], v[172:175], a[56:59], v[152:155]
    s_waitcnt vmcnt(4)
    ds_read_b128 v[176:179], v20 offset:49152
    ds_read_b128 v[180:183], v20 offset:50176
    v_mfma_f32_16x16x32_bf16 v[144:147], a[60:63], v[156:159], v[144:147]
    ds_read_b128 v[184:187], v20 offset:51200
    ds_read_b128 v[188:191], v20 offset:52224
    ds_read_b128 v[172:175], v18 offset:9216
    v_mfma_f32_16x16x32_bf16 v[148:151], a[64:67], v[156:159], v[148:151]
    v_mfma_f32_16x16x32_bf16 v[152:155], v[156:159], a[68:71], v[152:155]
    s_waitcnt lgkmcnt(6)
    v_mfma_f32_16x16x32_bf16 v[144:147], a[72:75], v[160:163], v[144:147]
    ds_read_b128 v[156:159], v18 offset:10240
    v_mfma_f32_16x16x32_bf16 v[148:151], a[76:79], v[160:163], v[148:151]
    s_waitcnt lgkmcnt(2)
    v_max3_u32 v252, v176, v180, v184
    v_max_u32 v252, v252, v188
    v_mfma_f32_16x16x32_bf16 v[152:155], v[160:163], a[80:83], v[152:155]
    v_cmp_eq_u32 vcc, -1, v252
    s_cbranch_vccnz Lslow_45
Lback_46:
    v_mfma_f32_16x16x32_bf16 v[204:207], v[176:179], v[176:179], 0
    v_mfma_f32_16x16x32_bf16 v[208:211], v[76:79], v[176:179], 0
    v_mfma_f32_16x16x32_bf16 v[204:207], v[180:183], v[180:183], v[204:207]
    v_mfma_f32_16x16x32_bf16 v[208:211], v[80:83], v[180:183], v[208:211]
    v_mfma_f32_16x16x32_bf16 v[204:207], v[184:187], v[184:187], v[204:207]
    v_mfma_f32_16x16x32_bf16 v[208:211], v[84:87], v[184:187], v[208:211]
    v_mfma_f32_16x16x32_bf16 v[204:207], v[188:191], v[188:191], v[204:207]
    v_mfma_f32_16x16x32_bf16 v[208:211], v[88:91], v[188:191], v[208:211]
    v_lshlrev_b32 v220, 4, v3
    v_add_u32 v220, 155648, v220
    v_mfma_f32_16x16x32_bf16 v[144:147], a[84:87], v[164:167], v[144:147]
    ds_read_b128 v[160:163], v18 offset:11264
    v_mfma_f32_16x16x32_bf16 v[148:151], a[88:91], v[164:167], v[148:151]
    s_nop 1
    v_cndmask_b32 v204, v204, v205, s[66:67]
    v_cndmask_b32 v206, v206, v207, s[66:67]
    v_mov_b32 v211, v92
    v_mfma_f32_16x16x32_bf16 v[152:155], v[164:167], a[92:95], v[152:155]
    v_cndmask_b32 v210, v204, v206, s[68:69]
    s_waitcnt lgkmcnt(2)
    v_mfma_f32_16x16x32_bf16 v[144:147], a[96:99], v[168:171], v[144:147]
    s_mov_b64 exec, s[0:1]
    ds_write_b128 v95, v[208:211]
    s_mov_b64 exec, -1
    ds_read_b128 v[164:167], v18 offset:12288
    v_mfma_f32_16x16x32_bf16 v[148:151], a[100:103], v[168:171], v[148:151]
    s_waitcnt vmcnt(0)
    ds_read2st64_b32 v[228:229], v21 offset0:128 offset1:132
    ds_read2st64_b32 v[230:231], v21 offset0:136 offset1:140
    v_mfma_f32_16x16x32_bf16 v[152:155], v[168:171], a[104:107], v[152:155]
    v_mfma_f32_16x16x32_bf16 v[144:147], a[108:111], v[172:175], v[144:147]
    ds_read_b128 v[168:171], v18 offset:13312
    v_mfma_f32_16x16x32_bf16 v[148:151], a[112:115], v[172:175], v[148:151]
    s_waitcnt lgkmcnt(1)
    v_max3_u32 v228, v228, v229, v230
    v_max_u32 v228, v228, v231
    v_mfma_f32_16x16x32_bf16 v[152:155], v[172:175], a[116:119], v[152:155]
    v_cmp_eq_u32 vcc, -1, v228
    s_cbranch_vccnz Lslow_48
Lback_49:
    s_barrier
    s_waitcnt lgkmcnt(5)
    v_mfma_f32_16x16x32_bf16 v[144:147], a[120:123], v[156:159], v[144:147]
    ds_read_b128 v[204:207], v220
    ds_read_b128 v[208:211], v220 offset:1280
    ds_read_b128 v[172:175], v18 offset:14336
    v_mfma_f32_16x16x32_bf16 v[148:151], a[124:127], v[156:159], v[148:151]
    ds_read_b128 v[212:215], v220 offset:2560
    ds_read_b128 v[216:219], v220 offset:3840
    v_mfma_f32_16x16x32_bf16 v[152:155], v[156:159], a[128:131], v[152:155]
    v_mfma_f32_16x16x32_bf16 v[144:147], a[132:135], v[160:163], v[144:147]
    ds_read_b128 v[156:159], v18 offset:15360
    v_mfma_f32_16x16x32_bf16 v[148:151], a[136:139], v[160:163], v[148:151]
    s_add_u32 m0, s88, 114688
    s_add_u32 s24, s34, 3538944
    s_add_u32 s25, s35, 3538944
    v_mfma_f32_16x16x32_bf16 v[152:155], v[160:163], a[140:143], v[152:155]
    buffer_load_dwordx4 v20, s[52:55], s24 offen offset:0 sc1 lds
    buffer_load_dwordx4 v20, s[52:55], s24 offen offset:1024 sc1 lds
    buffer_load_dwordx4 v20, s[52:55], s25 offen offset:2048 sc1 lds
    s_waitcnt lgkmcnt(6)
    v_mfma_f32_16x16x32_bf16 v[144:147], a[144:147], v[164:167], v[144:147]
    buffer_load_dwordx4 v20, s[52:55], s25 offen offset:3072 sc1 lds
    s_waitcnt lgkmcnt(1)
    ds_read_b128 v[160:163], v18 offset:32768
    v_mfma_f32_16x16x32_bf16 v[148:151], a[148:151], v[164:167], v[148:151]
    v_add_f32 v204, v204, v208
    v_add_f32 v205, v205, v209
    v_add_f32 v206, v206, v210
    v_add_f32 v207, v207, v211
    v_mfma_f32_16x16x32_bf16 v[152:155], v[164:167], a[152:155], v[152:155]
    v_add_f32 v212, v212, v216
    v_add_f32 v213, v213, v217
    v_add_f32 v214, v214, v218
    v_add_f32 v215, v215, v219
    v_mfma_f32_16x16x32_bf16 v[144:147], a[156:159], v[168:171], v[144:147]
    v_add_f32 v204, v204, v212
    v_add_f32 v205, v205, v213
    v_add_f32 v206, v206, v214
    ds_read_b128 v[164:167], v18 offset:33792
    v_mfma_f32_16x16x32_bf16 v[148:151], a[160:163], v[168:171], v[148:151]
    v_add_f32 v207, v207, v215
    v_mul_f32 v208, 0x3b000000, v204
    s_add_u32 m0, s88, 131072
    v_mfma_f32_16x16x32_bf16 v[152:155], v[168:171], a[164:167], v[152:155]
    v_mul_f32 v209, 0x3b000000, v206
    v_fma_f32 v209, -v208, v208, v209
    v_max_f32 v209, 0, v209
    s_waitcnt lgkmcnt(2)
    v_mfma_f32_16x16x32_bf16 v[144:147], a[168:171], v[172:175], v[144:147]
    s_add_u32 s24, s34, 3555328
    v_cvt_pk_bf16_f32 v211, v209, v209
    ds_read_b128 v[168:171], v18 offset:34816
    v_mfma_f32_16x16x32_bf16 v[148:151], a[172:175], v[172:175], v[148:151]
    v_cvt_pk_bf16_f32 v210, v208, v208
    v_and_b32 v211, 0xffff0000, v211
    s_add_u32 s25, s35, 3555328
    v_mfma_f32_16x16x32_bf16 v[152:155], v[172:175], a[176:179], v[152:155]
    v_and_b32 v210, 0xffff0000, v210
    v_add_f32 v211, 0x3727c5ac, v211
    v_cvt_pk_bf16_f32 v211, v211, v211
    v_mfma_f32_16x16x32_bf16 v[144:147], a[180:183], v[156:159], v[144:147]
    buffer_load_dwordx4 v20, s[52:55], s24 offen offset:0 sc1 lds
    v_and_b32 v211, 0xffff0000, v211
    ds_read_b128 v[172:175], v18 offset:35840
    v_mfma_f32_16x16x32_bf16 v[148:151], a[184:187], v[156:159], v[148:151]
    v_sqrt_f32 v211, v211
    s_nop 0
    v_cvt_pk_bf16_f32 v211, v211, v211
    buffer_load_dwordx4 v20, s[52:55], s24 offen offset:1024 sc1 lds
    v_mfma_f32_16x16x32_bf16 v[152:155], v[156:159], a[188:191], v[152:155]
    v_and_b32 v211, 0xffff0000, v211
    v_rcp_f32 v212, v211
    s_waitcnt lgkmcnt(2)
    v_mfma_f32_16x16x32_bf16 v[108:111], a[0:3], v[160:163], 0
    v_fma_f32 v213, -v210, v207, v205
    buffer_load_dwordx4 v20, s[52:55], s25 offen offset:2048 sc1 lds
    ds_read_b128 v[156:159], v18 offset:36864
    v_mfma_f32_16x16x32_bf16 v[112:115], a[4:7], v[160:163], 0
    s_lshl_b32 s19, s29, 4
    v_mul_f32 v213, v213, v212
    v_add_u32 v218, s19, v3
    v_mfma_f32_16x16x32_bf16 v[116:119], v[160:163], a[8:11], 0
    buffer_load_dwordx4 v20, s[52:55], s25 offen offset:3072 sc1 lds
    v_ashrrev_i32 v214, 31, v213
    v_mov_b32 v217, 0
    v_or_b32 v214, 0x80000000, v214
    v_mfma_f32_16x16x32_bf16 v[108:111], a[12:15], v[164:167], v[108:111]
    s_add_u32 m0, s88, 81920
    v_mov_b32 v219, s72
    v_xor_b32 v213, v213, v214
    ds_read_b128 v[160:163], v18 offset:37888
    v_mfma_f32_16x16x32_bf16 v[112:115], a[16:19], v[164:167], v[112:115]
    v_lshl_or_b32 v215, v16, 20, v16
    s_add_u32 s24, s34, 3506176
    v_or_b32 v213, 0xfff, v213
    v_mfma_f32_16x16x32_bf16 v[116:119], v[164:167], a[20:23], v[116:119]
    v_xor_b32 v213, v213, v218
    v_cndmask_b32 v216, 0, v213, s[20:21]
    s_add_u32 s25, s35, 3506176
    s_waitcnt lgkmcnt(2)
    v_mfma_f32_16x16x32_bf16 v[108:111], a[24:27], v[168:171], v[108:111]
    v_max_u32_dpp v217, v217, v217 quad_perm:[1,0,3,2] row_mask:0xf bank_mask:0xf
    v_mov_b32_dpp v218, v216 quad_perm:[1,0,3,2] row_mask:0xf bank_mask:0xf
    ds_read_b128 v[164:167], v18 offset:38912
    v_mfma_f32_16x16x32_bf16 v[112:115], a[28:31], v[168:171], v[112:115]
    v_med3_u32 v217, v216, v218, v217
    buffer_load_dwordx4 v10, s[52:55], s24 offen offset:0 sc1 lds
    v_max_u32 v216, v216, v218
    v_mfma_f32_16x16x32_bf16 v[116:119], v[168:171], a[32:35], v[116:119]
    v_max_u32_dpp v217, v217, v217 quad_perm:[2,3,0,1] row_mask:0xf bank_mask:0xf
    v_mov_b32_dpp v218, v216 quad_perm:[2,3,0,1] row_mask:0xf bank_mask:0xf
    buffer_load_dwordx4 v10, s[52:55], s24 offen offset:1024 sc1 lds
    v_mfma_f32_16x16x32_bf16 v[108:111], a[36:39], v[172:175], v[108:111]
    v_med3_u32 v217, v216, v218, v217
    v_max_u32 v216, v216, v218
    ds_read_b128 v[168:171], v18 offset:39936
    v_mfma_f32_16x16x32_bf16 v[112:115], a[40:43], v[172:175], v[112:115]
    v_max_u32_dpp v217, v217, v217 row_half_mirror row_mask:0xf bank_mask:0xf
    buffer_load_dwordx4 v10, s[52:55], s25 offen offset:2048 sc1 lds
    v_mov_b32_dpp v218, v216 row_half_mirror row_mask:0xf bank_mask:0xf
    v_mfma_f32_16x16x32_bf16 v[116:119], v[172:175], a[44:47], v[116:119]
    v_med3_u32 v217, v216, v218, v217
    v_max_u32 v216, v216, v218
    buffer_load_dwordx4 v10, s[52:55], s25 offen offset:3072 sc1 lds
    s_waitcnt lgkmcnt(2)
    v_mfma_f32_16x16x32_bf16 v[108:111], a[48:51], v[156:159], v[108:111]
    v_max_u32_dpp v217, v217, v217 row_mirror row_mask:0xf bank_mask:0xf
    v_mov_b32_dpp v218, v216 row_mirror row_mask:0xf bank_mask:0xf
    ds_read_b128 v[172:175], v18 offset:40960
    v_mfma_f32_16x16x32_bf16 v[112:115], a[52:55], v[156:159], v[112:115]
    v_med3_u32 v217, v216, v218, v217
    v_max_u32 v216, v216, v218
    buffer_store_dwordx4 v[216:219], v215, s[52:55], s27 offen sc1
    v_mfma_f32_16x16x32_bf16 v[116:119], v[156:159], a[56:59], v[116:119]
    v_readfirstlane_b32 s16, v216
    v_readfirstlane_b32 s17, v217
    v_lshrrev_b32 v222, 16, v210
    v_or_b32 v222, v222, v211
    v_mfma_f32_16x16x32_bf16 v[108:111], a[60:63], v[160:163], v[108:111]
    s_cmp_lt_u32 s8, 2
    s_cselect_b32 s16, s16, s17
    s_andn2_b32 s16, 15, s16
    ds_read_b128 v[156:159], v18 offset:41984
    v_mfma_f32_16x16x32_bf16 v[112:115], a[64:67], v[160:163], v[112:115]
    s_lshl_b32 s17, s16, 4
    v_add_u32 v215, s17, v11
    ds_read_b64 v[204:205], v215
    v_readlane_b32 s16, v222, s16
    v_mfma_f32_16x16x32_bf16 v[116:119], v[160:163], a[68:71], v[116:119]
    v_mov_b32 v207, s72
    s_lshl_b32 s18, s19, 8
    s_add_u32 s18, s18, 8421376
    s_waitcnt lgkmcnt(3)
    v_mfma_f32_16x16x32_bf16 v[108:111], a[72:75], v[164:167], v[108:111]
    v_mov_b32 v206, s16
    ds_read_b128 v[160:163], v18 offset:43008
    v_mfma_f32_16x16x32_bf16 v[112:115], a[76:79], v[164:167], v[112:115]
    v_mfma_f32_16x16x32_bf16 v[116:119], v[164:167], a[80:83], v[116:119]
    s_waitcnt lgkmcnt(1)
    buffer_store_dwordx4 v[204:207], v16, s[52:55], s18 offen sc1
    v_add_f32 v213, 1.0, v212
    v_mfma_f32_16x16x32_bf16 v[108:111], a[84:87], v[168:171], v[108:111]
    v_mul_f32 v214, v210, v212
    v_fma_f32 v208, v213, v208, -v214
    v_mul_f32 v209, v213, v209
    ds_read_b128 v[164:167], v18 offset:44032
    v_mfma_f32_16x16x32_bf16 v[112:115], a[88:91], v[168:171], v[112:115]
    v_mul_f32 v209, v213, v209
    v_rcp_f32 v227, v213
    v_cvt_pk_bf16_f32 v225, v209, v209
    v_mfma_f32_16x16x32_bf16 v[116:119], v[168:171], a[92:95], v[116:119]
    v_cvt_pk_bf16_f32 v224, v208, v208
    v_and_b32 v225, 0xffff0000, v225
    s_waitcnt lgkmcnt(3)
    v_mfma_f32_16x16x32_bf16 v[108:111], a[96:99], v[172:175], v[108:111]
    v_and_b32 v224, 0xffff0000, v224
    v_add_f32 v225, 0x3727c5ac, v225
    ds_read_b128 v[168:171], v18 offset:45056
    v_mfma_f32_16x16x32_bf16 v[112:115], a[100:103], v[172:175], v[112:115]
    v_cvt_pk_bf16_f32 v225, v225, v225
    v_and_b32 v225, 0xffff0000, v225
    v_sqrt_f32 v225, v225
    v_mfma_f32_16x16x32_bf16 v[116:119], v[172:175], a[104:107], v[116:119]
    v_cvt_pk_bf16_f32 v225, v225, v225
    v_and_b32 v225, 0xffff0000, v225
    v_mfma_f32_16x16x32_bf16 v[108:111], a[108:111], v[156:159], v[108:111]
    v_rcp_f32 v226, v225
    v_add_f32 v214, v214, v224
    ds_read_b128 v[172:175], v18 offset:46080
    v_mfma_f32_16x16x32_bf16 v[112:115], a[112:115], v[156:159], v[112:115]
    v_mul_f32 v220, v213, v226
    v_mul_f32 v221, -v214, v227
    v_mov_b32 v223, s72
    v_lshrrev_b32 v215, 8, v16
    v_mfma_f32_16x16x32_bf16 v[116:119], v[156:159], a[116:119], v[116:119]
    v_lshl_or_b32 v215, v215, 24, v16
    s_lshl_b32 s17, s29, 8
    s_add_u32 s18, s17, 65536
    s_waitcnt lgkmcnt(2)
    v_mfma_f32_16x16x32_bf16 v[108:111], a[120:123], v[160:163], v[108:111]
    s_cmp_lg_u32 s71, 0
    s_cbranch_scc1 Lwt_51
    buffer_store_dwordx4 v[220:223], v215, s[52:55], s18 offen
Lst_52:
    ds_read_b128 v[156:159], v18 offset:47104
    v_mfma_f32_16x16x32_bf16 v[112:115], a[124:127], v[160:163], v[112:115]
    s_add_u32 s18, s17, 131072
    buffer_store_dwordx4 v[220:223], v215, s[52:55], s18 offen sc1
    s_waitcnt vmcnt(4)
    v_mfma_f32_16x16x32_bf16 v[116:119], v[160:163], a[128:131], v[116:119]
    ds_read2st64_b32 v[228:229], v21 offset0:64 offset1:68
    ds_read2st64_b32 v[230:231], v21 offset0:72 offset1:76
    v_mfma_f32_16x16x32_bf16 v[108:111], a[132:135], v[164:167], v[108:111]
    ds_read_b128 v[160:163], v18 offset:48128
    v_mfma_f32_16x16x32_bf16 v[112:115], a[136:139], v[164:167], v[112:115]
    v_mfma_f32_16x16x32_bf16 v[116:119], v[164:167], a[140:143], v[116:119]
    s_waitcnt lgkmcnt(1)
    v_max3_u32 v228, v228, v229, v230
    s_waitcnt lgkmcnt(4)
    v_max_u32 v228, v228, v231
    v_cmp_eq_u32 vcc, -1, v228
    s_cbranch_vccnz Lslow_53
Lback_54:
    s_barrier
    v_mfma_f32_16x16x32_bf16 v[108:111], a[144:147], v[168:171], v[108:111]
    v_mov_b32 v248, v66
    ds_read_b128 v[164:167], v18 offset:16384
    v_mfma_f32_16x16x32_bf16 v[112:115], a[148:151], v[168:171], v[112:115]
    v_mov_b32 v249, v67
    v_mov_b32 v250, v68
    v_mov_b32 v251, v69
    v_mfma_f32_16x16x32_bf16 v[116:119], v[168:171], a[152:155], v[116:119]
    s_add_u32 s18, s23, 5963776
    v_permlane16_swap_b32 v248, v250
    v_mfma_f32_16x16x32_bf16 v[108:111], a[156:159], v[172:175], v[108:111]
    v_permlane16_swap_b32 v249, v251
    ds_read_b128 v[168:171], v18 offset:17408
    v_mfma_f32_16x16x32_bf16 v[112:115], a[160:163], v[172:175], v[112:115]
    buffer_store_dwordx4 v[248:251], v26, s[52:55], s18 offen sc1
    v_mov_b32 v236, v70
    v_mfma_f32_16x16x32_bf16 v[116:119], v[172:175], a[164:167], v[116:119]
    v_mov_b32 v237, v71
    v_mov_b32 v238, v72
    s_waitcnt lgkmcnt(2)
    v_mfma_f32_16x16x32_bf16 v[108:111], a[168:171], v[156:159], v[108:111]
    v_mov_b32 v239, v73
    ds_read_b128 v[172:175], v18 offset:18432
    v_mfma_f32_16x16x32_bf16 v[112:115], a[172:175], v[156:159], v[112:115]
    s_add_u32 s18, s23, 5996544
    v_permlane16_swap_b32 v236, v238
    v_mfma_f32_16x16x32_bf16 v[116:119], v[156:159], a[176:179], v[116:119]
    v_permlane16_swap_b32 v237, v239
    v_mfma_f32_16x16x32_bf16 v[108:111], a[180:183], v[160:163], v[108:111]
    buffer_store_dwordx4 v[236:239], v24, s[52:55], s18 offen sc1
    v_mov_b32 v240, v74
    ds_read_b128 v[156:159], v18 offset:19456
    v_mfma_f32_16x16x32_bf16 v[112:115], a[184:187], v[160:163], v[112:115]
    v_mov_b32 v241, v75
    s_add_u32 s18, s23, 6029312
    v_mfma_f32_16x16x32_bf16 v[116:119], v[160:163], a[188:191], v[116:119]
    v_permlane16_swap_b32 v240, v242
    s_waitcnt lgkmcnt(2)
    v_mfma_f32_16x16x32_bf16 v[96:99], a[0:3], v[164:167], 0
    v_permlane16_swap_b32 v241, v243
    ds_read_b128 v[160:163], v18 offset:20480
    v_mfma_f32_16x16x32_bf16 v[100:103], a[4:7], v[164:167], 0
    buffer_store_dwordx4 v[240:243], v25, s[52:55], s18 offen sc1
    v_mov_b32 v244, -1
    v_mfma_f32_16x16x32_bf16 v[104:107], v[164:167], a[8:11], 0
    v_mov_b32 v245, -1
    v_mov_b32 v246, -1
    v_mov_b32 v247, -1
    v_mfma_f32_16x16x32_bf16 v[96:99], a[12:15], v[168:171], v[96:99]
    s_add_u32 s16, s23, 1048576
    ds_read_b128 v[164:167], v18 offset:21504
    v_mfma_f32_16x16x32_bf16 v[100:103], a[16:19], v[168:171], v[100:103]
    s_add_u32 s17, s23, 1081344
    s_add_u32 s18, s23, 1114112
    v_mfma_f32_16x16x32_bf16 v[104:107], v[168:171], a[20:23], v[104:107]
    s_waitcnt lgkmcnt(2)
    v_mfma_f32_16x16x32_bf16 v[96:99], a[24:27], v[172:175], v[96:99]
    ds_read_b128 v[168:171], v18 offset:22528
    v_mfma_f32_16x16x32_bf16 v[100:103], a[28:31], v[172:175], v[100:103]
    s_cmp_lg_u32 s71, 0
    s_cbranch_scc1 Lwt_56
    buffer_store_dwordx4 v[244:247], v24, s[52:55], s16 offen
    buffer_store_dwordx4 v[244:247], v24, s[52:55], s17 offen
    buffer_store_dwordx4 v[244:247], v25, s[52:55], s18 offen
Lst_57:
    v_mfma_f32_16x16x32_bf16 v[104:107], v[172:175], a[32:35], v[104:107]
    v_max_u32 v236, 112, v17
    v_add_u32 v236, s32, v236
    v_mfma_f32_16x16x32_bf16 v[96:99], a[36:39], v[156:159], v[96:99]
    v_lshlrev_b32 v237, 4, v3
    ds_read_b128 v[172:175], v18 offset:23552
    v_mfma_f32_16x16x32_bf16 v[100:103], a[40:43], v[156:159], v[100:103]
    v_add_u32 v237, s32, v237
    v_lshlrev_b32 v238, 6, v4
    v_add_u32 v238, s32, v238
    v_mfma_f32_16x16x32_bf16 v[104:107], v[156:159], a[44:47], v[104:107]
    v_add_u32 v239, 1024, v238
    s_waitcnt vmcnt(14)
    s_waitcnt lgkmcnt(2)
    v_mfma_f32_16x16x32_bf16 v[96:99], a[48:51], v[160:163], v[96:99]
    ds_read2st64_b32 v[248:249], v21 offset0:192 offset1:196
    ds_read_b128 v[156:159], v18 offset:24576
    v_mfma_f32_16x16x32_bf16 v[100:103], a[52:55], v[160:163], v[100:103]
    ds_read2st64_b32 v[250:251], v21 offset0:200 offset1:204
    ds_read2st64_b32 v[228:229], v22 offset0:0 offset1:4
    v_mfma_f32_16x16x32_bf16 v[104:107], v[160:163], a[56:59], v[104:107]
    ds_read2st64_b32 v[230:231], v22 offset0:8 offset1:12
    v_mfma_f32_16x16x32_bf16 v[96:99], a[60:63], v[164:167], v[96:99]
    ds_read_b128 v[160:163], v18 offset:25600
    v_mfma_f32_16x16x32_bf16 v[100:103], a[64:67], v[164:167], v[100:103]
    v_mfma_f32_16x16x32_bf16 v[104:107], v[164:167], a[68:71], v[104:107]
    s_waitcnt lgkmcnt(1)
    s_waitcnt lgkmcnt(6)
    v_mfma_f32_16x16x32_bf16 v[96:99], a[72:75], v[168:171], v[96:99]
    v_max3_u32 v248, v248, v249, v250
    ds_read_b128 v[164:167], v18 offset:26624
    v_mfma_f32_16x16x32_bf16 v[100:103], a[76:79], v[168:171], v[100:103]
    v_max3_u32 v228, v228, v229, v230
    v_max3_u32 v248, v248, v251, v231
    v_max_u32 v248, v248, v228
    v_mfma_f32_16x16x32_bf16 v[104:107], v[168:171], a[80:83], v[104:107]
    v_cmp_eq_u32 vcc, -1, v248
    s_cbranch_vccnz Lslow_58
Lback_59:
    v_mfma_f32_16x16x32_bf16 v[96:99], a[84:87], v[172:175], v[96:99]
    ds_read_b128 v[168:171], v18 offset:27648
    v_mfma_f32_16x16x32_bf16 v[100:103], a[88:91], v[172:175], v[100:103]
    s_mov_b32 m0, s32
    s_mov_b32 exec_lo, 0xffffff80
    buffer_load_dwordx4 v17, s[52:55], s33 offen sc1 lds
    s_mov_b64 exec, 0xffff
    buffer_load_dwordx4 v17, s[52:55], s33 offen offset:1024 sc1 lds
    s_mov_b64 exec, -1
    v_mfma_f32_16x16x32_bf16 v[104:107], v[172:175], a[92:95], v[104:107]
    s_waitcnt lgkmcnt(2)
    v_mfma_f32_16x16x32_bf16 v[96:99], a[96:99], v[156:159], v[96:99]
    ds_read_b128 v[172:175], v18 offset:28672
    v_mfma_f32_16x16x32_bf16 v[100:103], a[100:103], v[156:159], v[100:103]
    v_mfma_f32_16x16x32_bf16 v[104:107], v[156:159], a[104:107], v[104:107]
    v_mfma_f32_16x16x32_bf16 v[96:99], a[108:111], v[160:163], v[96:99]
    ds_read_b128 v[156:159], v18 offset:29696
    v_mfma_f32_16x16x32_bf16 v[100:103], a[112:115], v[160:163], v[100:103]
    v_mfma_f32_16x16x32_bf16 v[104:107], v[160:163], a[116:119], v[104:107]
    s_waitcnt vmcnt(2)
    s_waitcnt lgkmcnt(2)
    v_mfma_f32_16x16x32_bf16 v[96:99], a[120:123], v[164:167], v[96:99]
    s_barrier
    ds_read_b128 v[160:163], v18 offset:30720
    v_mfma_f32_16x16x32_bf16 v[100:103], a[124:127], v[164:167], v[100:103]
    s_mov_b32 m0, s32
    s_mov_b64 exec, 0x7f
    buffer_load_dwordx4 v15, s[52:55], s33 offen sc1 lds
    s_mov_b64 exec, -1
    v_mfma_f32_16x16x32_bf16 v[104:107], v[164:167], a[128:131], v[104:107]
    s_add_u32 s18, s10, 819200
    v_mov_b32 v240, s5
    v_mfma_f32_16x16x32_bf16 v[96:99], a[132:135], v[168:171], v[96:99]
    v_lshlrev_b32 v241, 24, v0
    ds_read_b128 v[164:167], v18 offset:31744
    v_mfma_f32_16x16x32_bf16 v[100:103], a[136:139], v[168:171], v[100:103]
    buffer_store_dword v240, v241, s[52:55], s18 offen sc1
    s_waitcnt vmcnt(2)
    v_mfma_f32_16x16x32_bf16 v[104:107], v[168:171], a[140:143], v[104:107]
    ds_read_b32 v248, v236 offset:12
    ds_read_b32 v249, v237 offset:1036
    s_waitcnt lgkmcnt(4)
    v_mfma_f32_16x16x32_bf16 v[96:99], a[144:147], v[172:175], v[96:99]
    ds_read_b128 v[168:171], v18 offset:49152
    v_mfma_f32_16x16x32_bf16 v[100:103], a[148:151], v[172:175], v[100:103]
    v_mfma_f32_16x16x32_bf16 v[104:107], v[172:175], a[152:155], v[104:107]
    s_waitcnt lgkmcnt(1)
    v_xor_b32 v248, s72, v248
    v_mfma_f32_16x16x32_bf16 v[96:99], a[156:159], v[156:159], v[96:99]
    v_xor_b32 v249, s72, v249
    v_or_b32 v248, v248, v249
    ds_read_b128 v[172:175], v18 offset:50176
    v_mfma_f32_16x16x32_bf16 v[100:103], a[160:163], v[156:159], v[100:103]
    v_cmp_ne_u32 vcc, 0, v248
    s_cbranch_vccnz Lslow_61
Lback_62:
    v_mfma_f32_16x16x32_bf16 v[104:107], v[156:159], a[164:167], v[104:107]
    ds_read_b64 v[226:227], v237 offset:256
    ds_read2_b32 v[228:229], v238 offset0:64 offset1:68
    s_waitcnt lgkmcnt(6)
    v_mfma_f32_16x16x32_bf16 v[96:99], a[168:171], v[160:163], v[96:99]
    ds_read2_b32 v[230:231], v238 offset0:72 offset1:76
    ds_read_b128 v[156:159], v18 offset:51200
    v_mfma_f32_16x16x32_bf16 v[100:103], a[172:175], v[160:163], v[100:103]
    ds_read2_b32 v[232:233], v238 offset0:65 offset1:69
    ds_read2_b32 v[234:235], v238 offset0:73 offset1:77
    v_mfma_f32_16x16x32_bf16 v[104:107], v[160:163], a[176:179], v[104:107]
    ds_read_b64 v[206:207], v237 offset:1024
    ds_read2_b32 v[208:209], v239 offset0:0 offset1:4
    v_mfma_f32_16x16x32_bf16 v[96:99], a[180:183], v[164:167], v[96:99]
    ds_read2_b32 v[210:211], v239 offset0:8 offset1:12
    ds_read_b128 v[160:163], v18 offset:52224
    v_mfma_f32_16x16x32_bf16 v[100:103], a[184:187], v[164:167], v[100:103]
    ds_read2_b32 v[212:213], v239 offset0:1 offset1:5
    ds_read2_b32 v[214:215], v239 offset0:9 offset1:13
    v_mfma_f32_16x16x32_bf16 v[104:107], v[164:167], a[188:191], v[104:107]
    s_waitcnt lgkmcnt(6)
    v_fmac_f32 v108, v54, v227
    v_fmac_f32 v109, v55, v227
    s_waitcnt lgkmcnt(12)
    v_mfma_f32_16x16x32_bf16 v[120:123], a[0:3], v[168:171], 0
    v_fmac_f32 v110, v56, v227
    ds_read_b128 v[164:167], v18 offset:53248
    v_mfma_f32_16x16x32_bf16 v[124:127], a[4:7], v[168:171], 0
    v_fmac_f32 v111, v57, v227
    v_fmac_f32 v112, v58, v227
    v_mfma_f32_16x16x32_bf16 v[128:131], v[168:171], a[8:11], 0
    v_fmac_f32 v113, v59, v227
    v_fmac_f32 v114, v60, v227
    v_mfma_f32_16x16x32_bf16 v[120:123], a[12:15], v[172:175], v[120:123]
    v_fmac_f32 v115, v61, v227
    ds_read_b128 v[168:171], v18 offset:54272
    v_mfma_f32_16x16x32_bf16 v[124:127], a[16:19], v[172:175], v[124:127]
    v_mul_f32 v112, v112, v226
    v_mul_f32 v113, v113, v226
    v_mul_f32 v114, v114, v226
    v_mfma_f32_16x16x32_bf16 v[128:131], v[172:175], a[20:23], v[128:131]
    v_mul_f32 v115, v115, v226
    s_waitcnt lgkmcnt(4)
    v_mfma_f32_16x16x32_bf16 v[120:123], a[24:27], v[156:159], v[120:123]
    v_fmac_f32 v116, v62, v232
    ds_read_b128 v[172:175], v18 offset:55296
    v_mfma_f32_16x16x32_bf16 v[124:127], a[28:31], v[156:159], v[124:127]
    v_fmac_f32 v117, v62, v233
    v_fmac_f32 v118, v62, v234
    v_mfma_f32_16x16x32_bf16 v[128:131], v[156:159], a[32:35], v[128:131]
    v_fmac_f32 v119, v62, v235
    v_mul_f32 v116, v116, v228
    v_mfma_f32_16x16x32_bf16 v[120:123], a[36:39], v[160:163], v[120:123]
    v_mul_f32 v117, v117, v229
    ds_read_b128 v[156:159], v18 offset:56320
    v_mfma_f32_16x16x32_bf16 v[124:127], a[40:43], v[160:163], v[124:127]
    v_mul_f32 v118, v118, v230
    v_mul_f32 v119, v119, v231
    v_mfma_f32_16x16x32_bf16 v[128:131], v[160:163], a[44:47], v[128:131]
    v_cvt_pk_bf16_f32 v178, v108, v109
    s_waitcnt lgkmcnt(2)
    v_mfma_f32_16x16x32_bf16 v[120:123], a[48:51], v[164:167], v[120:123]
    v_cvt_pk_bf16_f32 v179, v110, v111
    ds_read_b128 v[160:163], v18 offset:57344
    v_mfma_f32_16x16x32_bf16 v[124:127], a[52:55], v[164:167], v[124:127]
    v_cvt_pk_bf16_f32 v188, v112, v113
    v_cvt_pk_bf16_f32 v189, v114, v115
    v_mfma_f32_16x16x32_bf16 v[128:131], v[164:167], a[56:59], v[128:131]
    v_cvt_pk_bf16_f32 v198, v116, v117
    v_mfma_f32_16x16x32_bf16 v[120:123], a[60:63], v[168:171], v[120:123]
    v_cvt_pk_bf16_f32 v199, v118, v119
    ds_read_b128 v[164:167], v18 offset:58368
    v_mfma_f32_16x16x32_bf16 v[124:127], a[64:67], v[168:171], v[124:127]
    v_mul_f32 v226, 0x3eb8aa3b, v226
    s_waitcnt lgkmcnt(6)
    v_mfma_f32_16x16x32_bf16 v[128:131], v[168:171], a[68:71], v[128:131]
    v_fmac_f32 v144, v54, v207
    s_waitcnt lgkmcnt(2)
    v_mfma_f32_16x16x32_bf16 v[120:123], a[72:75], v[172:175], v[120:123]
    v_fmac_f32 v145, v55, v207
    ds_read_b128 v[168:171], v18 offset:59392
    v_mfma_f32_16x16x32_bf16 v[124:127], a[76:79], v[172:175], v[124:127]
    v_fmac_f32 v146, v56, v207
    v_fmac_f32 v147, v57, v207
    v_mfma_f32_16x16x32_bf16 v[128:131], v[172:175], a[80:83], v[128:131]
    v_fmac_f32 v148, v58, v207
    v_fmac_f32 v149, v59, v207
    v_fmac_f32 v150, v60, v207
    v_mfma_f32_16x16x32_bf16 v[120:123], a[84:87], v[156:159], v[120:123]
    v_fmac_f32 v151, v61, v207
    ds_read_b128 v[172:175], v18 offset:60416
    v_mfma_f32_16x16x32_bf16 v[124:127], a[88:91], v[156:159], v[124:127]
    v_mul_f32 v148, v148, v206
    v_mul_f32 v149, v149, v206
    v_mfma_f32_16x16x32_bf16 v[128:131], v[156:159], a[92:95], v[128:131]
    v_mul_f32 v150, v150, v206
    s_waitcnt lgkmcnt(2)
    v_mfma_f32_16x16x32_bf16 v[120:123], a[96:99], v[160:163], v[120:123]
    v_mul_f32 v151, v151, v206
    ds_read_b128 v[156:159], v18 offset:61440
    v_mfma_f32_16x16x32_bf16 v[124:127], a[100:103], v[160:163], v[124:127]
    v_fmac_f32 v152, v62, v212
    v_fmac_f32 v153, v62, v213
    v_mfma_f32_16x16x32_bf16 v[128:131], v[160:163], a[104:107], v[128:131]
    v_fmac_f32 v154, v62, v214
    v_fmac_f32 v155, v62, v215
    v_mul_f32 v152, v152, v208
    v_mfma_f32_16x16x32_bf16 v[120:123], a[108:111], v[164:167], v[120:123]
    v_mul_f32 v153, v153, v209
    ds_read_b128 v[160:163], v18 offset:62464
    v_mfma_f32_16x16x32_bf16 v[124:127], a[112:115], v[164:167], v[124:127]
    v_mul_f32 v154, v154, v210
    v_mul_f32 v155, v155, v211
    v_mfma_f32_16x16x32_bf16 v[128:131], v[164:167], a[116:119], v[128:131]
    v_cvt_pk_bf16_f32 v184, v144, v145
    s_waitcnt lgkmcnt(2)
    v_mfma_f32_16x16x32_bf16 v[120:123], a[120:123], v[168:171], v[120:123]
    ds_read_b128 v[164:167], v18 offset:63488
    v_mfma_f32_16x16x32_bf16 v[124:127], a[124:127], v[168:171], v[124:127]
    v_cvt_pk_bf16_f32 v185, v146, v147
    v_cvt_pk_bf16_f32 v194, v148, v149
    v_mfma_f32_16x16x32_bf16 v[128:131], v[168:171], a[128:131], v[128:131]
    v_cvt_pk_bf16_f32 v195, v150, v151
    v_cvt_pk_bf16_f32 v204, v152, v153
    v_mfma_f32_16x16x32_bf16 v[120:123], a[132:135], v[172:175], v[120:123]
    ds_read_b128 v[168:171], v18 offset:64512
    v_mfma_f32_16x16x32_bf16 v[124:127], a[136:139], v[172:175], v[124:127]
    v_cvt_pk_bf16_f32 v205, v154, v155
    v_mul_f32 v206, 0x3eb8aa3b, v206
    v_mfma_f32_16x16x32_bf16 v[128:131], v[172:175], a[140:143], v[128:131]
    s_waitcnt vmcnt(1)
    s_waitcnt lgkmcnt(2)
    v_mfma_f32_16x16x32_bf16 v[120:123], a[144:147], v[156:159], v[120:123]
    ds_read_b32 v248, v237 offset:12
    ds_read_b128 v[172:175], v19 offset:0
    v_mfma_f32_16x16x32_bf16 v[124:127], a[148:151], v[156:159], v[124:127]
    v_mfma_f32_16x16x32_bf16 v[128:131], v[156:159], a[152:155], v[128:131]
    v_mfma_f32_16x16x32_bf16 v[120:123], a[156:159], v[160:163], v[120:123]
    s_waitcnt lgkmcnt(1)
    ds_read_b128 v[156:159], v19 offset:1024
    v_mfma_f32_16x16x32_bf16 v[124:127], a[160:163], v[160:163], v[124:127]
    v_cmp_ne_u32 vcc, s72, v248
    s_cbranch_vccnz Lslow_64
Lback_65:
    v_mfma_f32_16x16x32_bf16 v[128:131], v[160:163], a[164:167], v[128:131]
    ds_read_b64 v[216:217], v237 offset:0
    s_waitcnt lgkmcnt(4)
    v_mfma_f32_16x16x32_bf16 v[120:123], a[168:171], v[164:167], v[120:123]
    ds_read2_b32 v[218:219], v238 offset0:0 offset1:4
    ds_read_b128 v[160:163], v19 offset:2048
    v_mfma_f32_16x16x32_bf16 v[124:127], a[172:175], v[164:167], v[124:127]
    ds_read2_b32 v[220:221], v238 offset0:8 offset1:12
    v_mfma_f32_16x16x32_bf16 v[128:131], v[164:167], a[176:179], v[128:131]
    ds_read2_b32 v[222:223], v238 offset0:1 offset1:5
    ds_read2_b32 v[224:225], v238 offset0:9 offset1:13
    v_mfma_f32_16x16x32_bf16 v[120:123], a[180:183], v[168:171], v[120:123]
    v_and_b32 v241, 7, v2
    ds_read_b128 v[164:167], v19 offset:3072
    v_mfma_f32_16x16x32_bf16 v[124:127], a[184:187], v[168:171], v[124:127]
    s_lshl_b32 s38, s6, 10
    v_lshlrev_b32 v241, 7, v241
    v_mfma_f32_16x16x32_bf16 v[128:131], v[168:171], a[188:191], v[128:131]
    s_add_u32 s38, s38, 819200
    buffer_load_dword v240, v241, s[52:55], s38 offen sc1
    s_waitcnt lgkmcnt(7)
    v_mfma_f32_16x16x32_bf16 v[132:135], a[0:3], v[172:175], 0
    s_waitcnt lgkmcnt(1)
    ds_read_b128 v[168:171], v19 offset:4096
    v_mfma_f32_16x16x32_bf16 v[136:139], a[4:7], v[172:175], 0
    v_fmac_f32 v96, v54, v217
    v_fmac_f32 v97, v55, v217
    v_mfma_f32_16x16x32_bf16 v[140:143], v[172:175], a[8:11], 0
    v_fmac_f32 v98, v56, v217
    v_fmac_f32 v99, v57, v217
    v_mfma_f32_16x16x32_bf16 v[132:135], a[12:15], v[156:159], v[132:135]
    v_fmac_f32 v100, v58, v217
    ds_read_b128 v[172:175], v19 offset:5120
    v_mfma_f32_16x16x32_bf16 v[136:139], a[16:19], v[156:159], v[136:139]
    v_fmac_f32 v101, v59, v217
    v_fmac_f32 v102, v60, v217
    v_fmac_f32 v103, v61, v217
    v_mfma_f32_16x16x32_bf16 v[140:143], v[156:159], a[20:23], v[140:143]
    v_mul_f32 v100, v100, v216
    s_waitcnt lgkmcnt(2)
    v_mfma_f32_16x16x32_bf16 v[132:135], a[24:27], v[160:163], v[132:135]
    v_mul_f32 v101, v101, v216
    ds_read_b128 v[156:159], v19 offset:6144
    v_mfma_f32_16x16x32_bf16 v[136:139], a[28:31], v[160:163], v[136:139]
    v_mul_f32 v102, v102, v216
    v_mul_f32 v103, v103, v216
    v_mfma_f32_16x16x32_bf16 v[140:143], v[160:163], a[32:35], v[140:143]
    v_fmac_f32 v104, v62, v222
    v_fmac_f32 v105, v62, v223
    v_mfma_f32_16x16x32_bf16 v[132:135], a[36:39], v[164:167], v[132:135]
    v_fmac_f32 v106, v62, v224
    ds_read_b128 v[160:163], v19 offset:7168
    v_mfma_f32_16x16x32_bf16 v[136:139], a[40:43], v[164:167], v[136:139]
    v_fmac_f32 v107, v62, v225
    v_mul_f32 v104, v104, v218
    v_mfma_f32_16x16x32_bf16 v[140:143], v[164:167], a[44:47], v[140:143]
    v_mul_f32 v105, v105, v219
    v_mul_f32 v106, v106, v220
    s_waitcnt lgkmcnt(2)
    v_mfma_f32_16x16x32_bf16 v[132:135], a[48:51], v[168:171], v[132:135]
    v_mul_f32 v107, v107, v221
    ds_read_b128 v[164:167], v19 offset:8192
    v_mfma_f32_16x16x32_bf16 v[136:139], a[52:55], v[168:171], v[136:139]
    v_cvt_pk_bf16_f32 v176, v96, v97
    v_mfma_f32_16x16x32_bf16 v[140:143], v[168:171], a[56:59], v[140:143]
    v_cvt_pk_bf16_f32 v177, v98, v99
    v_cvt_pk_bf16_f32 v186, v100, v101
    v_mfma_f32_16x16x32_bf16 v[132:135], a[60:63], v[172:175], v[132:135]
    v_cvt_pk_bf16_f32 v187, v102, v103
    ds_read_b128 v[168:171], v19 offset:9216
    v_mfma_f32_16x16x32_bf16 v[136:139], a[64:67], v[172:175], v[136:139]
    v_cvt_pk_bf16_f32 v196, v104, v105
    v_mfma_f32_16x16x32_bf16 v[140:143], v[172:175], a[68:71], v[140:143]
    v_cvt_pk_bf16_f32 v197, v106, v107
    s_waitcnt lgkmcnt(2)
    v_mfma_f32_16x16x32_bf16 v[132:135], a[72:75], v[156:159], v[132:135]
    v_mul_f32 v216, 0x3eb8aa3b, v216
    v_mfma_f32_16x16x16_bf16 v[96:99], v[186:187], v[176:177], v[32:35]
    v_mfma_f32_16x16x16_bf16 v[112:115], v[186:187], v[178:179], v[40:43]
    v_mfma_f32_16x16x16_bf16 v[108:111], v[188:189], v[178:179], v[36:39]
    ds_read_b128 v[172:175], v19 offset:10240
    v_mfma_f32_16x16x32_bf16 v[136:139], a[76:79], v[156:159], v[136:139]
    s_nop 3
    v_max3_f32 v218, v96, v97, v98
    v_max_f32 v218, v218, v99
    v_mfma_f32_16x16x32_bf16 v[140:143], v[156:159], a[80:83], v[140:143]
    v_max_f32 v108, v108, v112
    v_max_f32 v109, v109, v113
    v_mfma_f32_16x16x32_bf16 v[132:135], a[84:87], v[160:163], v[132:135]
    v_max_f32 v110, v110, v114
    ds_read_b128 v[156:159], v19 offset:11264
    v_mfma_f32_16x16x32_bf16 v[136:139], a[88:91], v[160:163], v[136:139]
    v_max_f32 v111, v111, v115
    v_max3_f32 v228, v108, v109, v110
    v_mfma_f32_16x16x32_bf16 v[140:143], v[160:163], a[92:95], v[140:143]
    v_max_f32 v228, v228, v111
    s_waitcnt lgkmcnt(2)
    v_mfma_f32_16x16x32_bf16 v[132:135], a[96:99], v[164:167], v[132:135]
    ds_read_b128 v[160:163], v19 offset:12288
    v_mfma_f32_16x16x32_bf16 v[136:139], a[100:103], v[164:167], v[136:139]
    v_permlane16_swap_b32 v218, v228
    v_max_f32 v218, v218, v228
    v_mfma_f32_16x16x32_bf16 v[140:143], v[164:167], a[104:107], v[140:143]
    v_mov_b32 v228, v218
    v_mfma_f32_16x16x32_bf16 v[132:135], a[108:111], v[168:171], v[132:135]
    s_nop 0
    v_permlane32_swap_b32 v218, v228
    ds_read_b128 v[164:167], v19 offset:13312
    v_mfma_f32_16x16x32_bf16 v[136:139], a[112:115], v[168:171], v[136:139]
    v_max_f32 v218, v218, v228
    v_mov_b32 v228, v218
    v_mfma_f32_16x16x32_bf16 v[140:143], v[168:171], a[116:119], v[140:143]
    s_waitcnt lgkmcnt(2)
    v_mfma_f32_16x16x32_bf16 v[132:135], a[120:123], v[172:175], v[132:135]
    v_permlane16_swap_b32 v218, v228
    ds_read_b128 v[168:171], v19 offset:14336
    v_mfma_f32_16x16x32_bf16 v[136:139], a[124:127], v[172:175], v[136:139]
    v_mul_f32 v217, v216, v218
    v_mfma_f32_16x16x32_bf16 v[140:143], v[172:175], a[128:131], v[140:143]
    v_fma_f32 v96, v96, v216, -v217
    v_fma_f32 v97, v97, v216, -v217
    v_mfma_f32_16x16x32_bf16 v[132:135], a[132:135], v[156:159], v[132:135]
    v_fma_f32 v98, v98, v216, -v217
    ds_read_b128 v[172:175], v19 offset:15360
    v_mfma_f32_16x16x32_bf16 v[136:139], a[136:139], v[156:159], v[136:139]
    v_fma_f32 v99, v99, v216, -v217
    v_mfma_f32_16x16x32_bf16 v[140:143], v[156:159], a[140:143], v[140:143]
    v_exp_f32 v96, v96
    s_waitcnt lgkmcnt(2)
    v_mfma_f32_16x16x32_bf16 v[132:135], a[144:147], v[160:163], v[132:135]
    v_exp_f32 v97, v97
    v_mfma_f32_16x16x32_bf16 v[136:139], a[148:151], v[160:163], v[136:139]
    v_exp_f32 v98, v98
    v_mfma_f32_16x16x32_bf16 v[140:143], v[160:163], a[152:155], v[140:143]
    v_exp_f32 v99, v99
    v_mfma_f32_16x16x32_bf16 v[132:135], a[156:159], v[164:167], v[132:135]
    v_mul_f32 v227, v226, v228
    v_fma_f32 v108, v108, v226, -v227
    v_mfma_f32_16x16x32_bf16 v[136:139], a[160:163], v[164:167], v[136:139]
    v_fma_f32 v109, v109, v226, -v227
    v_fma_f32 v110, v110, v226, -v227
    v_mfma_f32_16x16x32_bf16 v[140:143], v[164:167], a[164:167], v[140:143]
    v_fma_f32 v111, v111, v226, -v227
    s_waitcnt lgkmcnt(0)
    v_mfma_f32_16x16x32_bf16 v[132:135], a[168:171], v[168:171], v[132:135]
    v_exp_f32 v108, v108
    v_mfma_f32_16x16x32_bf16 v[136:139], a[172:175], v[168:171], v[136:139]
    v_exp_f32 v109, v109
    v_mfma_f32_16x16x32_bf16 v[140:143], v[168:171], a[176:179], v[140:143]
    v_exp_f32 v110, v110
    v_mfma_f32_16x16x32_bf16 v[132:135], a[180:183], v[172:175], v[132:135]
    v_exp_f32 v111, v111
    v_mfma_f32_16x16x32_bf16 v[136:139], a[184:187], v[172:175], v[136:139]
    v_cvt_pk_bf16_f32 v220, v96, v97
    v_cvt_pk_bf16_f32 v221, v98, v99
    v_mfma_f32_16x16x32_bf16 v[140:143], v[172:175], a[188:191], v[140:143]
    s_nop 0
    v_mfma_f32_16x16x16_bf16 v[100:103], v[28:29], v[220:221], 0
    v_mfma_f32_16x16x16_bf16 v[96:99], v[196:197], v[220:221], 0
    v_cvt_pk_bf16_f32 v230, v108, v109
    v_cvt_pk_bf16_f32 v231, v110, v111
    v_and_b32 v118, v52, v230
    v_and_b32 v119, v53, v231
    v_mfma_f32_16x16x16_bf16 v[112:115], v[28:29], v[230:231], 0
    v_xor_b32 v116, v118, v230
    v_xor_b32 v117, v119, v231
    s_nop 1
    v_mfma_f32_16x16x32_bf16 v[108:111], v[196:199], v[116:119], 0
    v_rcp_f32 v100, v100
    s_nop 1
    v_rcp_f32 v112, v112
    v_mul_f32 v96, v96, v100
    v_mul_f32 v97, v97, v100
    v_mul_f32 v98, v98, v100
    v_mul_f32 v99, v99, v100
    v_cvt_pk_bf16_f32 v104, v96, v97
    v_cvt_pk_bf16_f32 v105, v98, v99
    v_mul_f32 v108, v108, v112
    v_mul_f32 v109, v109, v112
    v_mul_f32 v110, v110, v112
    v_mul_f32 v111, v111, v112
    v_cvt_pk_bf16_f32 v106, v108, v109
    v_cvt_pk_bf16_f32 v107, v110, v111
    s_add_u32 s18, s23, 1048576
    v_permlane16_swap_b32 v104, v106
    v_permlane16_swap_b32 v105, v107
    v_min_u32 v104, -2, v104
    s_cmp_lg_u32 s71, 0
    s_cbranch_scc1 Lwt_67
    buffer_store_dwordx4 v[104:107], v24, s[52:55], s18 offen
Lst_68:
    ds_read_b64 v[216:217], v237 offset:512
    ds_read2_b32 v[218:219], v238 offset0:128 offset1:132
    ds_read2_b32 v[220:221], v238 offset0:136 offset1:140
    ds_read2_b32 v[222:223], v238 offset0:129 offset1:133
    ds_read2_b32 v[224:225], v238 offset0:137 offset1:141
    ds_read_b64 v[226:227], v237 offset:768
    ds_read2_b32 v[228:229], v238 offset0:192 offset1:196
    ds_read2_b32 v[230:231], v238 offset0:200 offset1:204
    ds_read2_b32 v[232:233], v238 offset0:193 offset1:197
    ds_read2_b32 v[234:235], v238 offset0:201 offset1:205
    ds_read_b32 v112, v237 offset:8
    ds_read_b32 v113, v237 offset:264
    ds_read_b32 v114, v237 offset:520
    ds_read_b32 v115, v237 offset:776
    ds_read_b32 v116, v237 offset:1032
    s_waitcnt lgkmcnt(0)
    v_pk_fma_f32 v[124:125], v[58:59], v[216:217], v[124:125] op_sel:[0,1,0] op_sel_hi:[1,1,1]
    v_pk_fma_f32 v[126:127], v[60:61], v[216:217], v[126:127] op_sel:[0,1,0] op_sel_hi:[1,1,1]
    v_pk_fma_f32 v[120:121], v[54:55], v[216:217], v[120:121] op_sel:[0,1,0] op_sel_hi:[1,1,1]
    v_pk_fma_f32 v[122:123], v[56:57], v[216:217], v[122:123] op_sel:[0,1,0] op_sel_hi:[1,1,1]
    v_pk_fma_f32 v[128:129], v[62:63], v[222:223], v[128:129]
    v_pk_fma_f32 v[130:131], v[62:63], v[224:225], v[130:131]
    v_pk_mul_f32 v[124:125], v[124:125], v[216:217] op_sel_hi:[1,0]
    v_pk_mul_f32 v[126:127], v[126:127], v[216:217] op_sel_hi:[1,0]
    v_pk_mul_f32 v[128:129], v[128:129], v[218:219]
    v_pk_mul_f32 v[130:131], v[130:131], v[220:221]
    v_cvt_pk_bf16_f32 v180, v120, v121
    v_cvt_pk_bf16_f32 v181, v122, v123
    v_cvt_pk_bf16_f32 v190, v124, v125
    v_cvt_pk_bf16_f32 v191, v126, v127
    v_cvt_pk_bf16_f32 v200, v128, v129
    v_cvt_pk_bf16_f32 v201, v130, v131
    v_mul_f32 v216, 0x3eb8aa3b, v216
    v_pk_fma_f32 v[136:137], v[58:59], v[226:227], v[136:137] op_sel:[0,1,0] op_sel_hi:[1,1,1]
    v_pk_fma_f32 v[138:139], v[60:61], v[226:227], v[138:139] op_sel:[0,1,0] op_sel_hi:[1,1,1]
    v_pk_fma_f32 v[132:133], v[54:55], v[226:227], v[132:133] op_sel:[0,1,0] op_sel_hi:[1,1,1]
    v_pk_fma_f32 v[134:135], v[56:57], v[226:227], v[134:135] op_sel:[0,1,0] op_sel_hi:[1,1,1]
    v_pk_fma_f32 v[140:141], v[62:63], v[232:233], v[140:141]
    v_pk_fma_f32 v[142:143], v[62:63], v[234:235], v[142:143]
    v_pk_mul_f32 v[136:137], v[136:137], v[226:227] op_sel_hi:[1,0]
    v_pk_mul_f32 v[138:139], v[138:139], v[226:227] op_sel_hi:[1,0]
    v_pk_mul_f32 v[140:141], v[140:141], v[228:229]
    v_pk_mul_f32 v[142:143], v[142:143], v[230:231]
    v_cvt_pk_bf16_f32 v182, v132, v133
    v_cvt_pk_bf16_f32 v183, v134, v135
    v_cvt_pk_bf16_f32 v192, v136, v137
    v_cvt_pk_bf16_f32 v193, v138, v139
    v_cvt_pk_bf16_f32 v202, v140, v141
    v_cvt_pk_bf16_f32 v203, v142, v143
    v_mul_f32 v226, 0x3eb8aa3b, v226
    v_mfma_f32_16x16x16_bf16 v[124:127], v[188:189], v[180:181], v[40:43]
    v_and_b32 v64, 0xffff0000, v116
    v_rcp_f32 v64, v64
    v_lshlrev_b32 v65, 16, v116
    v_mul_f32 v65, -v65, v64
    v_mfma_f32_16x16x16_bf16 v[120:123], v[190:191], v[180:181], v[36:39]
    v_add_f32 v64, 1.0, v64
    v_and_b32 v118, 0xffff0000, v115
    v_rcp_f32 v118, v118
    v_lshlrev_b32 v119, 16, v115
    v_mfma_f32_16x16x16_bf16 v[136:139], v[190:191], v[182:183], v[40:43]
    v_mul_f32 v119, -v119, v118
    v_add_f32 v118, 1.0, v118
    v_and_b32 v10, 0xffff0000, v114
    v_rcp_f32 v10, v10
    v_mfma_f32_16x16x16_bf16 v[132:135], v[192:193], v[182:183], v[36:39]
    v_lshlrev_b32 v11, 16, v114
    v_mul_f32 v11, -v11, v10
    v_add_f32 v10, 1.0, v10
    v_and_b32 v8, 0xffff0000, v113
    v_mfma_f32_16x16x16_bf16 v[148:151], v[192:193], v[184:185], v[48:51]
    v_rcp_f32 v8, v8
    v_lshlrev_b32 v9, 16, v113
    v_mul_f32 v9, -v9, v8
    v_add_f32 v8, 1.0, v8
    v_and_b32 v6, 0xffff0000, v112
    v_mfma_f32_16x16x16_bf16 v[144:147], v[194:195], v[184:185], v[44:47]
    v_rcp_f32 v6, v6
    v_lshlrev_b32 v7, 16, v112
    v_mul_f32 v7, -v7, v6
    v_add_f32 v6, 1.0, v6
    s_waitcnt vmcnt(1)
    v_subrev_u32 v242, s72, v240
    v_cmp_lt_u32 vcc, 15, v242
    s_cbranch_vccnz Lslow_69
Lback_70:
    s_add_u32 s16, s23, 3506176
    s_add_u32 s17, s23, 3538944
    s_add_u32 s18, s23, 3571712
    s_cmp_lg_u32 s71, 0
    s_cbranch_scc1 Lwt_72
    buffer_store_dwordx4 v[244:247], v24, s[52:55], s16 offen
    buffer_store_dwordx4 v[244:247], v24, s[52:55], s17 offen
    buffer_store_dwordx4 v[244:247], v25, s[52:55], s18 offen
Lst_73:
    v_max_f32 v120, v120, v124
    s_add_u32 s24, s23, 1048576
    v_max_f32 v121, v121, v125
    v_max_f32 v122, v122, v126
    v_max_f32 v123, v123, v127
    v_max3_f32 v218, v120, v121, v122
    v_max_f32 v218, v218, v123
    v_max_f32 v132, v132, v136
    v_max_f32 v133, v133, v137
    buffer_load_dwordx4 v[96:99], v20, s[52:55], s24 offen offset:0 sc1
    v_max_f32 v134, v134, v138
    v_max_f32 v135, v135, v139
    v_max3_f32 v228, v132, v133, v134
    v_max_f32 v228, v228, v135
    v_max_f32 v144, v144, v148
    v_max_f32 v145, v145, v149
    v_max_f32 v146, v146, v150
    buffer_load_dwordx4 v[100:103], v20, s[52:55], s24 offen offset:1024 sc1
    v_max_f32 v147, v147, v151
    v_max3_f32 v208, v144, v145, v146
    v_max_f32 v208, v208, v147
    v_mov_b32 v209, v208
    v_permlane16_swap_b32 v218, v228
    s_nop 0
    v_permlane16_swap_b32 v208, v209
    v_max_f32 v218, v218, v228
    buffer_load_dwordx4 v[104:107], v20, s[52:55], s24 offen offset:2048 sc1
    v_mov_b32 v228, v218
    v_max_f32 v208, v208, v209
    v_mov_b32 v209, v208
    v_permlane32_swap_b32 v218, v228
    s_nop 0
    v_permlane32_swap_b32 v208, v209
    v_max_f32 v218, v218, v228
    v_mov_b32 v228, v218
    buffer_load_dwordx4 v[108:111], v20, s[52:55], s24 offen offset:3072 sc1
    v_max_f32 v208, v208, v209
    v_permlane16_swap_b32 v218, v228
    v_mul_f32 v207, v206, v208
    v_pk_fma_f32 v[144:145], v[144:145], v[206:207], v[206:207] op_sel:[0,0,1] op_sel_hi:[1,0,1] neg_lo:[0,0,1] neg_hi:[0,0,1]
    v_pk_fma_f32 v[146:147], v[146:147], v[206:207], v[206:207] op_sel:[0,0,1] op_sel_hi:[1,0,1] neg_lo:[0,0,1] neg_hi:[0,0,1]
    v_exp_f32 v144, v144
    v_exp_f32 v145, v145
    s_add_u32 s24, s23, 1064960
    v_exp_f32 v146, v146
    v_exp_f32 v147, v147
    v_mul_f32 v217, v216, v218
    v_pk_fma_f32 v[120:121], v[120:121], v[216:217], v[216:217] op_sel:[0,0,1] op_sel_hi:[1,0,1] neg_lo:[0,0,1] neg_hi:[0,0,1]
    v_pk_fma_f32 v[122:123], v[122:123], v[216:217], v[216:217] op_sel:[0,0,1] op_sel_hi:[1,0,1] neg_lo:[0,0,1] neg_hi:[0,0,1]
    v_exp_f32 v120, v120
    v_exp_f32 v121, v121
    buffer_load_dwordx4 v[156:159], v20, s[52:55], s24 offen offset:0 sc1
    v_exp_f32 v122, v122
    v_exp_f32 v123, v123
    v_mul_f32 v227, v226, v228
    v_pk_fma_f32 v[132:133], v[132:133], v[226:227], v[226:227] op_sel:[0,0,1] op_sel_hi:[1,0,1] neg_lo:[0,0,1] neg_hi:[0,0,1]
    v_pk_fma_f32 v[134:135], v[134:135], v[226:227], v[226:227] op_sel:[0,0,1] op_sel_hi:[1,0,1] neg_lo:[0,0,1] neg_hi:[0,0,1]
    v_exp_f32 v132, v132
    v_exp_f32 v133, v133
    buffer_load_dwordx4 v[160:163], v20, s[52:55], s24 offen offset:1024 sc1
    v_exp_f32 v134, v134
    v_exp_f32 v135, v135
    v_cvt_pk_bf16_f32 v210, v144, v145
    v_cvt_pk_bf16_f32 v211, v146, v147
    v_and_b32 v154, v52, v210
    v_and_b32 v155, v53, v211
    v_mfma_f32_16x16x16_bf16 v[148:151], v[28:29], v[210:211], 0
    buffer_load_dwordx4 v[164:167], v20, s[52:55], s24 offen offset:2048 sc1
    v_xor_b32 v152, v154, v210
    v_xor_b32 v153, v155, v211
    s_nop 1
    v_mfma_f32_16x16x32_bf16 v[144:147], v[202:205], v[152:155], 0
    v_cvt_pk_bf16_f32 v220, v120, v121
    v_cvt_pk_bf16_f32 v221, v122, v123
    v_and_b32 v130, v52, v220
    buffer_load_dwordx4 v[168:171], v20, s[52:55], s24 offen offset:3072 sc1
    v_and_b32 v131, v53, v221
    v_mfma_f32_16x16x16_bf16 v[124:127], v[28:29], v[220:221], 0
    v_xor_b32 v128, v130, v220
    v_xor_b32 v129, v131, v221
    s_nop 1
    v_mfma_f32_16x16x32_bf16 v[120:123], v[198:201], v[128:131], 0
    v_cvt_pk_bf16_f32 v230, v132, v133
    v_cvt_pk_bf16_f32 v231, v134, v135
    v_and_b32 v142, v52, v230
    v_and_b32 v143, v53, v231
    v_mfma_f32_16x16x16_bf16 v[136:139], v[28:29], v[230:231], 0
    v_xor_b32 v140, v142, v230
    v_xor_b32 v141, v143, v231
    s_nop 1
    v_mfma_f32_16x16x32_bf16 v[132:135], v[200:203], v[140:143], 0
    v_rcp_f32 v148, v148
    v_rcp_f32 v124, v124
    s_nop 0
    v_rcp_f32 v136, v136
    s_waitcnt vmcnt(8)
    v_pk_mul_f32 v[120:121], v[120:121], v[124:125] op_sel_hi:[1,0]
    v_pk_mul_f32 v[122:123], v[122:123], v[124:125] op_sel_hi:[1,0]
    v_cvt_pk_bf16_f32 v128, v120, v121
    v_cvt_pk_bf16_f32 v129, v122, v123
    v_pk_mul_f32 v[132:133], v[132:133], v[136:137] op_sel_hi:[1,0]
    v_pk_mul_f32 v[134:135], v[134:135], v[136:137] op_sel_hi:[1,0]
    v_cvt_pk_bf16_f32 v130, v132, v133
    v_cvt_pk_bf16_f32 v131, v134, v135
    s_add_u32 s18, s23, 1081344
    v_permlane16_swap_b32 v128, v130
    v_permlane16_swap_b32 v129, v131
    v_min_u32 v128, -2, v128
    s_cmp_lg_u32 s71, 0
    s_cbranch_scc1 Lwt_74
    buffer_store_dwordx4 v[128:131], v24, s[52:55], s18 offen
Lst_75:
    v_pk_mul_f32 v[144:145], v[144:145], v[148:149] op_sel_hi:[1,0]
    v_pk_mul_f32 v[146:147], v[146:147], v[148:149] op_sel_hi:[1,0]
    v_cvt_pk_bf16_f32 v152, v144, v145
    v_cvt_pk_bf16_f32 v153, v146, v147
    s_add_u32 s18, s23, 1114112
    v_permlane16_swap_b32 v152, v154
    v_permlane16_swap_b32 v153, v155
    v_min_u32 v152, -2, v152
    s_cmp_lg_u32 s71, 0
    s_cbranch_scc1 Lwt_76
    buffer_store_dwordx4 v[152:155], v25, s[52:55], s18 offen
Lst_77:
    s_waitcnt vmcnt(6)
    v_max3_u32 v252, v96, v100, v104
    v_max_u32 v252, v252, v108
    v_cmp_eq_u32 vcc, -1, v252
    s_cbranch_vccnz Lslow_78
Lback_79:
    v_mfma_f32_16x16x32_bf16 v[216:219], a[196:199], v[96:99], 0
    v_lshlrev_b32 v196, 16, v66
    v_and_b32 v197, 0xffff0000, v66
    v_lshlrev_b32 v198, 16, v67
    v_mfma_f32_16x16x32_bf16 v[216:219], a[212:215], v[100:103], v[216:219]
    v_and_b32 v199, 0xffff0000, v67
    v_fma_f32 v196, v196, v6, v7
    v_mfma_f32_16x16x32_bf16 v[216:219], a[228:231], v[104:107], v[216:219]
    v_fma_f32 v197, v197, v6, v7
    v_fma_f32 v198, v198, v6, v7
    v_fma_f32 v199, v199, v6, v7
    v_mfma_f32_16x16x32_bf16 v[216:219], a[244:247], v[108:111], v[216:219]
    v_lshlrev_b32 v200, 16, v68
    v_and_b32 v201, 0xffff0000, v68
    v_lshlrev_b32 v202, 16, v69
    v_mfma_f32_16x16x32_bf16 v[220:223], a[200:203], v[96:99], 0
    v_and_b32 v203, 0xffff0000, v69
    v_fma_f32 v200, v200, v8, v9
    v_mfma_f32_16x16x32_bf16 v[220:223], a[216:219], v[100:103], v[220:223]
    v_fma_f32 v201, v201, v8, v9
    v_fma_f32 v202, v202, v8, v9
    v_fma_f32 v203, v203, v8, v9
    v_mfma_f32_16x16x32_bf16 v[220:223], a[232:235], v[104:107], v[220:223]
    v_lshlrev_b32 v204, 16, v70
    v_and_b32 v205, 0xffff0000, v70
    ds_write_b128 v12, v[216:219] offset:1024
    v_mfma_f32_16x16x32_bf16 v[220:223], a[248:251], v[108:111], v[220:223]
    v_lshlrev_b32 v206, 16, v71
    v_and_b32 v207, 0xffff0000, v71
    v_fma_f32 v204, v204, v10, v11
    v_mfma_f32_16x16x32_bf16 v[224:227], a[204:207], v[96:99], 0
    v_fma_f32 v205, v205, v10, v11
    v_fma_f32 v206, v206, v10, v11
    v_mfma_f32_16x16x32_bf16 v[224:227], a[220:223], v[100:103], v[224:227]
    v_fma_f32 v207, v207, v10, v11
    v_lshlrev_b32 v208, 16, v72
    v_and_b32 v209, 0xffff0000, v72
    v_mfma_f32_16x16x32_bf16 v[224:227], a[236:239], v[104:107], v[224:227]
    v_lshlrev_b32 v210, 16, v73
    v_and_b32 v211, 0xffff0000, v73
    v_fma_f32 v208, v208, v118, v119
    ds_write_b128 v13, v[220:223] offset:2048
    v_mfma_f32_16x16x32_bf16 v[224:227], a[252:255], v[108:111], v[224:227]
    v_fma_f32 v209, v209, v118, v119
    v_fma_f32 v210, v210, v118, v119
    v_mfma_f32_16x16x32_bf16 v[196:199], a[192:195], v[96:99], v[196:199]
    v_fma_f32 v211, v211, v118, v119
    s_add_u32 s24, s23, 1081344
    buffer_load_dwordx4 v[124:127], v20, s[52:55], s24 offen offset:0 sc1
    v_mfma_f32_16x16x32_bf16 v[196:199], a[208:211], v[100:103], v[196:199]
    buffer_load_dwordx4 v[128:131], v20, s[52:55], s24 offen offset:1024 sc1
    buffer_load_dwordx4 v[132:135], v20, s[52:55], s24 offen offset:2048 sc1
    v_mfma_f32_16x16x32_bf16 v[196:199], a[224:227], v[104:107], v[196:199]
    buffer_load_dwordx4 v[136:139], v20, s[52:55], s24 offen offset:3072 sc1
    s_waitcnt vmcnt(6)
    v_max3_u32 v252, v156, v160, v164
    ds_write_b128 v14, v[224:227] offset:3072
    v_mfma_f32_16x16x32_bf16 v[196:199], a[240:243], v[108:111], v[196:199]
    v_max_u32 v252, v252, v168
    v_cmp_eq_u32 vcc, -1, v252
    s_cbranch_vccnz Lslow_81
Lback_82:
    v_mfma_f32_16x16x32_bf16 v[216:219], a[196:199], v[156:159], 0
    v_lshlrev_b32 v117, 4, v0
    s_add_u32 s18, s86, s11
    v_mfma_f32_16x16x32_bf16 v[216:219], a[212:215], v[160:163], v[216:219]
    v_add_u32 v16, s18, v3
    v_bfe_u32 v253, v0, 3, 4
    v_mfma_f32_16x16x32_bf16 v[216:219], a[228:231], v[164:167], v[216:219]
    v_subrev_u32 v253, s9, v253
    v_and_b32 v253, 15, v253
    v_mfma_f32_16x16x32_bf16 v[216:219], a[244:247], v[168:171], v[216:219]
    v_lshlrev_b32 v11, 10, v253
    v_bfe_u32 v253, v0, 1, 2
    v_mfma_f32_16x16x32_bf16 v[220:223], a[200:203], v[156:159], 0
    v_lshl_add_u32 v11, v253, 8, v11
    v_and_b32 v253, 1, v0
    v_mfma_f32_16x16x32_bf16 v[220:223], a[216:219], v[160:163], v[220:223]
    v_lshl_add_u32 v11, v253, 3, v11
    v_add_u32 v11, 49152, v11
    v_mfma_f32_16x16x32_bf16 v[220:223], a[232:235], v[164:167], v[220:223]
    v_lshlrev_b32 v212, 16, v74
    s_add_u32 s24, s23, 1097728
    ds_write_b128 v12, v[216:219] offset:17408
    v_mfma_f32_16x16x32_bf16 v[220:223], a[248:251], v[168:171], v[220:223]
    v_and_b32 v213, 0xffff0000, v74
    buffer_load_dwordx4 v[140:143], v20, s[52:55], s24 offen offset:0 sc1
    v_mfma_f32_16x16x32_bf16 v[224:227], a[204:207], v[156:159], 0
    v_lshlrev_b32 v214, 16, v75
    v_mfma_f32_16x16x32_bf16 v[224:227], a[220:223], v[160:163], v[224:227]
    v_and_b32 v215, 0xffff0000, v75
    buffer_load_dwordx4 v[144:147], v20, s[52:55], s24 offen offset:1024 sc1
    v_mfma_f32_16x16x32_bf16 v[224:227], a[236:239], v[164:167], v[224:227]
    v_fma_f32 v212, v212, v64, v65
    buffer_load_dwordx4 v[148:151], v20, s[52:55], s24 offen offset:2048 sc1
    ds_write_b128 v13, v[220:223] offset:18432
    v_mfma_f32_16x16x32_bf16 v[224:227], a[252:255], v[168:171], v[224:227]
    v_fma_f32 v213, v213, v64, v65
    v_mfma_f32_16x16x32_bf16 v[200:203], a[192:195], v[156:159], v[200:203]
    v_fma_f32 v214, v214, v64, v65
    buffer_load_dwordx4 v[152:155], v20, s[52:55], s24 offen offset:3072 sc1
    v_mfma_f32_16x16x32_bf16 v[200:203], a[208:211], v[160:163], v[200:203]
    v_fma_f32 v215, v215, v64, v65
    s_waitcnt vmcnt(4)
    v_mfma_f32_16x16x32_bf16 v[200:203], a[224:227], v[164:167], v[200:203]
    v_max3_u32 v252, v124, v128, v132
    v_max_u32 v252, v252, v136
    ds_write_b128 v14, v[224:227] offset:19456
    v_mfma_f32_16x16x32_bf16 v[200:203], a[240:243], v[168:171], v[200:203]
    v_cmp_eq_u32 vcc, -1, v252
    s_cbranch_vccnz Lslow_84
Lback_85:
    v_mfma_f32_16x16x32_bf16 v[216:219], a[196:199], v[124:127], 0
    s_add_u32 s24, s23, 1114112
    buffer_load_dwordx4 v[172:175], v20, s[52:55], s24 offen offset:0 sc1
    buffer_load_dwordx4 v[176:179], v20, s[52:55], s24 offen offset:1024 sc1
    v_mfma_f32_16x16x32_bf16 v[216:219], a[212:215], v[128:131], v[216:219]
    buffer_load_dwordx4 v[180:183], v20, s[52:55], s24 offen offset:2048 sc1
    buffer_load_dwordx4 v[184:187], v20, s[52:55], s24 offen offset:3072 sc1
    v_mfma_f32_16x16x32_bf16 v[216:219], a[228:231], v[132:135], v[216:219]
    v_mfma_f32_16x16x32_bf16 v[216:219], a[244:247], v[136:139], v[216:219]
    s_waitcnt lgkmcnt(0)
    v_mfma_f32_16x16x32_bf16 v[220:223], a[200:203], v[124:127], 0
    s_barrier
    ds_read_b128 v[240:243], v20 offset:1024
    ds_read_b128 v[244:247], v20 offset:2048
    v_mfma_f32_16x16x32_bf16 v[220:223], a[216:219], v[128:131], v[220:223]
    ds_read_b128 v[248:251], v20 offset:3072
    ds_read_b128 v[228:231], v20 offset:17408
    v_mfma_f32_16x16x32_bf16 v[220:223], a[232:235], v[132:135], v[220:223]
    ds_read_b128 v[232:235], v20 offset:18432
    ds_read_b128 v[236:239], v20 offset:19456
    s_waitcnt lgkmcnt(3)
    ds_write_b128 v12, v[216:219] offset:33792
    v_mfma_f32_16x16x32_bf16 v[220:223], a[248:251], v[136:139], v[220:223]
    v_add_f32 v196, v196, v240
    v_add_f32 v197, v197, v241
    v_add_f32 v198, v198, v242
    v_mfma_f32_16x16x32_bf16 v[224:227], a[204:207], v[124:127], 0
    v_add_f32 v199, v199, v243
    v_add_f32 v244, v244, v248
    v_add_f32 v245, v245, v249
    v_mfma_f32_16x16x32_bf16 v[224:227], a[220:223], v[128:131], v[224:227]
    v_add_f32 v246, v246, v250
    v_add_f32 v247, v247, v251
    v_add_f32 v196, v196, v244
    v_add_f32 v197, v197, v245
    v_mfma_f32_16x16x32_bf16 v[224:227], a[236:239], v[132:135], v[224:227]
    v_add_f32 v198, v198, v246
    v_add_f32 v199, v199, v247
    v_cvt_pk_bf16_f32 v196, v196, v197
    ds_write_b128 v13, v[220:223] offset:34816
    v_mfma_f32_16x16x32_bf16 v[224:227], a[252:255], v[136:139], v[224:227]
    v_cvt_pk_bf16_f32 v197, v198, v199
    s_add_u32 s18, s23, 3506176
    v_mfma_f32_16x16x32_bf16 v[204:207], a[192:195], v[124:127], v[204:207]
    v_permlane16_swap_b32 v196, v198
    v_permlane16_swap_b32 v197, v199
    v_mfma_f32_16x16x32_bf16 v[204:207], a[208:211], v[128:131], v[204:207]
    v_min_u32 v196, -2, v196
    s_cmp_lg_u32 s71, 0
    s_cbranch_scc1 Lwt_87
    buffer_store_dwordx4 v[196:199], v25, s[52:55], s18 offen
Lst_88:
    v_mfma_f32_16x16x32_bf16 v[204:207], a[224:227], v[132:135], v[204:207]
    s_waitcnt vmcnt(5)
    v_max3_u32 v252, v140, v144, v148
    ds_write_b128 v14, v[224:227] offset:35840
    v_mfma_f32_16x16x32_bf16 v[204:207], a[240:243], v[136:139], v[204:207]
    v_max_u32 v252, v252, v152
    v_cmp_eq_u32 vcc, -1, v252
    s_cbranch_vccnz Lslow_89
Lback_90:
    v_mfma_f32_16x16x32_bf16 v[216:219], a[196:199], v[140:143], 0
    v_mov_b32 v116, 0
    s_mov_b32 s33, 16384
    v_mfma_f32_16x16x32_bf16 v[216:219], a[212:215], v[144:147], v[216:219]
    buffer_load_dwordx4 v[112:115], v116, s[52:55], s33 offen sc1
    s_waitcnt lgkmcnt(3)
    v_mfma_f32_16x16x32_bf16 v[216:219], a[228:231], v[148:151], v[216:219]
    v_add_f32 v200, v200, v228
    v_add_f32 v201, v201, v229
    v_mfma_f32_16x16x32_bf16 v[216:219], a[244:247], v[152:155], v[216:219]
    v_add_f32 v202, v202, v230
    v_add_f32 v203, v203, v231
    v_mfma_f32_16x16x32_bf16 v[220:223], a[200:203], v[140:143], 0
    v_add_f32 v232, v232, v236
    v_add_f32 v233, v233, v237
    v_mfma_f32_16x16x32_bf16 v[220:223], a[216:219], v[144:147], v[220:223]
    v_add_f32 v234, v234, v238
    v_add_f32 v235, v235, v239
    v_mfma_f32_16x16x32_bf16 v[220:223], a[232:235], v[148:151], v[220:223]
    v_add_f32 v200, v200, v232
    v_add_f32 v201, v201, v233
    ds_write_b128 v12, v[216:219] offset:50176
    v_mfma_f32_16x16x32_bf16 v[220:223], a[248:251], v[152:155], v[220:223]
    v_add_f32 v202, v202, v234
    v_add_f32 v203, v203, v235
    v_mfma_f32_16x16x32_bf16 v[224:227], a[204:207], v[140:143], 0
    v_cvt_pk_bf16_f32 v200, v200, v201
    v_cvt_pk_bf16_f32 v201, v202, v203
    v_mfma_f32_16x16x32_bf16 v[224:227], a[220:223], v[144:147], v[224:227]
    s_add_u32 s18, s23, 3522560
    v_permlane16_swap_b32 v200, v202
    v_mfma_f32_16x16x32_bf16 v[224:227], a[236:239], v[148:151], v[224:227]
    v_permlane16_swap_b32 v201, v203
    ds_write_b128 v13, v[220:223] offset:51200
    v_mfma_f32_16x16x32_bf16 v[224:227], a[252:255], v[152:155], v[224:227]
    v_min_u32 v200, -2, v200
    v_mfma_f32_16x16x32_bf16 v[208:211], a[192:195], v[140:143], v[208:211]
    s_cmp_lg_u32 s71, 0
    s_cbranch_scc1 Lwt_92
    buffer_store_dwordx4 v[200:203], v25, s[52:55], s18 offen
Lst_93:
    v_mfma_f32_16x16x32_bf16 v[208:211], a[208:211], v[144:147], v[208:211]
    s_waitcnt vmcnt(3)
    v_mfma_f32_16x16x32_bf16 v[208:211], a[224:227], v[148:151], v[208:211]
    v_max3_u32 v252, v172, v176, v180
    v_max_u32 v252, v252, v184
    ds_write_b128 v14, v[224:227] offset:52224
    v_mfma_f32_16x16x32_bf16 v[208:211], a[240:243], v[152:155], v[208:211]
    v_cmp_eq_u32 vcc, -1, v252
    s_cbranch_vccnz Lslow_94
Lback_95:
    v_mfma_f32_16x16x32_bf16 v[216:219], a[196:199], v[172:175], 0
    v_mfma_f32_16x16x32_bf16 v[216:219], a[212:215], v[176:179], v[216:219]
    v_mfma_f32_16x16x32_bf16 v[216:219], a[228:231], v[180:183], v[216:219]
    s_waitcnt lgkmcnt(0)
    s_barrier
    v_mfma_f32_16x16x32_bf16 v[216:219], a[244:247], v[184:187], v[216:219]
    ds_read_b128 v[96:99], v20 offset:33792
    ds_read_b128 v[100:103], v20 offset:34816
    v_mfma_f32_16x16x32_bf16 v[220:223], a[200:203], v[172:175], 0
    ds_read_b128 v[104:107], v20 offset:35840
    ds_read_b128 v[240:243], v20 offset:50176
    v_mfma_f32_16x16x32_bf16 v[220:223], a[216:219], v[176:179], v[220:223]
    ds_read_b128 v[244:247], v20 offset:51200
    ds_read_b128 v[248:251], v20 offset:52224
    v_mfma_f32_16x16x32_bf16 v[220:223], a[232:235], v[180:183], v[220:223]
    s_waitcnt lgkmcnt(3)
    v_add_f32 v204, v204, v96
    ds_write_b128 v12, v[216:219] offset:0
    v_mfma_f32_16x16x32_bf16 v[220:223], a[248:251], v[184:187], v[220:223]
    v_add_f32 v205, v205, v97
    v_add_f32 v206, v206, v98
    v_add_f32 v207, v207, v99
    v_mfma_f32_16x16x32_bf16 v[224:227], a[204:207], v[172:175], 0
    v_add_f32 v100, v100, v104
    v_add_f32 v101, v101, v105
    v_mfma_f32_16x16x32_bf16 v[224:227], a[220:223], v[176:179], v[224:227]
    v_add_f32 v102, v102, v106
    v_add_f32 v103, v103, v107
    v_add_f32 v204, v204, v100
    v_mfma_f32_16x16x32_bf16 v[224:227], a[236:239], v[180:183], v[224:227]
    v_add_f32 v205, v205, v101
    v_add_f32 v206, v206, v102
    ds_write_b128 v13, v[220:223] offset:16384
    v_mfma_f32_16x16x32_bf16 v[224:227], a[252:255], v[184:187], v[224:227]
    v_add_f32 v207, v207, v103
    v_cvt_pk_bf16_f32 v204, v204, v205
    v_mfma_f32_16x16x32_bf16 v[212:215], a[192:195], v[172:175], v[212:215]
    v_cvt_pk_bf16_f32 v205, v206, v207
    s_add_u32 s18, s23, 3538944
    v_mfma_f32_16x16x32_bf16 v[212:215], a[208:211], v[176:179], v[212:215]
    v_permlane16_swap_b32 v204, v206
    v_permlane16_swap_b32 v205, v207
    v_mfma_f32_16x16x32_bf16 v[212:215], a[224:227], v[180:183], v[212:215]
    v_min_u32 v204, -2, v204
    ds_write_b128 v14, v[224:227] offset:32768
    v_mfma_f32_16x16x32_bf16 v[212:215], a[240:243], v[184:187], v[212:215]
    s_cmp_lg_u32 s71, 0
    s_cbranch_scc1 Lwt_97
    buffer_store_dwordx4 v[204:207], v25, s[52:55], s18 offen
Lst_98:
    s_waitcnt lgkmcnt(3)
    v_pk_add_f32 v[208:209], v[208:209], v[240:241]
    v_pk_add_f32 v[210:211], v[210:211], v[242:243]
    v_pk_add_f32 v[244:245], v[244:245], v[248:249]
    v_pk_add_f32 v[246:247], v[246:247], v[250:251]
    v_pk_add_f32 v[208:209], v[208:209], v[244:245]
    v_pk_add_f32 v[210:211], v[210:211], v[246:247]
    v_cvt_pk_bf16_f32 v208, v208, v209
    v_cvt_pk_bf16_f32 v209, v210, v211
    s_waitcnt lgkmcnt(0)
    s_barrier
    ds_read_b128 v[228:231], v20 offset:0
    ds_read_b128 v[232:235], v20 offset:16384
    ds_read_b128 v[236:239], v20 offset:32768
    s_add_u32 s18, s23, 3555328
    v_permlane16_swap_b32 v208, v210
    v_permlane16_swap_b32 v209, v211
    v_min_u32 v208, -2, v208
    s_cmp_lg_u32 s71, 0
    s_cbranch_scc1 Lwt_99
    buffer_store_dwordx4 v[208:211], v25, s[52:55], s18 offen
Lst_100:
    s_waitcnt lgkmcnt(0)
    v_pk_add_f32 v[212:213], v[212:213], v[228:229]
    v_pk_add_f32 v[214:215], v[214:215], v[230:231]
    v_pk_add_f32 v[232:233], v[232:233], v[236:237]
    v_pk_add_f32 v[234:235], v[234:235], v[238:239]
    v_pk_add_f32 v[212:213], v[212:213], v[232:233]
    v_pk_add_f32 v[214:215], v[214:215], v[234:235]
    v_cvt_pk_bf16_f32 v212, v212, v213
    v_cvt_pk_bf16_f32 v213, v214, v215
    s_add_u32 s18, s23, 3571712
    v_permlane16_swap_b32 v212, v214
    v_permlane16_swap_b32 v213, v215
    v_min_u32 v212, -2, v212
    s_cmp_lg_u32 s71, 0
    s_cbranch_scc1 Lwt_101
    buffer_store_dwordx4 v[212:215], v25, s[52:55], s18 offen
Lst_102:
    s_cmp_ge_u32 s7, 5
    s_cbranch_scc1 L_aexit
    s_add_u32 s24, s28, 3506176
    s_add_u32 s25, s24, s85
    s_add_u32 s24, s24, s84
    buffer_load_dwordx4 v[156:159], v20, s[52:55], s24 offen offset:0 sc1
    buffer_load_dwordx4 v[160:163], v20, s[52:55], s24 offen offset:1024 sc1
    buffer_load_dwordx4 v[164:167], v20, s[52:55], s25 offen offset:0 sc1
    buffer_load_dwordx4 v[168:171], v20, s[52:55], s25 offen offset:1024 sc1
    s_waitcnt vmcnt(8)
    v_cmp_ne_u32 vcc, s72, v115
    s_cbranch_vccnz Lslow_103
Lback_104:
    v_sub_u32 v200, v16, v112
    v_sub_u32 v201, v16, v113
    v_min_u32 v200, v200, v201
    v_cmp_lt_u32 vcc, 7, v200
    s_nop 0
    s_and_b64 s[20:21], s[20:21], vcc
    s_add_u32 s27, s27, 4096
    s_mov_b32 s70, 1
L_stage:
    s_mov_b32 s39, 200000
    s_waitcnt vmcnt(0)
Lpt_106:
    v_max3_u32 v252, v156, v160, v164
    v_max_u32 v252, v252, v168
    v_cmp_eq_u32 vcc, -1, v252
    s_cbranch_vccz Lptd_107
    s_add_u32 s24, s28, 3506176
    s_add_u32 s25, s24, s85
    s_add_u32 s24, s24, s84
    buffer_load_dwordx4 v[156:159], v20, s[52:55], s24 offen offset:0 sc1
    buffer_load_dwordx4 v[160:163], v20, s[52:55], s24 offen offset:1024 sc1
    buffer_load_dwordx4 v[164:167], v20, s[52:55], s25 offen offset:0 sc1
    buffer_load_dwordx4 v[168:171], v20, s[52:55], s25 offen offset:1024 sc1
    s_sub_u32 s39, s39, 1
    s_waitcnt vmcnt(0)
    s_cbranch_scc0 Lpt_106
Lptd_107:
    v_mfma_f32_16x16x32_bf16 v[172:175], v[156:159], v[156:159], 0
    ds_write_b128 v20, v[156:159] offset:49152
    v_mfma_f32_16x16x32_bf16 v[176:179], v[76:79], v[156:159], 0
    v_mfma_f32_16x16x32_bf16 v[172:175], v[160:163], v[160:163], v[172:175]
    ds_write_b128 v20, v[160:163] offset:50176
    v_mfma_f32_16x16x32_bf16 v[176:179], v[80:83], v[160:163], v[176:179]
    v_mfma_f32_16x16x32_bf16 v[172:175], v[164:167], v[164:167], v[172:175]
    ds_write_b128 v20, v[164:167] offset:51200
    v_mfma_f32_16x16x32_bf16 v[176:179], v[84:87], v[164:167], v[176:179]
    v_mfma_f32_16x16x32_bf16 v[172:175], v[168:171], v[168:171], v[172:175]
    v_mfma_f32_16x16x32_bf16 v[176:179], v[88:91], v[168:171], v[176:179]
    ds_write_b128 v20, v[168:171] offset:52224
    v_lshlrev_b32 v188, 4, v3
    v_add_u32 v188, 155648, v188
    s_nop 3
    v_cndmask_b32 v172, v172, v173, s[66:67]
    v_cndmask_b32 v174, v174, v175, s[66:67]
    v_mov_b32 v179, v92
    v_cndmask_b32 v178, v172, v174, s[68:69]
    s_mov_b64 exec, s[0:1]
    ds_write_b128 v95, v[176:179]
    s_mov_b64 exec, -1
    s_waitcnt lgkmcnt(0)
    s_barrier
    ds_read_b128 v[172:175], v188
    ds_read_b128 v[176:179], v188 offset:1280
    ds_read_b128 v[180:183], v188 offset:2560
    ds_read_b128 v[184:187], v188 offset:3840
    s_waitcnt lgkmcnt(0)
    v_pk_add_f32 v[172:173], v[172:173], v[176:177]
    v_pk_add_f32 v[174:175], v[174:175], v[178:179]
    v_pk_add_f32 v[180:181], v[180:181], v[184:185]
    v_pk_add_f32 v[182:183], v[182:183], v[186:187]
    v_pk_add_f32 v[172:173], v[172:173], v[180:181]
    v_pk_add_f32 v[174:175], v[174:175], v[182:183]
    v_mul_f32 v176, 0x3b000000, v172
    v_mul_f32 v177, 0x3b000000, v174
    v_fma_f32 v177, -v176, v176, v177
    v_max_f32 v177, 0, v177
    v_cvt_pk_bf16_f32 v179, v177, v177
    v_cvt_pk_bf16_f32 v178, v176, v176
    v_and_b32 v179, 0xffff0000, v179
    v_and_b32 v178, 0xffff0000, v178
    v_add_f32 v179, 0x3727c5ac, v179
    v_cvt_pk_bf16_f32 v179, v179, v179
    v_and_b32 v179, 0xffff0000, v179
    v_sqrt_f32 v179, v179
    s_nop 0
    v_cvt_pk_bf16_f32 v179, v179, v179
    v_and_b32 v179, 0xffff0000, v179
    v_rcp_f32 v180, v179
    v_fma_f32 v181, -v178, v175, v173
    s_lshl_b32 s19, s29, 4
    v_mul_f32 v181, v181, v180
    v_add_u32 v186, s19, v3
    v_ashrrev_i32 v182, 31, v181
    v_mov_b32 v185, 0
    v_or_b32 v182, 0x80000000, v182
    v_mov_b32 v187, s72
    v_xor_b32 v181, v181, v182
    v_lshl_or_b32 v183, v117, 20, v117
    v_or_b32 v181, 0xfff, v181
    v_xor_b32 v181, v181, v186
    v_cndmask_b32 v184, 0, v181, s[20:21]
    v_max_u32_dpp v185, v185, v185 quad_perm:[1,0,3,2] row_mask:0xf bank_mask:0xf
    s_nop 0
    v_mov_b32_dpp v186, v184 quad_perm:[1,0,3,2] row_mask:0xf bank_mask:0xf
    v_med3_u32 v185, v184, v186, v185
    v_max_u32 v184, v184, v186
    s_nop 0
    v_max_u32_dpp v185, v185, v185 quad_perm:[2,3,0,1] row_mask:0xf bank_mask:0xf
    v_mov_b32_dpp v186, v184 quad_perm:[2,3,0,1] row_mask:0xf bank_mask:0xf
    v_med3_u32 v185, v184, v186, v185
    v_max_u32 v184, v184, v186
    s_nop 0
    v_max_u32_dpp v185, v185, v185 row_half_mirror row_mask:0xf bank_mask:0xf
    v_mov_b32_dpp v186, v184 row_half_mirror row_mask:0xf bank_mask:0xf
    v_med3_u32 v185, v184, v186, v185
    v_max_u32 v184, v184, v186
    s_nop 0
    v_max_u32_dpp v185, v185, v185 row_mirror row_mask:0xf bank_mask:0xf
    v_mov_b32_dpp v186, v184 row_mirror row_mask:0xf bank_mask:0xf
    v_med3_u32 v185, v184, v186, v185
    v_max_u32 v184, v184, v186
    s_cmp_lg_u32 s70, 0
    s_cbranch_scc1 Lwt_108
    buffer_store_dwordx4 v[184:187], v183, s[52:55], s27 offen
Lst_109:
    v_readfirstlane_b32 s16, v184
    v_readfirstlane_b32 s17, v185
    v_lshrrev_b32 v190, 16, v178
    v_or_b32 v190, v190, v179
    s_cmp_lt_u32 s8, 2
    s_cselect_b32 s16, s16, s17
    s_andn2_b32 s16, 15, s16
    s_lshl_b32 s17, s16, 4
    v_add_u32 v183, s17, v11
    ds_read_b64 v[172:173], v183
    v_readlane_b32 s16, v190, s16
    v_mov_b32 v175, s72
    s_lshl_b32 s18, s19, 8
    s_add_u32 s18, s18, 9076736
    v_mov_b32 v174, s16
    s_waitcnt lgkmcnt(0)
    s_cmp_lg_u32 s70, 0
    s_cbranch_scc1 Lwt_110
    buffer_store_dwordx4 v[172:175], v117, s[52:55], s18 offen
Lst_111:
    v_add_f32 v194, 1.0, v180
    v_mul_f32 v195, -v178, v180
    v_lshlrev_b32 v196, 16, v156
    v_and_b32 v197, 0xffff0000, v156
    v_lshlrev_b32 v198, 16, v157
    v_and_b32 v199, 0xffff0000, v157
    v_lshlrev_b32 v200, 16, v158
    v_and_b32 v201, 0xffff0000, v158
    v_lshlrev_b32 v202, 16, v159
    v_and_b32 v203, 0xffff0000, v159
    v_pk_fma_f32 v[196:197], v[196:197], v[194:195], v[194:195] op_sel:[0,0,1] op_sel_hi:[1,0,1]
    v_pk_fma_f32 v[198:199], v[198:199], v[194:195], v[194:195] op_sel:[0,0,1] op_sel_hi:[1,0,1]
    v_pk_fma_f32 v[200:201], v[200:201], v[194:195], v[194:195] op_sel:[0,0,1] op_sel_hi:[1,0,1]
    v_pk_fma_f32 v[202:203], v[202:203], v[194:195], v[194:195] op_sel:[0,0,1] op_sel_hi:[1,0,1]
    v_cvt_pk_bf16_f32 v156, v196, v197
    v_cvt_pk_bf16_f32 v157, v198, v199
    v_cvt_pk_bf16_f32 v158, v200, v201
    v_cvt_pk_bf16_f32 v159, v202, v203
    v_lshlrev_b32 v196, 16, v160
    v_and_b32 v197, 0xffff0000, v160
    v_lshlrev_b32 v198, 16, v161
    v_and_b32 v199, 0xffff0000, v161
    v_lshlrev_b32 v200, 16, v162
    v_and_b32 v201, 0xffff0000, v162
    v_lshlrev_b32 v202, 16, v163
    v_and_b32 v203, 0xffff0000, v163
    v_pk_fma_f32 v[196:197], v[196:197], v[194:195], v[194:195] op_sel:[0,0,1] op_sel_hi:[1,0,1]
    v_pk_fma_f32 v[198:199], v[198:199], v[194:195], v[194:195] op_sel:[0,0,1] op_sel_hi:[1,0,1]
    v_pk_fma_f32 v[200:201], v[200:201], v[194:195], v[194:195] op_sel:[0,0,1] op_sel_hi:[1,0,1]
    v_pk_fma_f32 v[202:203], v[202:203], v[194:195], v[194:195] op_sel:[0,0,1] op_sel_hi:[1,0,1]
    v_cvt_pk_bf16_f32 v160, v196, v197
    v_cvt_pk_bf16_f32 v161, v198, v199
    v_cvt_pk_bf16_f32 v162, v200, v201
    v_cvt_pk_bf16_f32 v163, v202, v203
    v_lshlrev_b32 v196, 16, v164
    v_and_b32 v197, 0xffff0000, v164
    v_lshlrev_b32 v198, 16, v165
    v_and_b32 v199, 0xffff0000, v165
    v_lshlrev_b32 v200, 16, v166
    v_and_b32 v201, 0xffff0000, v166
    v_lshlrev_b32 v202, 16, v167
    v_and_b32 v203, 0xffff0000, v167
    v_pk_fma_f32 v[196:197], v[196:197], v[194:195], v[194:195] op_sel:[0,0,1] op_sel_hi:[1,0,1]
    v_pk_fma_f32 v[198:199], v[198:199], v[194:195], v[194:195] op_sel:[0,0,1] op_sel_hi:[1,0,1]
    v_pk_fma_f32 v[200:201], v[200:201], v[194:195], v[194:195] op_sel:[0,0,1] op_sel_hi:[1,0,1]
    v_pk_fma_f32 v[202:203], v[202:203], v[194:195], v[194:195] op_sel:[0,0,1] op_sel_hi:[1,0,1]
    v_cvt_pk_bf16_f32 v164, v196, v197
    v_cvt_pk_bf16_f32 v165, v198, v199
    v_cvt_pk_bf16_f32 v166, v200, v201
    v_cvt_pk_bf16_f32 v167, v202, v203
    v_lshlrev_b32 v196, 16, v168
    v_and_b32 v197, 0xffff0000, v168
    v_lshlrev_b32 v198, 16, v169
    v_and_b32 v199, 0xffff0000, v169
    v_lshlrev_b32 v200, 16, v170
    v_and_b32 v201, 0xffff0000, v170
    v_lshlrev_b32 v202, 16, v171
    v_and_b32 v203, 0xffff0000, v171
    v_pk_fma_f32 v[196:197], v[196:197], v[194:195], v[194:195] op_sel:[0,0,1] op_sel_hi:[1,0,1]
    v_pk_fma_f32 v[198:199], v[198:199], v[194:195], v[194:195] op_sel:[0,0,1] op_sel_hi:[1,0,1]
    v_pk_fma_f32 v[200:201], v[200:201], v[194:195], v[194:195] op_sel:[0,0,1] op_sel_hi:[1,0,1]
    v_pk_fma_f32 v[202:203], v[202:203], v[194:195], v[194:195] op_sel:[0,0,1] op_sel_hi:[1,0,1]
    v_cvt_pk_bf16_f32 v168, v196, v197
    v_cvt_pk_bf16_f32 v169, v198, v199
    v_cvt_pk_bf16_f32 v170, v200, v201
    v_cvt_pk_bf16_f32 v171, v202, v203
    v_and_b32 v172, 1023, v16
    v_lshlrev_b32 v172, 11, v172
    v_bfe_u32 v173, v16, 10, 1
    v_lshl_or_b32 v172, v173, 10, v172
    v_lshl_or_b32 v172, v4, 4, v172
    v_mov_b32 v173, 1073741824
    v_cndmask_b32 v172, v173, v172, s[20:21]
    v_cmp_le_u32 vcc, v185, v181
    s_nop 1
    v_cndmask_b32 v176, v173, v172, vcc
    v_cndmask_b32 v177, v172, v173, vcc
    s_lshl_b32 s16, s8, 2
    s_add_u32 s16, s16, s9
    s_add_u32 s17, s16, 0
    s_and_b32 s17, s17, 15
    s_lshl_b32 s90, s17, 6
    s_add_u32 s17, s16, 1
    s_and_b32 s17, s17, 15
    s_lshl_b32 s91, s17, 6
    s_add_u32 s17, s16, 2
    s_and_b32 s17, s17, 15
    s_lshl_b32 s92, s17, 6
    s_add_u32 s17, s16, 3
    s_and_b32 s17, s17, 15
    s_lshl_b32 s93, s17, 6
    buffer_store_dwordx4 v[156:159], v177, s[56:59], s90 offen sc1
    buffer_store_dwordx4 v[160:163], v177, s[56:59], s91 offen sc1
    buffer_store_dwordx4 v[164:167], v177, s[56:59], s92 offen sc1
    buffer_store_dwordx4 v[168:171], v177, s[56:59], s93 offen sc1
    v_mov_b32 v200, 0
    s_lshl_b32 s33, s6, 7
    s_add_u32 s33, s33, 20480
    s_mov_b32 s39, 200000
Lspin_112:
    buffer_load_dwordx4 v[196:199], v200, s[52:55], s33 offen sc1
    s_waitcnt vmcnt(0)
    v_cmp_ne_u32 vcc, s72, v199
    s_cbranch_vccz Ldone_113
    s_sub_u32 s39, s39, 1
    s_cbranch_scc0 Lspin_112
Ldone_113:
    v_cmp_ne_u32 vcc, v196, v181
    s_nop 1
    v_cndmask_b32 v176, v173, v176, vcc
    v_cmp_ne_u32 vcc, v197, v181
    s_nop 1
    v_cndmask_b32 v176, v173, v176, vcc
    buffer_store_dwordx4 v[156:159], v176, s[56:59], s90 offen nt
    buffer_store_dwordx4 v[160:163], v176, s[56:59], s91 offen nt
    buffer_store_dwordx4 v[164:167], v176, s[56:59], s92 offen nt
    buffer_store_dwordx4 v[168:171], v176, s[56:59], s93 offen nt
    s_branch L_fin
L_fix:
    s_waitcnt vmcnt(8)
    s_barrier
    ds_read_b64_tr_b16 a[0:1], v10 offset:0
    ds_read_b64_tr_b16 a[2:3], v10 offset:512
    ds_read_b64_tr_b16 a[4:5], v10 offset:1024
    ds_read_b64_tr_b16 a[6:7], v10 offset:1536
    ds_read_b64_tr_b16 a[8:9], v10 offset:2048
    ds_read_b64_tr_b16 a[10:11], v10 offset:2560
    ds_read_b64_tr_b16 a[12:13], v10 offset:12288
    ds_read_b64_tr_b16 a[14:15], v10 offset:12800
    ds_read_b64_tr_b16 a[16:17], v10 offset:13312
    ds_read_b64_tr_b16 a[18:19], v10 offset:13824
    ds_read_b64_tr_b16 a[20:21], v10 offset:14336
    ds_read_b64_tr_b16 a[22:23], v10 offset:14848
    s_add_u32 m0, s12, 24576
    s_nop 0
    buffer_load_dwordx4 v5, s[44:47], s75 offen offset:0 lds
    buffer_load_dwordx4 v5, s[44:47], s75 offen offset:1024 lds
    buffer_load_dwordx4 v5, s[44:47], s75 offen offset:2048 lds
    s_add_u32 m0, s12, 36864
    s_nop 0
    buffer_load_dwordx4 v5, s[44:47], s76 offen offset:0 lds
    buffer_load_dwordx4 v5, s[44:47], s76 offen offset:1024 lds
    buffer_load_dwordx4 v5, s[44:47], s76 offen offset:2048 lds
    s_add_u32 s17, s3, 4
    s_and_b32 s17, s17, 7
    s_lshl_b32 s34, s17, 7
    s_mul_i32 s81, s17, 196608
    s_add_u32 s82, s81, 98304
    s_add_u32 s17, s3, 5
    s_and_b32 s17, s17, 7
    s_lshl_b32 s35, s17, 7
    s_mul_i32 s83, s17, 196608
    s_add_u32 s90, s83, 98304
    s_add_u32 s17, s3, 6
    s_and_b32 s17, s17, 7
    s_lshl_b32 s36, s17, 7
    s_mul_i32 s91, s17, 196608
    s_add_u32 s92, s91, 98304
    s_add_u32 s17, s3, 7
    s_and_b32 s17, s17, 7
    s_lshl_b32 s37, s17, 7
    s_mul_i32 s93, s17, 196608
    s_add_u32 s94, s93, 98304
    s_cmp_ge_u32 s8, 2
    s_cselect_b32 s100, s35, s34
    s_cselect_b32 s101, s37, s36
    s_add_u32 m0, s12, 49152
    s_nop 0
    buffer_load_dwordx4 v5, s[44:47], s77 offen offset:0 lds
    buffer_load_dwordx4 v5, s[44:47], s77 offen offset:1024 lds
    buffer_load_dwordx4 v5, s[44:47], s77 offen offset:2048 lds
    s_add_u32 m0, s12, 61440
    s_nop 0
    buffer_load_dwordx4 v5, s[44:47], s78 offen offset:0 lds
    buffer_load_dwordx4 v5, s[44:47], s78 offen offset:1024 lds
    buffer_load_dwordx4 v5, s[44:47], s78 offen offset:2048 lds
    s_waitcnt lgkmcnt(0)
    v_mfma_f32_16x16x32_bf16 v[54:57], a[0:3], v[28:31], 0
    v_mfma_f32_16x16x32_bf16 v[58:61], a[4:7], v[28:31], 0
    v_mfma_f32_16x16x32_bf16 v[62:65], v[28:31], a[8:11], 0
    v_mfma_f32_16x16x32_bf16 v[54:57], a[12:15], v[28:31], v[54:57]
    v_mfma_f32_16x16x32_bf16 v[58:61], a[16:19], v[28:31], v[58:61]
    v_mfma_f32_16x16x32_bf16 v[62:65], v[28:31], a[20:23], v[62:65]
    s_waitcnt vmcnt(6)
    s_barrier
    v_readfirstlane_b32 s72, v216
    s_nop 0
    s_mul_i32 s72, s72, 0x9e3779b1
    s_add_u32 s72, s72, 0x7f4a7c15
    s_getreg_b32 s5, hwreg(HW_REG_XCC_ID, 0, 4)
    s_add_u32 s5, s5, s72
    ds_read_b64_tr_b16 a[24:25], v10 offset:24576
    ds_read_b64_tr_b16 a[26:27], v10 offset:25088
    ds_read_b64_tr_b16 a[28:29], v10 offset:25600
    ds_read_b64_tr_b16 a[30:31], v10 offset:26112
    ds_read_b64_tr_b16 a[32:33], v10 offset:26624
    ds_read_b64_tr_b16 a[34:35], v10 offset:27136
    ds_read_b64_tr_b16 a[36:37], v10 offset:36864
    ds_read_b64_tr_b16 a[38:39], v10 offset:37376
    ds_read_b64_tr_b16 a[40:41], v10 offset:37888
    ds_read_b64_tr_b16 a[42:43], v10 offset:38400
    ds_read_b64_tr_b16 a[44:45], v10 offset:38912
    ds_read_b64_tr_b16 a[46:47], v10 offset:39424
    s_add_u32 m0, s12, 0
    s_nop 0
    buffer_load_dwordx4 v5, s[44:47], s79 offen offset:0 lds
    buffer_load_dwordx4 v5, s[44:47], s79 offen offset:1024 lds
    buffer_load_dwordx4 v5, s[44:47], s79 offen offset:2048 lds
    s_add_u32 m0, s12, 12288
    s_nop 0
    buffer_load_dwordx4 v5, s[44:47], s80 offen offset:0 lds
    buffer_load_dwordx4 v5, s[44:47], s80 offen offset:1024 lds
    buffer_load_dwordx4 v5, s[44:47], s80 offen offset:2048 lds
    s_waitcnt lgkmcnt(0)
    v_mfma_f32_16x16x32_bf16 v[54:57], a[24:27], v[28:31], v[54:57]
    v_mfma_f32_16x16x32_bf16 v[58:61], a[28:31], v[28:31], v[58:61]
    v_mfma_f32_16x16x32_bf16 v[62:65], v[28:31], a[32:35], v[62:65]
    v_mfma_f32_16x16x32_bf16 v[54:57], a[36:39], v[28:31], v[54:57]
    v_mfma_f32_16x16x32_bf16 v[58:61], a[40:43], v[28:31], v[58:61]
    v_mfma_f32_16x16x32_bf16 v[62:65], v[28:31], a[44:47], v[62:65]
    s_waitcnt vmcnt(6)
    s_barrier
    ds_read_b64_tr_b16 a[48:49], v10 offset:49152
    ds_read_b64_tr_b16 a[50:51], v10 offset:49664
    ds_read_b64_tr_b16 a[52:53], v10 offset:50176
    ds_read_b64_tr_b16 a[54:55], v10 offset:50688
    ds_read_b64_tr_b16 a[56:57], v10 offset:51200
    ds_read_b64_tr_b16 a[58:59], v10 offset:51712
    ds_read_b64_tr_b16 a[60:61], v10 offset:61440
    ds_read_b64_tr_b16 a[62:63], v10 offset:61952
    ds_read_b64_tr_b16 a[64:65], v10 offset:62464
    ds_read_b64_tr_b16 a[66:67], v10 offset:62976
    ds_read_b64_tr_b16 a[68:69], v10 offset:63488
    ds_read_b64_tr_b16 a[70:71], v10 offset:64000
    s_add_u32 m0, s12, 24576
    s_nop 0
    buffer_load_dwordx4 v5, s[44:47], s81 offen offset:0 lds
    buffer_load_dwordx4 v5, s[44:47], s81 offen offset:1024 lds
    buffer_load_dwordx4 v5, s[44:47], s81 offen offset:2048 lds
    s_add_u32 m0, s12, 36864
    s_nop 0
    buffer_load_dwordx4 v5, s[44:47], s82 offen offset:0 lds
    buffer_load_dwordx4 v5, s[44:47], s82 offen offset:1024 lds
    buffer_load_dwordx4 v5, s[44:47], s82 offen offset:2048 lds
    s_waitcnt lgkmcnt(0)
    v_mfma_f32_16x16x32_bf16 v[54:57], a[48:51], v[28:31], v[54:57]
    v_mfma_f32_16x16x32_bf16 v[58:61], a[52:55], v[28:31], v[58:61]
    v_mfma_f32_16x16x32_bf16 v[62:65], v[28:31], a[56:59], v[62:65]
    v_mfma_f32_16x16x32_bf16 v[54:57], a[60:63], v[28:31], v[54:57]
    v_mfma_f32_16x16x32_bf16 v[58:61], a[64:67], v[28:31], v[58:61]
    v_mfma_f32_16x16x32_bf16 v[62:65], v[28:31], a[68:71], v[62:65]
    s_waitcnt vmcnt(6)
    s_barrier
    ds_read_b64_tr_b16 a[72:73], v10 offset:0
    ds_read_b64_tr_b16 a[74:75], v10 offset:512
    ds_read_b64_tr_b16 a[76:77], v10 offset:1024
    ds_read_b64_tr_b16 a[78:79], v10 offset:1536
    ds_read_b64_tr_b16 a[80:81], v10 offset:2048
    ds_read_b64_tr_b16 a[82:83], v10 offset:2560
    ds_read_b64_tr_b16 a[84:85], v10 offset:12288
    ds_read_b64_tr_b16 a[86:87], v10 offset:12800
    ds_read_b64_tr_b16 a[88:89], v10 offset:13312
    ds_read_b64_tr_b16 a[90:91], v10 offset:13824
    ds_read_b64_tr_b16 a[92:93], v10 offset:14336
    ds_read_b64_tr_b16 a[94:95], v10 offset:14848
    s_add_u32 m0, s12, 49152
    s_nop 0
    buffer_load_dwordx4 v5, s[44:47], s83 offen offset:0 lds
    buffer_load_dwordx4 v5, s[44:47], s83 offen offset:1024 lds
    buffer_load_dwordx4 v5, s[44:47], s83 offen offset:2048 lds
    s_add_u32 m0, s12, 61440
    s_nop 0
    buffer_load_dwordx4 v5, s[44:47], s90 offen offset:0 lds
    buffer_load_dwordx4 v5, s[44:47], s90 offen offset:1024 lds
    buffer_load_dwordx4 v5, s[44:47], s90 offen offset:2048 lds
    s_waitcnt lgkmcnt(0)
    v_mfma_f32_16x16x32_bf16 v[54:57], a[72:75], v[28:31], v[54:57]
    v_mfma_f32_16x16x32_bf16 v[58:61], a[76:79], v[28:31], v[58:61]
    v_mfma_f32_16x16x32_bf16 v[62:65], v[28:31], a[80:83], v[62:65]
    v_mfma_f32_16x16x32_bf16 v[54:57], a[84:87], v[28:31], v[54:57]
    v_mfma_f32_16x16x32_bf16 v[58:61], a[88:91], v[28:31], v[58:61]
    v_mfma_f32_16x16x32_bf16 v[62:65], v[28:31], a[92:95], v[62:65]
    s_waitcnt vmcnt(6)
    s_barrier
    ds_read_b64_tr_b16 a[96:97], v10 offset:24576
    ds_read_b64_tr_b16 a[98:99], v10 offset:25088
    ds_read_b64_tr_b16 a[100:101], v10 offset:25600
    ds_read_b64_tr_b16 a[102:103], v10 offset:26112
    ds_read_b64_tr_b16 a[104:105], v10 offset:26624
    ds_read_b64_tr_b16 a[106:107], v10 offset:27136
    ds_read_b64_tr_b16 a[108:109], v10 offset:36864
    ds_read_b64_tr_b16 a[110:111], v10 offset:37376
    ds_read_b64_tr_b16 a[112:113], v10 offset:37888
    ds_read_b64_tr_b16 a[114:115], v10 offset:38400
    ds_read_b64_tr_b16 a[116:117], v10 offset:38912
    ds_read_b64_tr_b16 a[118:119], v10 offset:39424
    s_add_u32 m0, s12, 0
    s_nop 0
    buffer_load_dwordx4 v5, s[44:47], s91 offen offset:0 lds
    buffer_load_dwordx4 v5, s[44:47], s91 offen offset:1024 lds
    buffer_load_dwordx4 v5, s[44:47], s91 offen offset:2048 lds
    s_add_u32 m0, s12, 12288
    s_nop 0
    buffer_load_dwordx4 v5, s[44:47], s92 offen offset:0 lds
    buffer_load_dwordx4 v5, s[44:47], s92 offen offset:1024 lds
    buffer_load_dwordx4 v5, s[44:47], s92 offen offset:2048 lds
    s_waitcnt lgkmcnt(0)
    v_mfma_f32_16x16x32_bf16 v[54:57], a[96:99], v[28:31], v[54:57]
    v_mfma_f32_16x16x32_bf16 v[58:61], a[100:103], v[28:31], v[58:61]
    v_mfma_f32_16x16x32_bf16 v[62:65], v[28:31], a[104:107], v[62:65]
    v_mfma_f32_16x16x32_bf16 v[54:57], a[108:111], v[28:31], v[54:57]
    v_mfma_f32_16x16x32_bf16 v[58:61], a[112:115], v[28:31], v[58:61]
    v_mfma_f32_16x16x32_bf16 v[62:65], v[28:31], a[116:119], v[62:65]
    s_waitcnt vmcnt(6)
    s_barrier
    ds_read_b64_tr_b16 a[120:121], v10 offset:49152
    ds_read_b64_tr_b16 a[122:123], v10 offset:49664
    ds_read_b64_tr_b16 a[124:125], v10 offset:50176
    ds_read_b64_tr_b16 a[126:127], v10 offset:50688
    ds_read_b64_tr_b16 a[128:129], v10 offset:51200
    ds_read_b64_tr_b16 a[130:131], v10 offset:51712
    ds_read_b64_tr_b16 a[132:133], v10 offset:61440
    ds_read_b64_tr_b16 a[134:135], v10 offset:61952
    ds_read_b64_tr_b16 a[136:137], v10 offset:62464
    ds_read_b64_tr_b16 a[138:139], v10 offset:62976
    ds_read_b64_tr_b16 a[140:141], v10 offset:63488
    ds_read_b64_tr_b16 a[142:143], v10 offset:64000
    s_add_u32 m0, s12, 24576
    s_nop 0
    buffer_load_dwordx4 v5, s[44:47], s93 offen offset:0 lds
    buffer_load_dwordx4 v5, s[44:47], s93 offen offset:1024 lds
    buffer_load_dwordx4 v5, s[44:47], s93 offen offset:2048 lds
    s_add_u32 m0, s12, 36864
    s_nop 0
    buffer_load_dwordx4 v5, s[44:47], s94 offen offset:0 lds
    buffer_load_dwordx4 v5, s[44:47], s94 offen offset:1024 lds
    buffer_load_dwordx4 v5, s[44:47], s94 offen offset:2048 lds
    s_waitcnt lgkmcnt(0)
    v_mfma_f32_16x16x32_bf16 v[54:57], a[120:123], v[28:31], v[54:57]
    v_mfma_f32_16x16x32_bf16 v[58:61], a[124:127], v[28:31], v[58:61]
    v_mfma_f32_16x16x32_bf16 v[62:65], v[28:31], a[128:131], v[62:65]
    v_mfma_f32_16x16x32_bf16 v[54:57], a[132:135], v[28:31], v[54:57]
    v_mfma_f32_16x16x32_bf16 v[58:61], a[136:139], v[28:31], v[58:61]
    v_mfma_f32_16x16x32_bf16 v[62:65], v[28:31], a[140:143], v[62:65]
    s_waitcnt vmcnt(6)
    s_barrier
    ds_read_b64_tr_b16 a[144:145], v10 offset:0
    ds_read_b64_tr_b16 a[146:147], v10 offset:512
    ds_read_b64_tr_b16 a[148:149], v10 offset:1024
    ds_read_b64_tr_b16 a[150:151], v10 offset:1536
    ds_read_b64_tr_b16 a[152:153], v10 offset:2048
    ds_read_b64_tr_b16 a[154:155], v10 offset:2560
    ds_read_b64_tr_b16 a[156:157], v10 offset:12288
    ds_read_b64_tr_b16 a[158:159], v10 offset:12800
    ds_read_b64_tr_b16 a[160:161], v10 offset:13312
    ds_read_b64_tr_b16 a[162:163], v10 offset:13824
    ds_read_b64_tr_b16 a[164:165], v10 offset:14336
    ds_read_b64_tr_b16 a[166:167], v10 offset:14848
    s_add_u32 m0, s88, 131072
    s_mov_b32 s17, 0
    buffer_load_dwordx4 v9, s[48:51], s17 offen offset:0 lds
    s_mov_b32 s17, 7168
    buffer_load_dwordx4 v23, s[48:51], s17 offen offset:1024 lds
    s_mov_b32 s17, 14336
    buffer_load_dwordx4 v9, s[48:51], s17 offen offset:2048 lds
    s_mov_b32 s17, 21504
    buffer_load_dwordx4 v23, s[48:51], s17 offen offset:3072 lds
    s_waitcnt lgkmcnt(0)
    v_mfma_f32_16x16x32_bf16 v[54:57], a[144:147], v[28:31], v[54:57]
    v_mfma_f32_16x16x32_bf16 v[58:61], a[148:151], v[28:31], v[58:61]
    v_mfma_f32_16x16x32_bf16 v[62:65], v[28:31], a[152:155], v[62:65]
    v_mfma_f32_16x16x32_bf16 v[54:57], a[156:159], v[28:31], v[54:57]
    v_mfma_f32_16x16x32_bf16 v[58:61], a[160:163], v[28:31], v[58:61]
    v_mfma_f32_16x16x32_bf16 v[62:65], v[28:31], a[164:167], v[62:65]
    s_waitcnt vmcnt(4)
    s_barrier
    ds_read_b64_tr_b16 a[168:169], v10 offset:24576
    ds_read_b64_tr_b16 a[170:171], v10 offset:25088
    ds_read_b64_tr_b16 a[172:173], v10 offset:25600
    ds_read_b64_tr_b16 a[174:175], v10 offset:26112
    ds_read_b64_tr_b16 a[176:177], v10 offset:26624
    ds_read_b64_tr_b16 a[178:179], v10 offset:27136
    ds_read_b64_tr_b16 a[180:181], v10 offset:36864
    ds_read_b64_tr_b16 a[182:183], v10 offset:37376
    ds_read_b64_tr_b16 a[184:185], v10 offset:37888
    ds_read_b64_tr_b16 a[186:187], v10 offset:38400
    ds_read_b64_tr_b16 a[188:189], v10 offset:38912
    ds_read_b64_tr_b16 a[190:191], v10 offset:39424
    s_waitcnt lgkmcnt(0)
    v_mfma_f32_16x16x32_bf16 v[54:57], a[168:171], v[28:31], v[54:57]
    v_mfma_f32_16x16x32_bf16 v[58:61], a[172:175], v[28:31], v[58:61]
    v_mfma_f32_16x16x32_bf16 v[62:65], v[28:31], a[176:179], v[62:65]
    v_mfma_f32_16x16x32_bf16 v[54:57], a[180:183], v[28:31], v[54:57]
    v_mfma_f32_16x16x32_bf16 v[58:61], a[184:187], v[28:31], v[58:61]
    v_mfma_f32_16x16x32_bf16 v[62:65], v[28:31], a[188:191], v[62:65]
    s_lshl_b32 s18, s7, 2
    s_add_u32 s18, s18, s8
    s_mul_i32 s18, s18, 3072
    s_add_u32 s18, s18, 851968
    v_mov_b32 v239, s72
    v_mov_b32 v243, s72
    v_mov_b32 v247, s72
    v_mov_b32 v236, v54
    v_mov_b32 v237, v55
    v_mov_b32 v238, v56
    v_mov_b32 v240, v57
    v_mov_b32 v241, v58
    v_mov_b32 v242, v59
    v_mov_b32 v244, v60
    v_mov_b32 v245, v61
    v_mov_b32 v246, v62
    buffer_store_dwordx4 v[236:239], v17, s[52:55], s18 offen offset:0 sc1
    buffer_store_dwordx4 v[240:243], v17, s[52:55], s18 offen offset:1024 sc1
    buffer_store_dwordx4 v[244:247], v17, s[52:55], s18 offen offset:2048 sc1
    s_add_u32 m0, s88, 81920
    s_mov_b32 s17, 32768
    buffer_load_dwordx4 v9, s[48:51], s17 offen offset:0 lds
    s_mov_b32 s17, 39936
    buffer_load_dwordx4 v23, s[48:51], s17 offen offset:1024 lds
    s_mov_b32 s17, 47104
    buffer_load_dwordx4 v9, s[48:51], s17 offen offset:2048 lds
    s_mov_b32 s17, 54272
    buffer_load_dwordx4 v23, s[48:51], s17 offen offset:3072 lds
    s_add_u32 m0, s88, 0
    s_mov_b32 s17, 65536
    buffer_load_dwordx4 v9, s[48:51], s17 offen offset:0 lds
    s_mov_b32 s17, 72704
    buffer_load_dwordx4 v23, s[48:51], s17 offen offset:1024 lds
    s_mov_b32 s17, 79872
    buffer_load_dwordx4 v9, s[48:51], s17 offen offset:2048 lds
    s_mov_b32 s17, 87040
    buffer_load_dwordx4 v23, s[48:51], s17 offen offset:3072 lds
    s_add_u32 m0, s88, 16384
    s_mov_b32 s17, 98304
    buffer_load_dwordx4 v9, s[48:51], s17 offen offset:0 lds
    s_mov_b32 s17, 105472
    buffer_load_dwordx4 v23, s[48:51], s17 offen offset:1024 lds
    s_mov_b32 s17, 112640
    buffer_load_dwordx4 v9, s[48:51], s17 offen offset:2048 lds
    s_mov_b32 s17, 119808
    buffer_load_dwordx4 v23, s[48:51], s17 offen offset:3072 lds
    v_mfma_f32_16x16x32_bf16 v[248:251], v[76:79], v[28:31], 0
    v_mfma_f32_16x16x32_bf16 v[248:251], v[80:83], v[28:31], v[248:251]
    v_mfma_f32_16x16x32_bf16 v[248:251], v[84:87], v[28:31], v[248:251]
    v_mfma_f32_16x16x32_bf16 v[248:251], v[88:91], v[28:31], v[248:251]
    s_nop 7
    v_mov_b32 v92, v249
    v_mov_b32 v236, -1
    v_mov_b32 v237, -1
    v_mov_b32 v238, -1
    v_mov_b32 v239, -1
    s_add_u32 s18, s23, 1048576
    buffer_store_dwordx4 v[236:239], v25, s[52:55], s18 offen sc1
    s_add_u32 s18, s23, 3506176
    buffer_store_dwordx4 v[236:239], v25, s[52:55], s18 offen sc1
    s_waitcnt vmcnt(0)
    s_barrier
    s_lshl_b32 s18, s4, 7
    s_add_u32 s18, s18, 36864
    v_mov_b32 v240, s5
    v_lshlrev_b32 v241, 24, v0
    buffer_store_dword v240, v241, s[52:55], s18 offen sc1
    s_mov_b32 s18, 9650176
    v_lshlrev_b32 v246, 4, v0
    buffer_load_dword v254, v246, s[52:55], s18 offen sc1
    v_lshrrev_b32 v242, 4, v0
    v_lshlrev_b32 v242, 14, v242
    v_lshl_add_u32 v242, v3, 7, v242
    v_cmp_gt_u32 vcc, 80, v0
    v_mov_b32 v243, 1073741824
    s_nop 0
    v_cndmask_b32 v242, v243, v242, vcc
    s_lshl_b32 s18, s7, 11
    s_add_u32 s18, s18, s23
    s_add_u32 s19, s18, 1048576
    buffer_load_dword v254, v242, s[52:55], s19 offen sc1
    s_add_u32 s19, s18, 3506176
    buffer_load_dword v254, v242, s[52:55], s19 offen sc1
    v_bfe_u32 v209, v2, 2, 2
    v_lshrrev_b32 v210, 1, v209
    v_and_b32 v211, 1, v4
    v_lshl_or_b32 v210, v211, 1, v210
    v_xor_b32 v210, v210, v1
    v_lshlrev_b32 v208, 10, v4
    v_lshl_add_u32 v208, v209, 7, v208
    v_lshl_add_u32 v208, v210, 5, v208
    v_and_b32 v209, 3, v2
    v_lshl_add_u32 v208, v209, 3, v208
    v_add_u32 v65, s88, v208
    v_add_u32 v208, 0, v65
    v_xor_b32 v209, 32, v208
    v_xor_b32 v210, 64, v208
    v_xor_b32 v211, 96, v208
    ds_read_b64_tr_b16 a[224:225], v208 offset:0
    ds_read_b64_tr_b16 a[226:227], v208 offset:512
    ds_read_b64_tr_b16 a[228:229], v209 offset:0
    ds_read_b64_tr_b16 a[230:231], v209 offset:512
    ds_read_b64_tr_b16 a[232:233], v210 offset:0
    ds_read_b64_tr_b16 a[234:235], v210 offset:512
    ds_read_b64_tr_b16 a[236:237], v211 offset:0
    ds_read_b64_tr_b16 a[238:239], v211 offset:512
    ds_read_b64_tr_b16 a[240:241], v208 offset:16384
    ds_read_b64_tr_b16 a[242:243], v208 offset:16896
    s_waitcnt lgkmcnt(6)
    ds_read_b64_tr_b16 a[244:245], v209 offset:16384
    ds_read_b64_tr_b16 a[246:247], v209 offset:16896
    ds_read_b64_tr_b16 a[248:249], v210 offset:16384
    ds_read_b64_tr_b16 a[250:251], v210 offset:16896
    ds_read_b64_tr_b16 a[252:253], v211 offset:16384
    ds_read_b64_tr_b16 a[254:255], v211 offset:16896
    v_add_u32 v212, 81920, v65
    v_xor_b32 v213, 32, v212
    v_xor_b32 v214, 64, v212
    v_xor_b32 v215, 96, v212
    ds_read_b64_tr_b16 a[192:193], v212 offset:49152
    ds_read_b64_tr_b16 a[194:195], v212 offset:49664
    ds_read_b64_tr_b16 a[196:197], v213 offset:49152
    ds_read_b64_tr_b16 a[198:199], v213 offset:49664
    ds_read_b64_tr_b16 a[200:201], v214 offset:49152
    ds_read_b64_tr_b16 a[202:203], v214 offset:49664
    ds_read_b64_tr_b16 a[204:205], v215 offset:49152
    ds_read_b64_tr_b16 a[206:207], v215 offset:49664
    ds_read_b64_tr_b16 a[208:209], v212 offset:0
    ds_read_b64_tr_b16 a[210:211], v212 offset:512
    s_waitcnt lgkmcnt(6)
    ds_read_b64_tr_b16 a[212:213], v213 offset:0
    ds_read_b64_tr_b16 a[214:215], v213 offset:512
    ds_read_b64_tr_b16 a[216:217], v214 offset:0
    ds_read_b64_tr_b16 a[218:219], v214 offset:512
    ds_read_b64_tr_b16 a[220:221], v215 offset:0
    ds_read_b64_tr_b16 a[222:223], v215 offset:512
    v_xor_b32 v12, 4096, v20
    v_xor_b32 v13, 8192, v20
    v_xor_b32 v14, 12288, v20
    v_min_u32 v201, 29, v2
    v_lshlrev_b32 v201, 7, v201
    s_mov_b32 s33, 36864
    s_mov_b32 s39, 200000
Lspin_114:
    buffer_load_dword v200, v201, s[52:55], s33 offen sc1
    s_waitcnt vmcnt(0)
    v_subrev_u32 v202, s72, v200
    v_cmp_lt_u32 vcc, 15, v202
    s_cbranch_vccz Ldone_115
    s_sub_u32 s39, s39, 1
    s_cbranch_scc0 Lspin_114
Ldone_115:
    v_cmp_ne_u32 vcc, s5, v200
    s_nop 0
    s_mov_b32 s71, vcc_lo
    v_lshlrev_b32 v241, 4, v0
    s_mov_b32 s33, 28672
    buffer_load_dword v254, v241, s[52:55], s33 offen sc1
    v_lshrrev_b32 v200, 2, v3
    v_lshl_add_u32 v200, v1, 2, v200
    v_subrev_u32 v200, s9, v200
    v_and_b32 v200, 15, v200
    v_lshlrev_b32 v200, 10, v200
    v_bfe_u32 v201, v3, 1, 1
    v_lshrrev_b32 v202, 1, v4
    v_lshl_add_u32 v201, v201, 1, v202
    v_lshl_add_u32 v200, v201, 8, v200
    v_and_b32 v201, 1, v4
    v_lshl_add_u32 v247, v201, 3, v200
    v_cmp_eq_u32 s[78:79], 1, v201
    v_and_b32 v201, 1, v3
    v_cmp_eq_u32 s[80:81], 1, v201
    v_lshl_add_u32 v244, v201, 7, v247
    v_add_u32 v244, 16384, v244
    v_xor_b32 v201, 1, v201
    v_lshl_add_u32 v247, v201, 7, v247
    s_lshl_b32 s16, s7, 1
    s_lshr_b32 s17, s8, 1
    s_add_u32 s16, s16, s17
    s_sub_u32 s16, s16, s9
    s_and_b32 s16, s16, 15
    s_lshl_b32 s16, s16, 10
    s_and_b32 s17, s8, 1
    s_lshl_b32 s17, s17, 9
    s_add_u32 s16, s16, s17
    v_lshrrev_b32 v200, 1, v4
    v_lshlrev_b32 v200, 8, v200
    v_lshl_add_u32 v200, v3, 4, v200
    v_and_b32 v201, 1, v4
    v_lshl_add_u32 v200, v201, 3, v200
    v_add_u32 v242, s16, v200
    v_and_b32 v245, 31, v2
    v_lshlrev_b32 v245, 2, v245
    v_add_u32 v245, 160768, v245
    v_cmp_lt_u32 s[82:83], 7, v3
    v_and_b32 v240, 7, v3
    v_lshlrev_b32 v239, 8, v4
    v_lshl_add_u32 v239, v1, 12, v239
    v_lshlrev_b32 v216, 2, v201
    v_sub_u32 v216, v240, v216
    v_lshrrev_b32 v217, 1, v4
    v_lshrrev_b32 v218, 3, v3
    v_xor_b32 v217, v217, v218
    v_lshlrev_b32 v217, 6, v217
    v_subrev_u32 v218, 0, v216
    v_ashrrev_i32 v220, 31, v218
    v_add_u32 v44, v218, v217
    v_add_u32 v48, 8, v44
    v_subrev_u32 v218, 1, v216
    v_ashrrev_i32 v221, 31, v218
    v_add_u32 v45, v218, v217
    v_add_u32 v49, 8, v45
    v_subrev_u32 v218, 2, v216
    v_ashrrev_i32 v222, 31, v218
    v_add_u32 v46, v218, v217
    v_add_u32 v50, 8, v46
    v_subrev_u32 v218, 3, v216
    v_ashrrev_i32 v223, 31, v218
    v_add_u32 v47, v218, v217
    v_add_u32 v51, 8, v47
    v_mov_b32 v218, 0xffff
    v_bfi_b32 v52, v218, v220, v221
    v_bfi_b32 v53, v218, v222, v223
    v_not_b32 v52, v52
    v_not_b32 v53, v53
    s_waitcnt lgkmcnt(0)
    s_barrier
    v_lshlrev_b32 v168, 4, v2
    v_add_u32 v169, 128, v2
    s_mov_b32 s34, 4095
    s_mov_b32 s35, 0
    v_mov_b32 v156, 139
    v_cndmask_b32 v169, v156, v169, s[34:35]
    v_lshlrev_b32 v169, 4, v169
    s_mov_b32 s33, 8192
    s_mov_b32 s39, 200000
Lspin_116:
    buffer_load_dwordx4 v[156:159], v168, s[52:55], s33 offen sc1
    buffer_load_dwordx4 v[160:163], v168, s[52:55], s33 offen offset:1024 sc1
    buffer_load_dwordx4 v[164:167], v169, s[52:55], s33 offen sc1
    s_waitcnt vmcnt(0)
    v_xor_b32 v159, s72, v159
    v_xor_b32 v163, s72, v163
    v_xor_b32 v167, s72, v167
    v_or3_b32 v159, v159, v163, v167
    v_cmp_ne_u32 vcc, 0, v159
    s_cbranch_vccz Ldone_117
    s_sub_u32 s39, s39, 1
    s_cbranch_scc0 Lspin_116
Ldone_117:
    v_cndmask_b32 v164, 0, v164, s[34:35]
    v_cndmask_b32 v165, 0, v165, s[34:35]
    v_max_u32 v157, v157, v161
    v_med3_u32 v157, v156, v160, v157
    v_max_u32 v156, v156, v160
    v_max_u32 v157, v157, v165
    v_med3_u32 v157, v156, v164, v157
    v_max_u32 v156, v156, v164
    s_nop 0
    v_max_u32_dpp v157, v157, v157 quad_perm:[1,0,3,2] row_mask:0xf bank_mask:0xf
    v_mov_b32_dpp v158, v156 quad_perm:[1,0,3,2] row_mask:0xf bank_mask:0xf
    v_med3_u32 v157, v156, v158, v157
    v_max_u32 v156, v156, v158
    s_nop 0
    v_max_u32_dpp v157, v157, v157 quad_perm:[2,3,0,1] row_mask:0xf bank_mask:0xf
    v_mov_b32_dpp v158, v156 quad_perm:[2,3,0,1] row_mask:0xf bank_mask:0xf
    v_med3_u32 v157, v156, v158, v157
    v_max_u32 v156, v156, v158
    s_nop 0
    v_max_u32_dpp v157, v157, v157 row_half_mirror row_mask:0xf bank_mask:0xf
    v_mov_b32_dpp v158, v156 row_half_mirror row_mask:0xf bank_mask:0xf
    v_med3_u32 v157, v156, v158, v157
    v_max_u32 v156, v156, v158
    s_nop 0
    v_max_u32_dpp v157, v157, v157 row_mirror row_mask:0xf bank_mask:0xf
    v_mov_b32_dpp v158, v156 row_mirror row_mask:0xf bank_mask:0xf
    v_med3_u32 v157, v156, v158, v157
    v_max_u32 v156, v156, v158
    v_mov_b32 v158, v156
    v_mov_b32 v159, v157
    s_nop 0
    v_permlane16_swap_b32 v156, v158
    v_permlane16_swap_b32 v157, v159
    v_max_u32 v157, v157, v159
    v_med3_u32 v157, v156, v158, v157
    v_max_u32 v156, v156, v158
    v_mov_b32 v158, v156
    v_mov_b32 v159, v157
    s_nop 0
    v_permlane32_swap_b32 v156, v158
    v_permlane32_swap_b32 v157, v159
    v_max_u32 v157, v157, v159
    v_med3_u32 v157, v156, v158, v157
    v_max_u32 v156, v156, v158
    s_nop 0
    v_readfirstlane_b32 s30, v156
    v_readfirstlane_b32 s31, v157
    s_not_b32 s32, s30
    s_and_b32 s32, s32, 0xfff
    s_lshr_b32 s16, s32, 4
    s_mul_i32 s16, s16, 205
    s_lshr_b32 s16, s16, 10
    s_mul_i32 s16, s16, 7
    s_sub_u32 s74, s32, s16
    s_not_b32 s32, s31
    s_and_b32 s32, s32, 0xfff
    s_lshr_b32 s16, s32, 4
    s_mul_i32 s16, s16, 205
    s_lshr_b32 s16, s16, 10
    s_mul_i32 s16, s16, 7
    s_sub_u32 s75, s32, s16
    v_mov_b32 v200, s74
    v_mov_b32 v201, s75
    v_cndmask_b32 v200, v200, v201, s[82:83]
    v_add_u32 v250, v200, v240
    v_subrev_u32 v248, 8, v250
    v_cndmask_b32 v201, -8, 7, s[78:79]
    v_add_u32 v201, v200, v201
    v_max_i32 v202, 0, v201
    v_min_i32 v202, 0x7ff, v202
    v_subrev_u32 v209, 7, v202
    v_max_i32 v209, 0, v209
    v_mul_u32_u24 v209, 898, v209
    v_lshrrev_b32 v209, 16, v209
    v_lshl_add_u32 v209, v209, 3, v240
    v_lshlrev_b32 v209, 7, v209
    s_mov_b32 s33, 819200
    buffer_load_dword v208, v209, s[52:55], s33 offen sc1
    v_max_i32 v202, 0, v248
    v_min_i32 v202, 0x7ff, v202
    v_subrev_u32 v203, 7, v202
    v_max_i32 v203, 0, v203
    v_mul_u32_u24 v203, 898, v203
    v_lshrrev_b32 v203, 16, v203
    v_mad_u32_u24 v204, v203, 7, v202
    v_lshrrev_b32 v202, 4, v204
    v_and_b32 v203, 15, v204
    v_lshl_add_u32 v202, v202, 14, v239
    v_lshl_add_u32 v206, v203, 4, v202
    v_max_i32 v202, 0, v250
    v_min_i32 v202, 0x7ff, v202
    v_subrev_u32 v203, 7, v202
    v_max_i32 v203, 0, v203
    v_mul_u32_u24 v203, 898, v203
    v_lshrrev_b32 v203, 16, v203
    v_mad_u32_u24 v205, v203, 7, v202
    v_lshrrev_b32 v202, 4, v205
    v_and_b32 v203, 15, v205
    v_lshl_add_u32 v202, v202, 14, v239
    v_lshl_add_u32 v207, v203, 4, v202
    v_cndmask_b32 v203, v204, v205, s[78:79]
    v_lshlrev_b32 v203, 4, v203
    s_mov_b32 s32, 131072
    s_mov_b32 s28, 0
    buffer_load_dwordx4 v[212:215], v203, s[52:55], s32 offen sc1
    v_cndmask_b32 v246, v248, v250, s[78:79]
    v_mov_b32 v220, 0xf149f2ca
    v_and_b32 v221, 1023, v250
    v_min_u32 v221, 7, v221
    v_cmp_lt_u32 vcc, v221, v44
    v_cmp_lt_u32 s[34:35], v221, v48
    s_nop 0
    v_cndmask_b32 v36, 0, v220, vcc
    v_cndmask_b32 v40, 0, v220, s[34:35]
    v_cmp_lt_u32 vcc, v221, v45
    v_cmp_lt_u32 s[34:35], v221, v49
    s_nop 0
    v_cndmask_b32 v37, 0, v220, vcc
    v_cndmask_b32 v41, 0, v220, s[34:35]
    v_cmp_lt_u32 vcc, v221, v46
    v_cmp_lt_u32 s[34:35], v221, v50
    s_nop 0
    v_cndmask_b32 v38, 0, v220, vcc
    v_cndmask_b32 v42, 0, v220, s[34:35]
    v_cmp_lt_u32 vcc, v221, v47
    v_cmp_lt_u32 s[34:35], v221, v51
    s_nop 0
    v_cndmask_b32 v39, 0, v220, vcc
    v_cndmask_b32 v43, 0, v220, s[34:35]
    s_sub_u32 s16, s74, s75
    s_sub_u32 s17, s75, s74
    v_mov_b32 v216, s16
    v_mov_b32 v217, s17
    v_cndmask_b32 v216, v216, v217, s[80:81]
    v_add_u32 v216, 8, v216
    v_cmp_gt_u32 vcc, 16, v216
    v_lshrrev_b32 v217, 3, v216
    v_and_b32 v218, 7, v216
    v_lshl_add_u32 v217, v217, 14, v247
    v_lshl_add_u32 v217, v218, 4, v217
    v_cndmask_b32 v243, v244, v217, vcc
    v_cmp_eq_u32 vcc, s74, v250
    v_cmp_eq_u32 s[34:35], s75, v250
    s_nop 0
    s_or_b64 s[34:35], vcc, s[34:35]
    v_cmp_eq_u32 s[76:77], s75, v246
    v_cmp_eq_u32 vcc, s74, v246
    s_nop 0
    s_or_b64 vcc, vcc, s[76:77]
    v_lshlrev_b32 v200, 2, v2
    v_add_u32 v200, 162048, v200
    v_cndmask_b32 v238, v200, v245, vcc
    s_waitcnt vmcnt(0)
    v_cmp_ne_u32 vcc, s72, v215
    s_cbranch_vccnz Lslow_118
Lback_119:
    ds_write2_b32 v245, v212, v213 offset0:0 offset1:80
    ds_write_b32 v245, v214 offset:640
    ds_read_b32 v204, v93 offset:704
    s_waitcnt lgkmcnt(0)
    v_and_b32 v6, 0xffff0000, v204
    v_rcp_f32 v6, v6
    v_lshlrev_b32 v7, 16, v204
    v_mul_f32 v7, -v7, v6
    v_add_f32 v6, 1.0, v6
    v_cndmask_b32 v6, v6, 1.0, s[34:35]
    v_cndmask_b32 v7, v7, 0, s[34:35]
    s_mov_b32 s39, 200000
Lgf_121:
    v_subrev_u32 v208, s72, v208
    v_cmp_lt_u32 vcc, 15, v208
    s_cbranch_vccz Lgfd_122
    buffer_load_dword v208, v209, s[52:55], s33 offen sc1
    s_sub_u32 s39, s39, 1
    s_waitcnt vmcnt(0)
    s_cbranch_scc0 Lgf_121
Lgfd_122:
    s_add_u32 m0, s88, 0
    s_add_u32 s24, s28, 5963776
    s_add_u32 s25, s24, s89
    s_add_u32 s24, s24, s84
    buffer_load_dwordx4 v206, s[52:55], s24 offen offset:0 sc1 lds
    buffer_load_dwordx4 v206, s[52:55], s24 offen offset:1024 sc1 lds
    buffer_load_dwordx4 v206, s[52:55], s25 offen offset:2048 sc1 lds
    buffer_load_dwordx4 v206, s[52:55], s25 offen offset:3072 sc1 lds
    s_add_u32 m0, s88, 16384
    s_add_u32 s24, s28, 5963776
    s_add_u32 s25, s24, s89
    s_add_u32 s24, s24, s84
    buffer_load_dwordx4 v207, s[52:55], s24 offen offset:0 sc1 lds
    buffer_load_dwordx4 v207, s[52:55], s24 offen offset:1024 sc1 lds
    buffer_load_dwordx4 v207, s[52:55], s25 offen offset:2048 sc1 lds
    buffer_load_dwordx4 v207, s[52:55], s25 offen offset:3072 sc1 lds
    s_mov_b32 s33, 28672
    s_sub_u32 s16, s74, s75
    s_add_u32 s16, s16, 8
    s_cmp_le_u32 s16, 16
    s_cselect_b32 s87, 1, 0
    s_waitcnt vmcnt(4)
    s_barrier
    ds_read_b128 v[156:159], v17 offset:0
    ds_read_b128 v[160:163], v17 offset:1024
    ds_read_b128 v[164:167], v17 offset:2048
    ds_read_b128 v[168:171], v17 offset:3072
    ds_read_b128 v[172:175], v17 offset:4096
    ds_read_b128 v[176:179], v17 offset:5120
    s_waitcnt lgkmcnt(4)
    v_mfma_f32_16x16x32_bf16 v[100:103], a[4:7], v[156:159], 0
    ds_read_b128 v[180:183], v17 offset:6144
    v_mfma_f32_16x16x32_bf16 v[104:107], v[156:159], a[8:11], 0
    v_mfma_f32_16x16x32_bf16 v[100:103], a[16:19], v[160:163], v[100:103]
    ds_read_b128 v[156:159], v17 offset:7168
    v_mfma_f32_16x16x32_bf16 v[104:107], v[160:163], a[20:23], v[104:107]
    s_waitcnt lgkmcnt(4)
    v_mfma_f32_16x16x32_bf16 v[100:103], a[28:31], v[164:167], v[100:103]
    ds_read_b128 v[160:163], v17 offset:8192
    v_mfma_f32_16x16x32_bf16 v[104:107], v[164:167], a[32:35], v[104:107]
    v_mfma_f32_16x16x32_bf16 v[100:103], a[40:43], v[168:171], v[100:103]
    ds_read_b128 v[164:167], v17 offset:9216
    v_mfma_f32_16x16x32_bf16 v[104:107], v[168:171], a[44:47], v[104:107]
    s_waitcnt lgkmcnt(4)
    v_mfma_f32_16x16x32_bf16 v[100:103], a[52:55], v[172:175], v[100:103]
    ds_read_b128 v[168:171], v17 offset:10240
    v_mfma_f32_16x16x32_bf16 v[104:107], v[172:175], a[56:59], v[104:107]
    v_mfma_f32_16x16x32_bf16 v[100:103], a[64:67], v[176:179], v[100:103]
    ds_read_b128 v[172:175], v17 offset:11264
    v_mfma_f32_16x16x32_bf16 v[104:107], v[176:179], a[68:71], v[104:107]
    s_waitcnt lgkmcnt(4)
    v_mfma_f32_16x16x32_bf16 v[100:103], a[76:79], v[180:183], v[100:103]
    ds_read_b128 v[176:179], v17 offset:12288
    v_mfma_f32_16x16x32_bf16 v[104:107], v[180:183], a[80:83], v[104:107]
    v_mfma_f32_16x16x32_bf16 v[100:103], a[88:91], v[156:159], v[100:103]
    ds_read_b128 v[180:183], v17 offset:13312
    v_mfma_f32_16x16x32_bf16 v[104:107], v[156:159], a[92:95], v[104:107]
    s_waitcnt lgkmcnt(4)
    v_mfma_f32_16x16x32_bf16 v[100:103], a[100:103], v[160:163], v[100:103]
    ds_read_b128 v[156:159], v17 offset:14336
    v_mfma_f32_16x16x32_bf16 v[104:107], v[160:163], a[104:107], v[104:107]
    v_mfma_f32_16x16x32_bf16 v[100:103], a[112:115], v[164:167], v[100:103]
    ds_read_b128 v[160:163], v17 offset:15360
    v_mfma_f32_16x16x32_bf16 v[104:107], v[164:167], a[116:119], v[104:107]
    s_waitcnt lgkmcnt(4)
    v_mfma_f32_16x16x32_bf16 v[100:103], a[124:127], v[168:171], v[100:103]
    v_mfma_f32_16x16x32_bf16 v[104:107], v[168:171], a[128:131], v[104:107]
    v_mfma_f32_16x16x32_bf16 v[100:103], a[136:139], v[172:175], v[100:103]
    v_mfma_f32_16x16x32_bf16 v[104:107], v[172:175], a[140:143], v[104:107]
    s_waitcnt lgkmcnt(2)
    v_mfma_f32_16x16x32_bf16 v[100:103], a[148:151], v[176:179], v[100:103]
    v_mfma_f32_16x16x32_bf16 v[104:107], v[176:179], a[152:155], v[104:107]
    v_mfma_f32_16x16x32_bf16 v[100:103], a[160:163], v[180:183], v[100:103]
    v_mfma_f32_16x16x32_bf16 v[104:107], v[180:183], a[164:167], v[104:107]
    s_waitcnt lgkmcnt(0)
    v_mfma_f32_16x16x32_bf16 v[100:103], a[172:175], v[156:159], v[100:103]
    v_mfma_f32_16x16x32_bf16 v[104:107], v[156:159], a[176:179], v[104:107]
    v_mfma_f32_16x16x32_bf16 v[100:103], a[184:187], v[160:163], v[100:103]
    v_mfma_f32_16x16x32_bf16 v[104:107], v[160:163], a[188:191], v[104:107]
    s_waitcnt vmcnt(0)
    s_barrier
    s_mov_b32 s39, 200000
Lspin_123:
    buffer_load_dwordx4 v[204:207], v241, s[52:55], s33 offen sc1
    s_waitcnt vmcnt(0)
    v_cmp_ne_u32 vcc, s72, v207
    s_cbranch_vccz Ldone_124
    s_sub_u32 s39, s39, 1
    s_cbranch_scc0 Lspin_123
Ldone_124:
    ds_write_b64 v244, v[204:205]
    s_cmp_lg_u32 s87, 0
    s_cbranch_scc1 L_fix_redo
    s_waitcnt lgkmcnt(0)
    s_barrier
L_fix_noredo:
    ds_read_b128 v[176:179], v20 offset:16384
    ds_read_b128 v[180:183], v20 offset:17408
    ds_read_b128 v[184:187], v20 offset:18432
    ds_read_b128 v[188:191], v20 offset:19456
    ds_read_b64 v[66:67], v242 offset:16384
    ds_read_b128 v[156:159], v17 offset:16384
    ds_read_b128 v[160:163], v17 offset:17408
    ds_read_b128 v[164:167], v17 offset:18432
    ds_read_b128 v[168:171], v17 offset:19456
    s_waitcnt lgkmcnt(2)
    v_mfma_f32_16x16x32_bf16 v[108:111], a[0:3], v[156:159], 0
    s_waitcnt lgkmcnt(5)
    v_mfma_f32_16x16x32_bf16 v[192:195], v[176:179], v[176:179], 0
    v_mfma_f32_16x16x32_bf16 v[196:199], v[76:79], v[176:179], 0
    v_mfma_f32_16x16x32_bf16 v[192:195], v[180:183], v[180:183], v[192:195]
    v_mfma_f32_16x16x32_bf16 v[196:199], v[80:83], v[180:183], v[196:199]
    v_mfma_f32_16x16x32_bf16 v[192:195], v[184:187], v[184:187], v[192:195]
    v_mfma_f32_16x16x32_bf16 v[196:199], v[84:87], v[184:187], v[196:199]
    v_mfma_f32_16x16x32_bf16 v[192:195], v[188:191], v[188:191], v[192:195]
    v_mfma_f32_16x16x32_bf16 v[196:199], v[88:91], v[188:191], v[196:199]
    v_lshlrev_b32 v208, 4, v3
    v_add_u32 v208, 155648, v208
    ds_read_b128 v[172:175], v17 offset:20480
    v_mfma_f32_16x16x32_bf16 v[112:115], a[4:7], v[156:159], 0
    v_mfma_f32_16x16x32_bf16 v[116:119], v[156:159], a[8:11], 0
    s_nop 1
    v_cndmask_b32 v192, v192, v193, s[66:67]
    v_cndmask_b32 v194, v194, v195, s[66:67]
    v_mfma_f32_16x16x32_bf16 v[108:111], a[12:15], v[160:163], v[108:111]
    v_mov_b32 v199, v92
    v_cndmask_b32 v198, v192, v194, s[68:69]
    ds_read_b128 v[156:159], v17 offset:21504
    v_mfma_f32_16x16x32_bf16 v[112:115], a[16:19], v[160:163], v[112:115]
    s_mov_b64 exec, s[0:1]
    ds_write_b128 v95, v[196:199]
    s_mov_b64 exec, -1
    v_mfma_f32_16x16x32_bf16 v[116:119], v[160:163], a[20:23], v[116:119]
    s_waitcnt lgkmcnt(3)
    v_mfma_f32_16x16x32_bf16 v[108:111], a[24:27], v[164:167], v[108:111]
    ds_read_b128 v[160:163], v17 offset:22528
    v_mfma_f32_16x16x32_bf16 v[112:115], a[28:31], v[164:167], v[112:115]
    s_waitcnt lgkmcnt(0)
    s_barrier
    v_mfma_f32_16x16x32_bf16 v[116:119], v[164:167], a[32:35], v[116:119]
    ds_read_b128 v[192:195], v208
    ds_read_b128 v[196:199], v208 offset:1280
    ds_read_b128 v[200:203], v208 offset:2560
    v_mfma_f32_16x16x32_bf16 v[108:111], a[36:39], v[168:171], v[108:111]
    ds_read_b128 v[204:207], v208 offset:3840
    ds_read_b128 v[164:167], v17 offset:23552
    v_mfma_f32_16x16x32_bf16 v[112:115], a[40:43], v[168:171], v[112:115]
    v_mfma_f32_16x16x32_bf16 v[116:119], v[168:171], a[44:47], v[116:119]
    s_waitcnt lgkmcnt(7)
    v_mfma_f32_16x16x32_bf16 v[108:111], a[48:51], v[172:175], v[108:111]
    s_waitcnt lgkmcnt(1)
    ds_read_b128 v[168:171], v17 offset:24576
    v_mfma_f32_16x16x32_bf16 v[112:115], a[52:55], v[172:175], v[112:115]
    v_add_f32 v192, v192, v196
    v_add_f32 v194, v194, v198
    v_add_f32 v200, v200, v204
    v_mfma_f32_16x16x32_bf16 v[116:119], v[172:175], a[56:59], v[116:119]
    v_add_f32 v202, v202, v206
    v_add_f32 v192, v192, v200
    v_add_f32 v194, v194, v202
    v_mfma_f32_16x16x32_bf16 v[108:111], a[60:63], v[156:159], v[108:111]
    v_mul_f32 v196, 0x3b000000, v192
    v_mul_f32 v197, 0x3b000000, v194
    ds_read_b128 v[172:175], v17 offset:25600
    v_mfma_f32_16x16x32_bf16 v[112:115], a[64:67], v[156:159], v[112:115]
    v_fma_f32 v197, -v196, v196, v197
    v_max_f32 v197, 0, v197
    v_mfma_f32_16x16x32_bf16 v[116:119], v[156:159], a[68:71], v[116:119]
    v_cvt_pk_bf16_f32 v199, v197, v197
    v_cvt_pk_bf16_f32 v198, v196, v196
    s_waitcnt lgkmcnt(2)
    v_mfma_f32_16x16x32_bf16 v[108:111], a[72:75], v[160:163], v[108:111]
    v_and_b32 v199, 0xffff0000, v199
    ds_read_b128 v[156:159], v17 offset:26624
    v_mfma_f32_16x16x32_bf16 v[112:115], a[76:79], v[160:163], v[112:115]
    v_and_b32 v198, 0xffff0000, v198
    v_add_f32 v199, 0x3727c5ac, v199
    v_mfma_f32_16x16x32_bf16 v[116:119], v[160:163], a[80:83], v[116:119]
    v_cvt_pk_bf16_f32 v199, v199, v199
    v_and_b32 v199, 0xffff0000, v199
    v_mfma_f32_16x16x32_bf16 v[108:111], a[84:87], v[164:167], v[108:111]
    v_sqrt_f32 v199, v199
    ds_read_b128 v[160:163], v17 offset:27648
    v_mfma_f32_16x16x32_bf16 v[112:115], a[88:91], v[164:167], v[112:115]
    v_cvt_pk_bf16_f32 v199, v199, v199
    v_and_b32 v199, 0xffff0000, v199
    v_mfma_f32_16x16x32_bf16 v[116:119], v[164:167], a[92:95], v[116:119]
    v_rcp_f32 v200, v199
    s_waitcnt lgkmcnt(2)
    v_mfma_f32_16x16x32_bf16 v[108:111], a[96:99], v[168:171], v[108:111]
    v_sub_f32 v201, 0, v198
    v_mov_b32_dpp v202, v200 row_newbcast:0 row_mask:0xf bank_mask:0xf
    ds_read_b128 v[164:167], v17 offset:28672
    v_mfma_f32_16x16x32_bf16 v[112:115], a[100:103], v[168:171], v[112:115]
    v_mov_b32_dpp v203, v201 row_newbcast:0 row_mask:0xf bank_mask:0xf
    v_mov_b32_dpp v204, v200 row_newbcast:8 row_mask:0xf bank_mask:0xf
    v_mfma_f32_16x16x32_bf16 v[116:119], v[168:171], a[104:107], v[116:119]
    v_mov_b32_dpp v205, v201 row_newbcast:8 row_mask:0xf bank_mask:0xf
    v_cndmask_b32 v202, v202, v204, s[76:77]
    v_mfma_f32_16x16x32_bf16 v[108:111], a[108:111], v[172:175], v[108:111]
    v_cndmask_b32 v203, v203, v205, s[76:77]
    ds_write2_b32 v238, v202, v203 offset0:0 offset1:80
    ds_read_b128 v[168:171], v17 offset:29696
    v_mfma_f32_16x16x32_bf16 v[112:115], a[112:115], v[172:175], v[112:115]
    ds_read2_b32 v[216:217], v93 offset0:0 offset1:80
    ds_read_b128 v[218:221], v94 offset:0
    v_mfma_f32_16x16x32_bf16 v[116:119], v[172:175], a[116:119], v[116:119]
    ds_read_b128 v[222:225], v94 offset:320
    s_waitcnt lgkmcnt(6)
    v_mfma_f32_16x16x32_bf16 v[108:111], a[120:123], v[156:159], v[108:111]
    ds_read2_b32 v[226:227], v93 offset0:16 offset1:96
    ds_read_b128 v[228:231], v94 offset:64
    ds_read_b128 v[172:175], v17 offset:30720
    v_mfma_f32_16x16x32_bf16 v[112:115], a[124:127], v[156:159], v[112:115]
    ds_read_b128 v[232:235], v94 offset:384
    v_mfma_f32_16x16x32_bf16 v[116:119], v[156:159], a[128:131], v[116:119]
    v_mfma_f32_16x16x32_bf16 v[108:111], a[132:135], v[160:163], v[108:111]
    ds_read_b128 v[156:159], v17 offset:31744
    v_mfma_f32_16x16x32_bf16 v[112:115], a[136:139], v[160:163], v[112:115]
    s_waitcnt lgkmcnt(5)
    v_fmac_f32 v100, v58, v217
    v_fmac_f32 v101, v59, v217
    v_mfma_f32_16x16x32_bf16 v[116:119], v[160:163], a[140:143], v[116:119]
    v_fmac_f32 v102, v60, v217
    v_fmac_f32 v103, v61, v217
    s_waitcnt lgkmcnt(8)
    v_mfma_f32_16x16x32_bf16 v[108:111], a[144:147], v[164:167], v[108:111]
    v_mul_f32 v100, v100, v216
    v_mul_f32 v101, v101, v216
    v_mul_f32 v102, v102, v216
    v_mfma_f32_16x16x32_bf16 v[112:115], a[148:151], v[164:167], v[112:115]
    v_mul_f32 v103, v103, v216
    v_fmac_f32 v104, v62, v222
    v_fmac_f32 v105, v62, v223
    v_mfma_f32_16x16x32_bf16 v[116:119], v[164:167], a[152:155], v[116:119]
    v_fmac_f32 v106, v62, v224
    v_fmac_f32 v107, v62, v225
    v_mul_f32 v104, v104, v218
    v_mfma_f32_16x16x32_bf16 v[108:111], a[156:159], v[168:171], v[108:111]
    v_mul_f32 v105, v105, v219
    v_mul_f32 v106, v106, v220
    v_mul_f32 v107, v107, v221
    v_mfma_f32_16x16x32_bf16 v[112:115], a[160:163], v[168:171], v[112:115]
    v_cvt_pk_bf16_f32 v180, v100, v101
    v_cvt_pk_bf16_f32 v181, v102, v103
    v_mfma_f32_16x16x32_bf16 v[116:119], v[168:171], a[164:167], v[116:119]
    v_cvt_pk_bf16_f32 v184, v104, v105
    v_cvt_pk_bf16_f32 v185, v106, v107
    s_waitcnt lgkmcnt(0)
    v_mfma_f32_16x16x32_bf16 v[108:111], a[168:171], v[172:175], v[108:111]
    v_mfma_f32_16x16x32_bf16 v[112:115], a[172:175], v[172:175], v[112:115]
    v_mfma_f32_16x16x32_bf16 v[116:119], v[172:175], a[176:179], v[116:119]
    v_mfma_f32_16x16x32_bf16 v[108:111], a[180:183], v[156:159], v[108:111]
    v_mfma_f32_16x16x32_bf16 v[112:115], a[184:187], v[156:159], v[112:115]
    v_mfma_f32_16x16x32_bf16 v[116:119], v[156:159], a[188:191], v[116:119]
    s_waitcnt lgkmcnt(1)
    s_nop 5
    v_pk_fma_f32 v[112:113], v[58:59], v[226:227], v[112:113] op_sel:[0,1,0] op_sel_hi:[1,1,1]
    v_pk_fma_f32 v[114:115], v[60:61], v[226:227], v[114:115] op_sel:[0,1,0] op_sel_hi:[1,1,1]
    v_pk_fma_f32 v[108:109], v[54:55], v[226:227], v[108:109] op_sel:[0,1,0] op_sel_hi:[1,1,1]
    v_pk_fma_f32 v[110:111], v[56:57], v[226:227], v[110:111] op_sel:[0,1,0] op_sel_hi:[1,1,1]
    v_pk_fma_f32 v[116:117], v[62:63], v[232:233], v[116:117]
    v_pk_fma_f32 v[118:119], v[62:63], v[234:235], v[118:119]
    v_pk_mul_f32 v[112:113], v[112:113], v[226:227] op_sel_hi:[1,0]
    v_pk_mul_f32 v[114:115], v[114:115], v[226:227] op_sel_hi:[1,0]
    v_pk_mul_f32 v[116:117], v[116:117], v[228:229]
    v_pk_mul_f32 v[118:119], v[118:119], v[230:231]
    v_cvt_pk_bf16_f32 v178, v108, v109
    v_cvt_pk_bf16_f32 v179, v110, v111
    v_cvt_pk_bf16_f32 v182, v112, v113
    v_cvt_pk_bf16_f32 v183, v114, v115
    v_cvt_pk_bf16_f32 v186, v116, v117
    v_cvt_pk_bf16_f32 v187, v118, v119
    v_mul_f32 v226, 0x3eb8aa3b, v226
    v_mfma_f32_16x16x16_bf16 v[112:115], v[180:181], v[178:179], v[40:43]
    v_mfma_f32_16x16x16_bf16 v[108:111], v[182:183], v[178:179], v[36:39]
    s_nop 7
    v_max_f32 v108, v108, v112
    v_max_f32 v109, v109, v113
    v_max_f32 v110, v110, v114
    v_max_f32 v111, v111, v115
    v_max3_f32 v228, v108, v109, v110
    v_max_f32 v228, v228, v111
    v_mov_b32 v229, v228
    s_nop 1
    v_permlane16_swap_b32 v228, v229
    v_max_f32 v228, v228, v229
    v_mov_b32 v229, v228
    s_nop 1
    v_permlane32_swap_b32 v228, v229
    v_max_f32 v228, v228, v229
    v_mul_f32 v227, v226, v228
    v_pk_fma_f32 v[108:109], v[108:109], v[226:227], v[226:227] op_sel:[0,0,1] op_sel_hi:[1,0,1] neg_lo:[0,0,1] neg_hi:[0,0,1]
    v_pk_fma_f32 v[110:111], v[110:111], v[226:227], v[226:227] op_sel:[0,0,1] op_sel_hi:[1,0,1] neg_lo:[0,0,1] neg_hi:[0,0,1]
    v_exp_f32 v108, v108
    v_exp_f32 v109, v109
    v_exp_f32 v110, v110
    v_exp_f32 v111, v111
    v_cvt_pk_bf16_f32 v230, v108, v109
    v_cvt_pk_bf16_f32 v231, v110, v111
    v_and_b32 v118, v52, v230
    v_and_b32 v119, v53, v231
    v_mfma_f32_16x16x16_bf16 v[112:115], v[28:29], v[230:231], 0
    v_xor_b32 v116, v118, v230
    v_xor_b32 v117, v119, v231
    s_nop 1
    v_mfma_f32_16x16x32_bf16 v[108:111], v[184:187], v[116:119], 0
    s_nop 2
    v_rcp_f32 v112, v112
    s_nop 3
    v_pk_mul_f32 v[108:109], v[108:109], v[112:113] op_sel_hi:[1,0]
    v_pk_mul_f32 v[110:111], v[110:111], v[112:113] op_sel_hi:[1,0]
    v_cvt_pk_bf16_f32 v116, v108, v109
    v_cvt_pk_bf16_f32 v117, v110, v111
    s_add_u32 s18, s23, 1048576
    v_permlane16_swap_b32 v116, v118
    v_permlane16_swap_b32 v117, v119
    v_min_u32 v116, -2, v116
    s_cmp_lg_u32 s71, 0
    s_cbranch_scc1 Lwt_125
    buffer_store_dwordx4 v[116:119], v25, s[52:55], s18 offen
Lst_126:
    s_add_u32 s24, s23, 1048576
    buffer_load_dwordx4 v[156:159], v20, s[52:55], s24 offen offset:0 sc1
    buffer_load_dwordx4 v[160:163], v20, s[52:55], s24 offen offset:1024 sc1
    buffer_load_dwordx4 v[164:167], v20, s[52:55], s24 offen offset:2048 sc1
    buffer_load_dwordx4 v[168:171], v20, s[52:55], s24 offen offset:3072 sc1
    v_lshlrev_b32 v196, 16, v66
    v_and_b32 v197, 0xffff0000, v66
    v_lshlrev_b32 v198, 16, v67
    v_and_b32 v199, 0xffff0000, v67
    v_pk_fma_f32 v[196:197], v[196:197], v[6:7], v[6:7] op_sel:[0,0,1] op_sel_hi:[1,0,1]
    v_pk_fma_f32 v[198:199], v[198:199], v[6:7], v[6:7] op_sel:[0,0,1] op_sel_hi:[1,0,1]
    s_mov_b32 s28, s23
    s_mov_b32 s29, 140
    s_mov_b32 s27, 14592
    s_mov_b32 s70, s71
    v_cmp_gt_u32 s[20:21], 8, v3
    v_subrev_u32 v200, s74, v250
    v_cmp_lt_u32 vcc, 7, v200
    s_nop 0
    s_or_b64 s[20:21], s[20:21], vcc
    v_cmp_gt_u32 vcc, 0x800, v250
    s_nop 0
    s_and_b64 s[20:21], s[20:21], vcc
    v_mov_b32 v16, v250
    v_lshlrev_b32 v117, 4, v0
    v_bfe_u32 v253, v0, 3, 4
    v_subrev_u32 v253, s9, v253
    v_and_b32 v253, 15, v253
    v_lshlrev_b32 v11, 10, v253
    v_bfe_u32 v253, v0, 1, 2
    v_lshl_add_u32 v11, v253, 8, v11
    v_and_b32 v253, 1, v0
    v_lshl_add_u32 v11, v253, 3, v11
    v_add_u32 v11, 49152, v11
    s_mov_b32 s39, 200000
    s_waitcnt vmcnt(0)
Lpt_127:
    v_max3_u32 v252, v156, v160, v164
    v_max_u32 v252, v252, v168
    v_cmp_eq_u32 vcc, -1, v252
    s_cbranch_vccz Lptd_128
    s_add_u32 s24, s23, 1048576
    buffer_load_dwordx4 v[156:159], v20, s[52:55], s24 offen offset:0 sc1
    buffer_load_dwordx4 v[160:163], v20, s[52:55], s24 offen offset:1024 sc1
    buffer_load_dwordx4 v[164:167], v20, s[52:55], s24 offen offset:2048 sc1
    buffer_load_dwordx4 v[168:171], v20, s[52:55], s24 offen offset:3072 sc1
    s_sub_u32 s39, s39, 1
    s_waitcnt vmcnt(0)
    s_cbranch_scc0 Lpt_127
Lptd_128:
    v_mfma_f32_16x16x32_bf16 v[216:219], a[196:199], v[156:159], 0
    v_mfma_f32_16x16x32_bf16 v[216:219], a[212:215], v[160:163], v[216:219]
    v_mfma_f32_16x16x32_bf16 v[216:219], a[228:231], v[164:167], v[216:219]
    v_mfma_f32_16x16x32_bf16 v[216:219], a[244:247], v[168:171], v[216:219]
    v_mfma_f32_16x16x32_bf16 v[220:223], a[200:203], v[156:159], 0
    v_mfma_f32_16x16x32_bf16 v[220:223], a[216:219], v[160:163], v[220:223]
    v_mfma_f32_16x16x32_bf16 v[220:223], a[232:235], v[164:167], v[220:223]
    s_nop 4
    ds_write_b128 v12, v[216:219] offset:33792
    v_mfma_f32_16x16x32_bf16 v[220:223], a[248:251], v[168:171], v[220:223]
    v_mfma_f32_16x16x32_bf16 v[224:227], a[204:207], v[156:159], 0
    v_mfma_f32_16x16x32_bf16 v[224:227], a[220:223], v[160:163], v[224:227]
    v_mfma_f32_16x16x32_bf16 v[224:227], a[236:239], v[164:167], v[224:227]
    s_nop 4
    ds_write_b128 v13, v[220:223] offset:34816
    v_mfma_f32_16x16x32_bf16 v[224:227], a[252:255], v[168:171], v[224:227]
    v_mfma_f32_16x16x32_bf16 v[196:199], a[192:195], v[156:159], v[196:199]
    v_mfma_f32_16x16x32_bf16 v[196:199], a[208:211], v[160:163], v[196:199]
    v_mfma_f32_16x16x32_bf16 v[196:199], a[224:227], v[164:167], v[196:199]
    s_nop 4
    ds_write_b128 v14, v[224:227] offset:35840
    v_mfma_f32_16x16x32_bf16 v[196:199], a[240:243], v[168:171], v[196:199]
    s_waitcnt lgkmcnt(0)
    s_barrier
    ds_read_b128 v[228:231], v20 offset:33792
    ds_read_b128 v[232:235], v20 offset:34816
    ds_read_b128 v[236:239], v20 offset:35840
    s_waitcnt lgkmcnt(0)
    s_nop 1
    v_pk_add_f32 v[196:197], v[196:197], v[228:229]
    v_pk_add_f32 v[198:199], v[198:199], v[230:231]
    v_pk_add_f32 v[232:233], v[232:233], v[236:237]
    v_pk_add_f32 v[234:235], v[234:235], v[238:239]
    v_pk_add_f32 v[196:197], v[196:197], v[232:233]
    v_pk_add_f32 v[198:199], v[198:199], v[234:235]
    v_cvt_pk_bf16_f32 v196, v196, v197
    v_cvt_pk_bf16_f32 v197, v198, v199
    s_add_u32 s18, s23, 3506176
    v_permlane16_swap_b32 v196, v198
    v_permlane16_swap_b32 v197, v199
    v_min_u32 v196, -2, v196
    s_cmp_lg_u32 s71, 0
    s_cbranch_scc1 Lwt_129
    buffer_store_dwordx4 v[196:199], v25, s[52:55], s18 offen
Lst_130:
    s_cmp_lg_u32 s7, 0
    s_cbranch_scc1 L_fin
    s_add_u32 s24, s28, 3506176
    s_add_u32 s25, s24, s85
    s_add_u32 s24, s24, s84
    buffer_load_dwordx4 v[156:159], v20, s[52:55], s24 offen offset:0 sc1
    buffer_load_dwordx4 v[160:163], v20, s[52:55], s24 offen offset:1024 sc1
    buffer_load_dwordx4 v[164:167], v20, s[52:55], s25 offen offset:0 sc1
    buffer_load_dwordx4 v[168:171], v20, s[52:55], s25 offen offset:1024 sc1
    s_branch L_stage
L_ffn:
    s_sub_u32 s7, s4, 8
    s_mov_b32 s46, 1572864
    s_mov_b32 s47, 0x20000
    s_mov_b32 s50, 524288
    s_mov_b32 s51, 0x20000
    s_cmp_ge_u32 s7, 22
    s_cbranch_scc1 L_idle
    s_lshl_b32 s16, s7, 8
    v_add_u32 v30, s16, v0
    v_add_u32 v31, -1536, v30
    v_add_u32 v32, 10752, v30
    v_min_u32 v31, v31, v32
    v_lshlrev_b32 v31, 7, v31
    v_add_u32 v32, 4096, v30
    v_lshlrev_b32 v32, 7, v32
    v_add_u32 v33, 9728, v30
    v_lshlrev_b32 v33, 7, v33
    v_lshrrev_b32 v34, 10, v30
    v_lshl_or_b32 v33, v34, 24, v33
    s_waitcnt lgkmcnt(0)
    buffer_load_dword v35, v31, s[44:47], 0 offen
    buffer_load_dword v36, v32, s[44:47], 0 offen
    buffer_load_dword v37, v33, s[44:47], 0 offen
    s_load_dwordx2 s[40:41], s[0:1], 40
    s_load_dwordx2 s[44:45], s[0:1], 48
    s_load_dwordx2 s[48:49], s[0:1], 56
    s_mov_b32 s42, 1409024
    s_mov_b32 s43, 0x20000
    s_mov_b32 s46, 1409024
    s_mov_b32 s47, 0x20000
    s_mov_b32 s50, 1409024
    s_mov_b32 s51, 0x20000
    v_mov_b32 v20, 0
    buffer_load_dword v21, v20, s[52:55], 0 offen sc1
    v_mov_b32 v24, -1
    v_mov_b32 v25, -1
    v_mov_b32 v26, -1
    v_mov_b32 v27, -1
    v_lshlrev_b32 v5, 4, v0
    s_lshl_b32 s23, s7, 12
    s_add_u32 s16, s23, 262144
    s_add_u32 s17, s23, 393216
    buffer_store_dwordx4 v[24:27], v5, s[52:55], s16 offen sc1
    buffer_store_dwordx4 v[24:27], v5, s[52:55], s17 offen sc1
    v_lshrrev_b32 v10, 3, v2
    v_and_b32 v11, 7, v2
    v_bfe_u32 v12, v10, 1, 1
    v_and_b32 v13, 1, v1
    v_lshl_or_b32 v12, v13, 1, v12
    v_lshlrev_b32 v12, 1, v12
    v_xor_b32 v12, v12, v11
    v_lshl_add_u32 v13, v1, 3, v10
    v_mul_u32_u24 v6, 2752, v13
    v_lshl_add_u32 v6, v12, 4, v6
    s_lshl_b32 s10, s7, 7
    v_add_u32 v6, s10, v6
    v_lshlrev_b32 v7, 10, v13
    v_lshl_add_u32 v7, v12, 4, v7
    s_lshl_b32 s12, s7, 16
    v_add_u32 v7, s12, v7
    v_add_u32 v22, 32768, v7
    s_lshl_b32 s13, s8, 10
    s_waitcnt lgkmcnt(0)
    s_add_u32 m0, s13, 0
    s_mov_b32 s17, 0
    buffer_load_dwordx4 v6, s[40:43], s17 offen lds
    s_add_u32 m0, s13, 4096
    s_mov_b32 s17, 88064
    buffer_load_dwordx4 v6, s[40:43], s17 offen lds
    s_add_u32 m0, s13, 8192
    s_mov_b32 s17, 176128
    buffer_load_dwordx4 v6, s[40:43], s17 offen lds
    s_add_u32 m0, s13, 12288
    s_mov_b32 s17, 264192
    buffer_load_dwordx4 v6, s[40:43], s17 offen lds
    s_add_u32 m0, s13, 16384
    s_mov_b32 s17, 352256
    buffer_load_dwordx4 v6, s[40:43], s17 offen lds
    s_add_u32 m0, s13, 20480
    s_mov_b32 s17, 440320
    buffer_load_dwordx4 v6, s[40:43], s17 offen lds
    s_add_u32 m0, s13, 24576
    s_mov_b32 s17, 528384
    buffer_load_dwordx4 v6, s[40:43], s17 offen lds
    s_add_u32 m0, s13, 28672
    s_mov_b32 s17, 616448
    buffer_load_dwordx4 v6, s[40:43], s17 offen lds
    s_add_u32 m0, s13, 32768
    s_mov_b32 s17, 704512
    buffer_load_dwordx4 v6, s[40:43], s17 offen lds
    s_add_u32 m0, s13, 36864
    s_mov_b32 s17, 792576
    buffer_load_dwordx4 v6, s[40:43], s17 offen lds
    s_add_u32 m0, s13, 40960
    s_mov_b32 s17, 880640
    buffer_load_dwordx4 v6, s[40:43], s17 offen lds
    s_add_u32 m0, s13, 45056
    s_mov_b32 s17, 968704
    buffer_load_dwordx4 v6, s[40:43], s17 offen lds
    s_add_u32 m0, s13, 49152
    s_mov_b32 s17, 1056768
    buffer_load_dwordx4 v6, s[40:43], s17 offen lds
    s_add_u32 m0, s13, 53248
    s_mov_b32 s17, 1144832
    buffer_load_dwordx4 v6, s[40:43], s17 offen lds
    s_add_u32 m0, s13, 57344
    s_mov_b32 s17, 1232896
    buffer_load_dwordx4 v6, s[40:43], s17 offen lds
    s_add_u32 m0, s13, 61440
    s_mov_b32 s17, 1320960
    buffer_load_dwordx4 v6, s[40:43], s17 offen lds
    s_add_u32 m0, s13, 65536
    s_mov_b32 s17, 0
    buffer_load_dwordx4 v6, s[44:47], s17 offen lds
    s_add_u32 m0, s13, 69632
    s_mov_b32 s17, 88064
    buffer_load_dwordx4 v6, s[44:47], s17 offen lds
    s_add_u32 m0, s13, 73728
    s_mov_b32 s17, 176128
    buffer_load_dwordx4 v6, s[44:47], s17 offen lds
    s_add_u32 m0, s13, 77824
    s_mov_b32 s17, 264192
    buffer_load_dwordx4 v6, s[44:47], s17 offen lds
    s_add_u32 m0, s13, 81920
    s_mov_b32 s17, 352256
    buffer_load_dwordx4 v6, s[44:47], s17 offen lds
    s_add_u32 m0, s13, 86016
    s_mov_b32 s17, 440320
    buffer_load_dwordx4 v6, s[44:47], s17 offen lds
    s_add_u32 m0, s13, 90112
    s_mov_b32 s17, 528384
    buffer_load_dwordx4 v6, s[44:47], s17 offen lds
    s_add_u32 m0, s13, 94208
    s_mov_b32 s17, 616448
    buffer_load_dwordx4 v6, s[44:47], s17 offen lds
    s_add_u32 m0, s13, 98304
    s_mov_b32 s17, 704512
    buffer_load_dwordx4 v6, s[44:47], s17 offen lds
    s_add_u32 m0, s13, 102400
    s_mov_b32 s17, 792576
    buffer_load_dwordx4 v6, s[44:47], s17 offen lds
    s_add_u32 m0, s13, 106496
    s_mov_b32 s17, 880640
    buffer_load_dwordx4 v6, s[44:47], s17 offen lds
    s_add_u32 m0, s13, 110592
    s_mov_b32 s17, 968704
    buffer_load_dwordx4 v6, s[44:47], s17 offen lds
    s_add_u32 m0, s13, 114688
    s_mov_b32 s17, 1056768
    buffer_load_dwordx4 v6, s[44:47], s17 offen lds
    s_add_u32 m0, s13, 118784
    s_mov_b32 s17, 1144832
    buffer_load_dwordx4 v6, s[44:47], s17 offen lds
    s_add_u32 m0, s13, 122880
    s_mov_b32 s17, 1232896
    buffer_load_dwordx4 v6, s[44:47], s17 offen lds
    s_add_u32 m0, s13, 126976
    s_mov_b32 s17, 1320960
    buffer_load_dwordx4 v6, s[44:47], s17 offen lds
    v_bfe_u32 v10, v2, 2, 2
    v_and_b32 v11, 3, v2
    v_lshrrev_b32 v12, 1, v10
    v_and_b32 v13, 1, v4
    v_lshl_or_b32 v12, v13, 1, v12
    v_lshlrev_b32 v14, 10, v4
    v_lshl_add_u32 v14, v10, 7, v14
    v_lshl_add_u32 v14, v11, 3, v14
    v_xor_b32 v13, v12, v1
    v_lshl_add_u32 v8, v13, 5, v14
    v_add_u32 v9, 65536, v8
    v_lshl_add_u32 v14, v12, 5, v14
    v_lshl_add_u32 v14, v1, 13, v14
    v_xor_b32 v15, 32, v14
    v_xor_b32 v16, 64, v14
    v_xor_b32 v17, 96, v14
    v_mov_b32 v24, 0
    v_mov_b32 v25, 0
    v_mov_b32 v26, 0
    v_mov_b32 v27, 0
    v_add_u32 v18, 135168, v5
    ds_write_b128 v18, v[24:27]
    s_waitcnt vmcnt(32)
    v_readfirstlane_b32 s72, v21
    s_nop 0
    s_mul_i32 s72, s72, 0x9e3779b1
    s_add_u32 s72, s72, 0x7f4a7c15
    s_getreg_b32 s5, hwreg(HW_REG_XCC_ID, 0, 4)
    s_add_u32 s5, s5, s72
    s_waitcnt vmcnt(16) lgkmcnt(0)
    s_barrier
    s_lshl_b32 s16, s4, 7
    s_add_u32 s16, s16, 36864
    v_mov_b32 v20, s5
    v_mov_b32 v21, 1073741824
    v_cmp_eq_u32 vcc, 0, v0
    s_nop 1
    v_cndmask_b32 v19, v21, v0, vcc
    buffer_store_dword v20, v19, s[52:55], s16 offen sc1
    ds_read_b64_tr_b16 a[0:1], v8 offset:0
    ds_read_b64_tr_b16 a[2:3], v8 offset:512
    ds_read_b64_tr_b16 a[4:5], v8 offset:4096
    ds_read_b64_tr_b16 a[6:7], v8 offset:4608
    ds_read_b64_tr_b16 a[8:9], v8 offset:8192
    ds_read_b64_tr_b16 a[10:11], v8 offset:8704
    ds_read_b64_tr_b16 a[12:13], v8 offset:12288
    ds_read_b64_tr_b16 a[14:15], v8 offset:12800
    ds_read_b64_tr_b16 a[16:17], v8 offset:16384
    ds_read_b64_tr_b16 a[18:19], v8 offset:16896
    ds_read_b64_tr_b16 a[20:21], v8 offset:20480
    ds_read_b64_tr_b16 a[22:23], v8 offset:20992
    s_waitcnt lgkmcnt(4)
    ds_read_b64_tr_b16 a[24:25], v8 offset:24576
    ds_read_b64_tr_b16 a[26:27], v8 offset:25088
    ds_read_b64_tr_b16 a[28:29], v8 offset:28672
    ds_read_b64_tr_b16 a[30:31], v8 offset:29184
    ds_read_b64_tr_b16 a[32:33], v8 offset:32768
    ds_read_b64_tr_b16 a[34:35], v8 offset:33280
    ds_read_b64_tr_b16 a[36:37], v8 offset:36864
    ds_read_b64_tr_b16 a[38:39], v8 offset:37376
    ds_read_b64_tr_b16 a[40:41], v8 offset:40960
    ds_read_b64_tr_b16 a[42:43], v8 offset:41472
    ds_read_b64_tr_b16 a[44:45], v8 offset:45056
    ds_read_b64_tr_b16 a[46:47], v8 offset:45568
    s_waitcnt lgkmcnt(4)
    ds_read_b64_tr_b16 a[48:49], v8 offset:49152
    ds_read_b64_tr_b16 a[50:51], v8 offset:49664
    ds_read_b64_tr_b16 a[52:53], v8 offset:53248
    ds_read_b64_tr_b16 a[54:55], v8 offset:53760
    ds_read_b64_tr_b16 a[56:57], v8 offset:57344
    ds_read_b64_tr_b16 a[58:59], v8 offset:57856
    ds_read_b64_tr_b16 a[60:61], v8 offset:61440
    ds_read_b64_tr_b16 a[62:63], v8 offset:61952
    s_waitcnt lgkmcnt(0)
    s_barrier
    s_add_u32 m0, s13, 0
    s_mov_b32 s17, 0
    buffer_load_dwordx4 v7, s[48:51], s17 offen lds
    s_add_u32 m0, s13, 4096
    s_mov_b32 s17, 128
    buffer_load_dwordx4 v7, s[48:51], s17 offen lds
    s_add_u32 m0, s13, 8192
    s_mov_b32 s17, 256
    buffer_load_dwordx4 v7, s[48:51], s17 offen lds
    s_add_u32 m0, s13, 12288
    s_mov_b32 s17, 384
    buffer_load_dwordx4 v7, s[48:51], s17 offen lds
    s_add_u32 m0, s13, 16384
    s_mov_b32 s17, 512
    buffer_load_dwordx4 v7, s[48:51], s17 offen lds
    s_add_u32 m0, s13, 20480
    s_mov_b32 s17, 640
    buffer_load_dwordx4 v7, s[48:51], s17 offen lds
    s_add_u32 m0, s13, 24576
    s_mov_b32 s17, 768
    buffer_load_dwordx4 v7, s[48:51], s17 offen lds
    s_add_u32 m0, s13, 28672
    s_mov_b32 s17, 896
    buffer_load_dwordx4 v7, s[48:51], s17 offen lds
    s_add_u32 m0, s13, 32768
    s_mov_b32 s17, 0
    buffer_load_dwordx4 v22, s[48:51], s17 offen lds
    s_add_u32 m0, s13, 36864
    s_mov_b32 s17, 128
    buffer_load_dwordx4 v22, s[48:51], s17 offen lds
    s_add_u32 m0, s13, 40960
    s_mov_b32 s17, 256
    buffer_load_dwordx4 v22, s[48:51], s17 offen lds
    s_add_u32 m0, s13, 45056
    s_mov_b32 s17, 384
    buffer_load_dwordx4 v22, s[48:51], s17 offen lds
    s_add_u32 m0, s13, 49152
    s_mov_b32 s17, 512
    buffer_load_dwordx4 v22, s[48:51], s17 offen lds
    s_add_u32 m0, s13, 53248
    s_mov_b32 s17, 640
    buffer_load_dwordx4 v22, s[48:51], s17 offen lds
    s_add_u32 m0, s13, 57344
    s_mov_b32 s17, 768
    buffer_load_dwordx4 v22, s[48:51], s17 offen lds
    s_add_u32 m0, s13, 61440
    s_mov_b32 s17, 896
    buffer_load_dwordx4 v22, s[48:51], s17 offen lds
    s_waitcnt vmcnt(17)
    s_barrier
    ds_read_b64_tr_b16 a[64:65], v9 offset:0
    ds_read_b64_tr_b16 a[66:67], v9 offset:512
    ds_read_b64_tr_b16 a[68:69], v9 offset:4096
    ds_read_b64_tr_b16 a[70:71], v9 offset:4608
    ds_read_b64_tr_b16 a[72:73], v9 offset:8192
    ds_read_b64_tr_b16 a[74:75], v9 offset:8704
    ds_read_b64_tr_b16 a[76:77], v9 offset:12288
    ds_read_b64_tr_b16 a[78:79], v9 offset:12800
    ds_read_b64_tr_b16 a[80:81], v9 offset:16384
    ds_read_b64_tr_b16 a[82:83], v9 offset:16896
    ds_read_b64_tr_b16 a[84:85], v9 offset:20480
    ds_read_b64_tr_b16 a[86:87], v9 offset:20992
    s_waitcnt lgkmcnt(4)
    ds_read_b64_tr_b16 a[88:89], v9 offset:24576
    ds_read_b64_tr_b16 a[90:91], v9 offset:25088
    ds_read_b64_tr_b16 a[92:93], v9 offset:28672
    ds_read_b64_tr_b16 a[94:95], v9 offset:29184
    ds_read_b64_tr_b16 a[96:97], v9 offset:32768
    ds_read_b64_tr_b16 a[98:99], v9 offset:33280
    ds_read_b64_tr_b16 a[100:101], v9 offset:36864
    ds_read_b64_tr_b16 a[102:103], v9 offset:37376
    ds_read_b64_tr_b16 a[104:105], v9 offset:40960
    ds_read_b64_tr_b16 a[106:107], v9 offset:41472
    ds_read_b64_tr_b16 a[108:109], v9 offset:45056
    ds_read_b64_tr_b16 a[110:111], v9 offset:45568
    s_waitcnt lgkmcnt(4)
    ds_read_b64_tr_b16 a[112:113], v9 offset:49152
    ds_read_b64_tr_b16 a[114:115], v9 offset:49664
    ds_read_b64_tr_b16 a[116:117], v9 offset:53248
    ds_read_b64_tr_b16 a[118:119], v9 offset:53760
    ds_read_b64_tr_b16 a[120:121], v9 offset:57344
    ds_read_b64_tr_b16 a[122:123], v9 offset:57856
    ds_read_b64_tr_b16 a[124:125], v9 offset:61440
    ds_read_b64_tr_b16 a[126:127], v9 offset:61952
    s_waitcnt lgkmcnt(0)
    s_waitcnt vmcnt(0)
    s_barrier
    ds_read_b64_tr_b16 a[128:129], v14 offset:0
    ds_read_b64_tr_b16 a[130:131], v14 offset:512
    ds_read_b64_tr_b16 a[132:133], v14 offset:32768
    ds_read_b64_tr_b16 a[134:135], v14 offset:33280
    ds_read_b64_tr_b16 a[136:137], v15 offset:0
    ds_read_b64_tr_b16 a[138:139], v15 offset:512
    ds_read_b64_tr_b16 a[140:141], v15 offset:32768
    ds_read_b64_tr_b16 a[142:143], v15 offset:33280
    ds_read_b64_tr_b16 a[144:145], v16 offset:0
    ds_read_b64_tr_b16 a[146:147], v16 offset:512
    ds_read_b64_tr_b16 a[148:149], v16 offset:32768
    ds_read_b64_tr_b16 a[150:151], v16 offset:33280
    s_waitcnt lgkmcnt(4)
    ds_read_b64_tr_b16 a[152:153], v17 offset:0
    ds_read_b64_tr_b16 a[154:155], v17 offset:512
    ds_read_b64_tr_b16 a[156:157], v17 offset:32768
    ds_read_b64_tr_b16 a[158:159], v17 offset:33280
    ds_read_b64_tr_b16 a[160:161], v14 offset:4096
    ds_read_b64_tr_b16 a[162:163], v14 offset:4608
    ds_read_b64_tr_b16 a[164:165], v14 offset:36864
    ds_read_b64_tr_b16 a[166:167], v14 offset:37376
    ds_read_b64_tr_b16 a[168:169], v15 offset:4096
    ds_read_b64_tr_b16 a[170:171], v15 offset:4608
    ds_read_b64_tr_b16 a[172:173], v15 offset:36864
    ds_read_b64_tr_b16 a[174:175], v15 offset:37376
    s_waitcnt lgkmcnt(4)
    ds_read_b64_tr_b16 a[176:177], v16 offset:4096
    ds_read_b64_tr_b16 a[178:179], v16 offset:4608
    ds_read_b64_tr_b16 a[180:181], v16 offset:36864
    ds_read_b64_tr_b16 a[182:183], v16 offset:37376
    ds_read_b64_tr_b16 a[184:185], v17 offset:4096
    ds_read_b64_tr_b16 a[186:187], v17 offset:4608
    ds_read_b64_tr_b16 a[188:189], v17 offset:36864
    ds_read_b64_tr_b16 a[190:191], v17 offset:37376
    s_waitcnt lgkmcnt(0)
    v_lshlrev_b32 v10, 3, v0
    v_add_u32 v10, 131072, v10
    v_and_b32 v20, 1, v3
    v_lshlrev_b32 v11, 5, v4
    v_lshl_add_u32 v11, v20, 4, v11
    v_add_u32 v11, 131072, v11
    v_lshrrev_b32 v21, 1, v4
    v_lshl_add_u32 v21, v1, 1, v21
    v_lshlrev_b32 v12, 9, v21
    v_lshl_add_u32 v12, v3, 4, v12
    v_and_b32 v21, 1, v4
    v_lshl_add_u32 v12, v21, 3, v12
    v_add_u32 v12, 135392, v12
    v_lshlrev_b32 v13, 9, v4
    v_lshl_add_u32 v13, v3, 4, v13
    v_add_u32 v13, 135168, v13
    v_lshrrev_b32 v14, 2, v0
    v_and_b32 v20, 1, v0
    v_lshl_add_u32 v14, v14, 1, v20
    v_lshlrev_b32 v14, 4, v14
    v_bfe_u32 v20, v0, 1, 1
    v_cmp_eq_u32 s[66:67], 1, v20
    s_lshl_b32 s16, s7, 2
    s_add_u32 s16, s16, s8
    s_cmp_lt_u32 s16, 86
    s_cselect_b32 s16, 2, 0
    v_cmp_gt_u32 s[64:65], s16, v3
    s_cmp_eq_u32 s7, 0
    s_cselect_b32 s16, 0, 1073741824
    v_or_b32 v19, s16, v19
    s_add_u32 s16, s23, 262144
    s_add_u32 s17, s23, 393216
    buffer_load_dwordx4 v[24:27], v5, s[52:55], s16 offen sc1
    buffer_load_dwordx4 v[28:31], v5, s[52:55], s17 offen sc1
    s_getpc_b64 s[18:19]
Lpc_131:
    s_lshl_b32 s20, s7, 11
    s_sub_u32 s18, s18, Lpc_131-interleave_layers__sliding_local_dilated__moe_arch_mod__prompt_kernel
    s_subb_u32 s19, s19, 0
    s_add_u32 s18, s18, s20
    s_addc_u32 s19, s19, 0
    v_lshlrev_b32 v156, 7, v3
    global_load_dword v157, v156, s[18:19]
    v_and_b32 v130, 1, v3
    v_cmp_eq_u32 s[68:69], 1, v130
    s_lshr_b32 s16, s7, 2
    s_lshl_b32 s16, s16, 7
    s_and_b32 s17, s7, 3
    s_lshl_b32 s17, s17, 2
    s_add_u32 s16, s16, s17
    v_lshrrev_b32 v131, 1, v3
    v_lshl_add_u32 v131, v131, 4, s16
    v_and_b32 v131, 511, v131
    v_lshrrev_b32 v132, 3, v131
    v_lshl_add_u32 v132, v132, 1, v130
    v_lshlrev_b32 v132, 4, v132
    v_bfe_u32 v133, v131, 2, 1
    v_lshl_add_u32 v132, v133, 3, v132
    v_add_u32 v132, 131072, v132
    v_lshlrev_b32 v131, 1, v131
    v_lshl_or_b32 v131, v4, 24, v131
    v_mov_b32 v133, 1073741824
    v_lshlrev_b32 v134, 12, v4
    v_lshl_add_u32 v134, v3, 4, v134
    v_cmp_gt_u32 vcc, 2, v4
    s_nop 1
    v_cndmask_b32 v135, v133, v134, vcc
    v_lshlrev_b32 v136, 4, v2
    v_lshl_or_b32 v136, v4, 24, v136
    s_cmp_eq_u32 s7, 21
    s_cselect_b32 s16, 0, 1073741824
    v_subrev_u32 v154, 192, v0
    v_cmp_gt_u32 vcc, 29, v154
    v_lshlrev_b32 v155, 7, v154
    s_nop 0
    v_cndmask_b32 v155, v133, v155, vcc
    v_or_b32 v155, s16, v155
    v_lshlrev_b32 v154, 24, v154
    v_or_b32 v154, s16, v154
    v_min_u32 v21, 29, v2
    v_lshlrev_b32 v21, 7, v21
    s_mov_b32 s33, 36864
    s_mov_b32 s39, 200000
Lspin_132:
    buffer_load_dword v20, v21, s[52:55], s33 offen sc1
    s_waitcnt vmcnt(0)
    v_subrev_u32 v22, s72, v20
    v_cmp_lt_u32 vcc, 15, v22
    s_cbranch_vccz Ldone_133
    s_sub_u32 s39, s39, 1
    s_cbranch_scc0 Lspin_132
Ldone_133:
    v_cmp_ne_u32 vcc, s5, v20
    s_nop 0
    s_mov_b32 s71, vcc_lo
    v_lshlrev_b32 v44, 4, v2
    v_add_u32 v45, 128, v2
    s_mov_b32 s34, 4095
    s_mov_b32 s35, 0
    v_mov_b32 v32, 139
    v_cndmask_b32 v45, v32, v45, s[34:35]
    v_lshlrev_b32 v45, 4, v45
    s_mov_b32 s33, 8192
    s_mov_b32 s32, 8421376
    s_mov_b32 s30, 0
    s_mov_b32 s31, 0
    v_mov_b32 v23, 1073741824
    s_mov_b32 s39, 200000
Lpf_134:
    buffer_load_dwordx4 v[32:35], v44, s[52:55], s33 offen sc1
    buffer_load_dwordx4 v[36:39], v44, s[52:55], s33 offen offset:1024 sc1
    buffer_load_dwordx4 v[40:43], v45, s[52:55], s33 offen sc1
    buffer_load_dwordx4 v[24:27], v23, s[52:55], s32 offen sc1
    s_waitcnt vmcnt(1)
    v_cmp_eq_u32 s[90:91], s72, v35
    v_cmp_eq_u32 s[92:93], s72, v39
    v_cmp_eq_u32 s[94:95], s72, v43
    v_cndmask_b32 v32, 0, v32, s[90:91]
    v_cndmask_b32 v33, 0, v33, s[90:91]
    s_and_b64 s[90:91], s[90:91], s[92:93]
    v_cndmask_b32 v36, 0, v36, s[92:93]
    v_cndmask_b32 v37, 0, v37, s[92:93]
    s_and_b64 s[90:91], s[90:91], s[94:95]
    s_and_b64 s[94:95], s[94:95], s[34:35]
    v_cndmask_b32 v40, 0, v40, s[94:95]
    v_cndmask_b32 v41, 0, v41, s[94:95]
    v_max_u32 v33, v33, v37
    v_med3_u32 v33, v32, v36, v33
    v_max_u32 v32, v32, v36
    v_max_u32 v33, v33, v41
    v_med3_u32 v33, v32, v40, v33
    v_max_u32 v32, v32, v40
    v_cmp_eq_u32 vcc, s30, v32
    s_nop 1
    v_cndmask_b32 v34, v32, v33, vcc
    v_cmp_lt_u32 vcc, s31, v34
    s_cbranch_vccnz Lpfn_136
    s_waitcnt vmcnt(0)
    v_cmp_eq_u32 vcc, s72, v27
    s_nop 0
    s_and_b64 s[90:91], s[90:91], vcc
    s_cmp_eq_u64 s[90:91], -1
    s_cbranch_scc1 Lpfd_135
    s_sub_u32 s39, s39, 1
    s_cbranch_scc0 Lpf_134
    s_branch Lpfd_135
Lpfn_136:
    v_max_u32_dpp v33, v33, v33 quad_perm:[1,0,3,2] row_mask:0xf bank_mask:0xf
    v_mov_b32_dpp v34, v32 quad_perm:[1,0,3,2] row_mask:0xf bank_mask:0xf
    v_med3_u32 v33, v32, v34, v33
    v_max_u32 v32, v32, v34
    s_nop 0
    v_max_u32_dpp v33, v33, v33 quad_perm:[2,3,0,1] row_mask:0xf bank_mask:0xf
    v_mov_b32_dpp v34, v32 quad_perm:[2,3,0,1] row_mask:0xf bank_mask:0xf
    v_med3_u32 v33, v32, v34, v33
    v_max_u32 v32, v32, v34
    s_nop 0
    v_max_u32_dpp v33, v33, v33 row_half_mirror row_mask:0xf bank_mask:0xf
    v_mov_b32_dpp v34, v32 row_half_mirror row_mask:0xf bank_mask:0xf
    v_med3_u32 v33, v32, v34, v33
    v_max_u32 v32, v32, v34
    s_nop 0
    v_max_u32_dpp v33, v33, v33 row_mirror row_mask:0xf bank_mask:0xf
    v_mov_b32_dpp v34, v32 row_mirror row_mask:0xf bank_mask:0xf
    v_med3_u32 v33, v32, v34, v33
    v_max_u32 v32, v32, v34
    v_mov_b32 v34, v32
    v_mov_b32 v35, v33
    s_nop 0
    v_permlane16_swap_b32 v32, v34
    v_permlane16_swap_b32 v33, v35
    v_max_u32 v33, v33, v35
    v_med3_u32 v33, v32, v34, v33
    v_max_u32 v32, v32, v34
    v_mov_b32 v34, v32
    v_mov_b32 v35, v33
    s_nop 0
    v_permlane32_swap_b32 v32, v34
    v_permlane32_swap_b32 v33, v35
    v_max_u32 v33, v33, v35
    v_med3_u32 v33, v32, v34, v33
    v_max_u32 v32, v32, v34
    s_nop 0
    v_readfirstlane_b32 s30, v32
    v_readfirstlane_b32 s31, v33
    s_not_b32 s80, s30
    s_and_b32 s80, s80, 0xfff
    s_not_b32 s81, s31
    s_and_b32 s81, s81, 0xfff
    s_lshr_b32 s16, s80, 4
    s_lshr_b32 s17, s81, 4
    s_cmp_eq_u32 s16, s17
    s_cselect_b32 s18, 2048, 0
    s_lshl_b32 s16, s16, 12
    s_lshl_b32 s17, s17, 12
    s_add_u32 s17, s17, s18
    v_add_u32 v21, s16, v14
    v_add_u32 v22, s17, v14
    v_cndmask_b32 v23, v21, v22, s[66:67]
    s_sub_u32 s39, s39, 1
    s_cbranch_scc0 Lpf_134
    s_waitcnt vmcnt(0)
Lpfd_135:
    v_and_b32 v21, 0xffff0000, v26
    v_rcp_f32 v21, v21
    v_lshlrev_b32 v20, 16, v26
    v_lshlrev_b32 v36, 16, v24
    v_and_b32 v37, 0xffff0000, v24
    v_lshlrev_b32 v38, 16, v25
    v_and_b32 v39, 0xffff0000, v25
    v_pk_add_f32 v[36:37], v[36:37], v[20:21] op_sel_hi:[1,0] neg_lo:[0,1] neg_hi:[0,1]
    v_pk_add_f32 v[38:39], v[38:39], v[20:21] op_sel_hi:[1,0] neg_lo:[0,1] neg_hi:[0,1]
    v_pk_mul_f32 v[36:37], v[36:37], v[20:21] op_sel:[0,1] op_sel_hi:[1,1]
    v_pk_mul_f32 v[38:39], v[38:39], v[20:21] op_sel:[0,1] op_sel_hi:[1,1]
    v_cvt_pk_bf16_f32 v30, v36, v37
    v_cvt_pk_bf16_f32 v31, v38, v39
    ds_write_b64 v10, v[30:31]
    ds_write_b64 v10, v[24:25] offset:2048
    s_lshr_b32 s16, s80, 4
    s_mul_i32 s16, s16, 205
    s_lshr_b32 s16, s16, 10
    s_mul_i32 s16, s16, 7
    s_sub_u32 s74, s80, s16
    s_lshr_b32 s16, s81, 4
    s_mul_i32 s16, s16, 205
    s_lshr_b32 s16, s16, 10
    s_mul_i32 s16, s16, 7
    s_sub_u32 s75, s81, s16
    s_mov_b32 s82, s74
    s_mov_b32 s83, s75
    s_waitcnt lgkmcnt(0)
    s_barrier
    ds_read_b128 v[64:67], v11 offset:0
    ds_read_b128 v[68:71], v11 offset:128
    ds_read_b128 v[72:75], v11 offset:256
    ds_read_b128 v[76:79], v11 offset:384
    ds_read_b128 v[80:83], v11 offset:512
    ds_read_b128 v[84:87], v11 offset:640
    ds_read_b128 v[88:91], v11 offset:768
    ds_read_b128 v[92:95], v11 offset:896
    s_waitcnt lgkmcnt(6)
    v_mfma_f32_16x16x32_bf16 v[44:47], a[0:3], v[64:67], 0
    v_mov_b32 v32, s82
    ds_read_b128 v[96:99], v11 offset:1024
    v_mfma_f32_16x16x32_bf16 v[48:51], a[64:67], v[64:67], 0
    v_mov_b32 v33, s83
    v_mov_b32 v34, 0
    v_mfma_f32_16x16x32_bf16 v[44:47], a[4:7], v[68:71], v[44:47]
    v_mov_b32 v35, s72
    ds_read_b128 v[100:103], v11 offset:1152
    v_mfma_f32_16x16x32_bf16 v[48:51], a[68:71], v[68:71], v[48:51]
    s_mov_b32 s16, 16384
    s_waitcnt lgkmcnt(6)
    v_mfma_f32_16x16x32_bf16 v[44:47], a[8:11], v[72:75], v[44:47]
    buffer_store_dwordx4 v[32:35], v154, s[52:55], s16 offen sc1
    ds_read_b128 v[104:107], v11 offset:1280
    v_mfma_f32_16x16x32_bf16 v[48:51], a[72:75], v[72:75], v[48:51]
    ds_read_b64 v[138:139], v132
    v_mfma_f32_16x16x32_bf16 v[44:47], a[12:15], v[76:79], v[44:47]
    ds_read_b64 v[140:141], v132 offset:2048
    ds_read_b128 v[108:111], v11 offset:1408
    v_mfma_f32_16x16x32_bf16 v[48:51], a[76:79], v[76:79], v[48:51]
    v_mov_b32 v142, s30
    v_mov_b32 v143, s31
    s_waitcnt lgkmcnt(8)
    v_mfma_f32_16x16x32_bf16 v[44:47], a[16:19], v[80:83], v[44:47]
    v_cndmask_b32 v142, v142, v143, s[68:69]
    ds_read_b128 v[112:115], v11 offset:1536
    v_mfma_f32_16x16x32_bf16 v[48:51], a[80:83], v[80:83], v[48:51]
    v_ashrrev_i32 v143, 31, v142
    v_mfma_f32_16x16x32_bf16 v[44:47], a[20:23], v[84:87], v[44:47]
    v_not_b32 v143, v143
    ds_read_b128 v[116:119], v11 offset:1664
    v_mfma_f32_16x16x32_bf16 v[48:51], a[84:87], v[84:87], v[48:51]
    v_or_b32 v143, 0x80000000, v143
    s_waitcnt lgkmcnt(8)
    v_mfma_f32_16x16x32_bf16 v[44:47], a[24:27], v[88:91], v[44:47]
    v_xor_b32 v137, v142, v143
    ds_read_b128 v[120:123], v11 offset:1792
    v_mfma_f32_16x16x32_bf16 v[48:51], a[88:91], v[88:91], v[48:51]
    v_cvt_pk_bf16_f32 v137, v137, v137
    v_and_b32 v137, 0xffff0000, v137
    v_mfma_f32_16x16x32_bf16 v[44:47], a[28:31], v[92:95], v[44:47]
    v_mul_f32 v137, 0xbfb8aa3b, v137
    ds_read_b128 v[124:127], v11 offset:1920
    v_mfma_f32_16x16x32_bf16 v[48:51], a[92:95], v[92:95], v[48:51]
    s_waitcnt lgkmcnt(8)
    v_mfma_f32_16x16x32_bf16 v[44:47], a[32:35], v[96:99], v[44:47]
    v_exp_f32 v137, v137
    v_mfma_f32_16x16x32_bf16 v[48:51], a[96:99], v[96:99], v[48:51]
    v_add_f32 v137, 1.0, v137
    v_mfma_f32_16x16x32_bf16 v[44:47], a[36:39], v[100:103], v[44:47]
    v_rcp_f32 v137, v137
    v_mfma_f32_16x16x32_bf16 v[48:51], a[100:103], v[100:103], v[48:51]
    v_cvt_pk_bf16_f32 v137, v137, v137
    s_waitcnt lgkmcnt(4)
    v_mfma_f32_16x16x32_bf16 v[44:47], a[40:43], v[104:107], v[44:47]
    v_and_b32 v137, 0xffff0000, v137
    v_mfma_f32_16x16x32_bf16 v[48:51], a[104:107], v[104:107], v[48:51]
    s_waitcnt lgkmcnt(5)
    v_mfma_f32_16x16x32_bf16 v[44:47], a[44:47], v[108:111], v[44:47]
    v_lshlrev_b32 v144, 16, v140
    v_mfma_f32_16x16x32_bf16 v[48:51], a[108:111], v[108:111], v[48:51]
    v_and_b32 v145, 0xffff0000, v140
    s_waitcnt lgkmcnt(2)
    v_mfma_f32_16x16x32_bf16 v[44:47], a[48:51], v[112:115], v[44:47]
    v_lshlrev_b32 v146, 16, v138
    v_and_b32 v147, 0xffff0000, v138
    v_mfma_f32_16x16x32_bf16 v[48:51], a[112:115], v[112:115], v[48:51]
    v_lshlrev_b32 v148, 16, v141
    v_mfma_f32_16x16x32_bf16 v[44:47], a[52:55], v[116:119], v[44:47]
    v_and_b32 v149, 0xffff0000, v141
    v_mfma_f32_16x16x32_bf16 v[48:51], a[116:119], v[116:119], v[48:51]
    v_lshlrev_b32 v150, 16, v139
    s_waitcnt lgkmcnt(0)
    v_mfma_f32_16x16x32_bf16 v[44:47], a[56:59], v[120:123], v[44:47]
    v_and_b32 v151, 0xffff0000, v139
    v_mfma_f32_16x16x32_bf16 v[48:51], a[120:123], v[120:123], v[48:51]
    v_add_f32 v144, v144, v146
    v_mfma_f32_16x16x32_bf16 v[44:47], a[60:63], v[124:127], v[44:47]
    v_add_f32 v145, v145, v147
    v_add_f32 v146, v148, v150
    v_mfma_f32_16x16x32_bf16 v[48:51], a[124:127], v[124:127], v[48:51]
    v_add_f32 v147, v149, v151
    s_nop 3
    v_mul_f32 v56, 0xbfb8aa3b, v44
    v_mul_f32 v57, 0xbfb8aa3b, v45
    v_mul_f32 v58, 0xbfb8aa3b, v46
    v_mul_f32 v59, 0xbfb8aa3b, v47
    v_exp_f32 v56, v56
    v_exp_f32 v57, v57
    v_exp_f32 v58, v58
    v_exp_f32 v59, v59
    v_pk_mul_f32 v[44:45], v[44:45], v[48:49]
    v_pk_mul_f32 v[46:47], v[46:47], v[50:51]
    v_add_f32 v56, 1.0, v56
    v_add_f32 v57, 1.0, v57
    v_add_f32 v58, 1.0, v58
    v_add_f32 v59, 1.0, v59
    v_rcp_f32 v56, v56
    v_rcp_f32 v57, v57
    v_rcp_f32 v58, v58
    v_rcp_f32 v59, v59
    v_pk_mul_f32 v[44:45], v[44:45], v[56:57]
    v_pk_mul_f32 v[46:47], v[46:47], v[58:59]
    v_cvt_pk_bf16_f32 v52, v44, v45
    v_cvt_pk_bf16_f32 v53, v46, v47
    s_mov_b64 exec, s[64:65]
    ds_write_b64 v12, v[52:53]
    s_mov_b64 exec, -1
    s_waitcnt lgkmcnt(0)
    s_barrier
    ds_read_b128 v[64:67], v13 offset:224
    ds_read_b128 v[68:71], v13 offset:2272
    ds_read_b128 v[72:75], v13 offset:192
    ds_read_b128 v[76:79], v13 offset:2240
    ds_read_b128 v[80:83], v13 offset:160
    ds_read_b128 v[84:87], v13 offset:2208
    ds_read_b128 v[88:91], v13 offset:128
    ds_read_b128 v[92:95], v13 offset:2176
    s_waitcnt lgkmcnt(6)
    v_mfma_f32_16x16x32_bf16 v[44:47], a[128:131], v[64:67], 0
    ds_read_b128 v[96:99], v13 offset:96
    v_mfma_f32_16x16x32_bf16 v[44:47], a[132:135], v[68:71], v[44:47]
    ds_read_b128 v[100:103], v13 offset:2144
    s_waitcnt lgkmcnt(6)
    v_mfma_f32_16x16x32_bf16 v[44:47], a[136:139], v[72:75], v[44:47]
    ds_read_b128 v[104:107], v13 offset:64
    v_mfma_f32_16x16x32_bf16 v[44:47], a[140:143], v[76:79], v[44:47]
    ds_read_b128 v[108:111], v13 offset:2112
    s_waitcnt lgkmcnt(6)
    v_mfma_f32_16x16x32_bf16 v[44:47], a[144:147], v[80:83], v[44:47]
    ds_read_b128 v[112:115], v13 offset:32
    v_mfma_f32_16x16x32_bf16 v[44:47], a[148:151], v[84:87], v[44:47]
    ds_read_b128 v[116:119], v13 offset:2080
    s_waitcnt lgkmcnt(6)
    v_mfma_f32_16x16x32_bf16 v[44:47], a[152:155], v[88:91], v[44:47]
    ds_read_b128 v[120:123], v13 offset:0
    v_mfma_f32_16x16x32_bf16 v[44:47], a[156:159], v[92:95], v[44:47]
    ds_read_b128 v[124:127], v13 offset:2048
    s_waitcnt lgkmcnt(6)
    v_mfma_f32_16x16x32_bf16 v[44:47], a[160:163], v[96:99], v[44:47]
    v_mfma_f32_16x16x32_bf16 v[44:47], a[164:167], v[100:103], v[44:47]
    s_waitcnt lgkmcnt(4)
    v_mfma_f32_16x16x32_bf16 v[44:47], a[168:171], v[104:107], v[44:47]
    v_mfma_f32_16x16x32_bf16 v[44:47], a[172:175], v[108:111], v[44:47]
    s_waitcnt lgkmcnt(2)
    v_mfma_f32_16x16x32_bf16 v[44:47], a[176:179], v[112:115], v[44:47]
    v_mfma_f32_16x16x32_bf16 v[44:47], a[180:183], v[116:119], v[44:47]
    s_waitcnt lgkmcnt(0)
    v_mfma_f32_16x16x32_bf16 v[44:47], a[184:187], v[120:123], v[44:47]
    v_mfma_f32_16x16x32_bf16 v[44:47], a[188:191], v[124:127], v[44:47]
    s_add_u32 s16, s23, 262144
    s_nop 6
    v_min_u32 v44, -2, v44
    s_cmp_lg_u32 s71, 0
    s_cbranch_scc1 Lwt_137
    buffer_store_dwordx4 v[44:47], v5, s[52:55], s16 offen
Lst_138:
    s_lshl_b32 s16, s8, 8
    s_add_u32 s16, s16, s7
    s_cmp_ge_u32 s16, 16
    s_cbranch_scc1 L_ffn_l2
    s_lshl_b32 s33, s7, 8
    s_add_u32 s33, s33, 262144
    s_mov_b32 s39, 200000
Lspin_139:
    s_add_u32 s16, s33, 0
    buffer_load_dwordx4 v[64:67], v134, s[52:55], s16 offen sc1
    s_add_u32 s16, s33, 16384
    buffer_load_dwordx4 v[68:71], v134, s[52:55], s16 offen sc1
    s_add_u32 s16, s33, 32768
    buffer_load_dwordx4 v[72:75], v134, s[52:55], s16 offen sc1
    s_add_u32 s16, s33, 49152
    buffer_load_dwordx4 v[76:79], v134, s[52:55], s16 offen sc1
    s_add_u32 s16, s33, 65536
    buffer_load_dwordx4 v[80:83], v134, s[52:55], s16 offen sc1
    s_add_u32 s16, s33, 81920
    buffer_load_dwordx4 v[84:87], v135, s[52:55], s16 offen sc1
    s_waitcnt vmcnt(0)
    v_max3_u32 v32, v64, v68, v72
    v_max3_u32 v32, v32, v76, v80
    v_max_u32 v32, v32, v84
    v_cmp_eq_u32 vcc, -1, v32
    s_cbranch_vccz Ldone_140
    s_sub_u32 s39, s39, 1
    s_cbranch_scc0 Lspin_139
Ldone_140:
    v_pk_add_f32 v[64:65], v[64:65], v[68:69]
    v_pk_add_f32 v[66:67], v[66:67], v[70:71]
    v_pk_add_f32 v[72:73], v[72:73], v[76:77]
    v_pk_add_f32 v[74:75], v[74:75], v[78:79]
    v_pk_add_f32 v[80:81], v[80:81], v[84:85]
    v_pk_add_f32 v[82:83], v[82:83], v[86:87]
    v_pk_add_f32 v[64:65], v[64:65], v[72:73]
    v_pk_add_f32 v[66:67], v[66:67], v[74:75]
    v_pk_add_f32 v[64:65], v[64:65], v[80:81]
    v_pk_add_f32 v[66:67], v[66:67], v[82:83]
    v_mov_b32 v68, v64
    v_mov_b32 v69, v65
    v_mov_b32 v70, v66
    v_mov_b32 v71, v67
    v_permlane16_swap_b32 v64, v68
    v_permlane16_swap_b32 v65, v69
    v_permlane16_swap_b32 v66, v70
    v_permlane16_swap_b32 v67, v71
    v_pk_add_f32 v[64:65], v[64:65], v[68:69]
    v_pk_add_f32 v[66:67], v[66:67], v[70:71]
    v_mov_b32 v68, v64
    v_mov_b32 v69, v65
    v_mov_b32 v70, v66
    v_mov_b32 v71, v67
    v_permlane32_swap_b32 v64, v68
    v_permlane32_swap_b32 v65, v69
    v_permlane32_swap_b32 v66, v70
    v_permlane32_swap_b32 v67, v71
    v_pk_add_f32 v[64:65], v[64:65], v[68:69]
    v_pk_add_f32 v[66:67], v[66:67], v[70:71]
    v_pk_fma_f32 v[64:65], v[64:65], v[136:137], v[144:145] op_sel:[0,1,0] op_sel_hi:[1,1,1]
    v_pk_fma_f32 v[66:67], v[66:67], v[136:137], v[146:147] op_sel:[0,1,0] op_sel_hi:[1,1,1]
    v_cvt_pk_bf16_f32 v32, v64, v65
    v_cvt_pk_bf16_f32 v33, v66, v67
    v_mov_b32 v35, s72
    s_lshl_b32 s16, s7, 8
    s_add_u32 s16, s16, 28672
    s_cmp_lg_u32 s71, 0
    s_cbranch_scc1 Lwt_141
    buffer_store_dwordx4 v[32:35], v136, s[52:55], s16 offen
Lst_142:
L_ffn_l2:
    s_barrier
    v_lshlrev_b32 v44, 4, v2
    v_add_u32 v45, 128, v2
    s_mov_b32 s34, 69631
    s_mov_b32 s35, 0
    v_mov_b32 v32, 139
    v_cndmask_b32 v45, v32, v45, s[34:35]
    v_lshlrev_b32 v45, 4, v45
    s_mov_b32 s33, 12288
    s_mov_b32 s32, 9076736
    s_mov_b32 s30, 0
    s_mov_b32 s31, 0
    v_mov_b32 v23, 1073741824
    s_mov_b32 s39, 200000
Lpf_143:
    buffer_load_dwordx4 v[32:35], v44, s[52:55], s33 offen sc1
    buffer_load_dwordx4 v[36:39], v44, s[52:55], s33 offen offset:1024 sc1
    buffer_load_dwordx4 v[40:43], v45, s[52:55], s33 offen sc1
    buffer_load_dwordx4 v[24:27], v23, s[52:55], s32 offen sc1
    s_waitcnt vmcnt(1)
    v_cmp_eq_u32 s[90:91], s72, v35
    v_cmp_eq_u32 s[92:93], s72, v39
    v_cmp_eq_u32 s[94:95], s72, v43
    v_cndmask_b32 v32, 0, v32, s[90:91]
    v_cndmask_b32 v33, 0, v33, s[90:91]
    s_and_b64 s[90:91], s[90:91], s[92:93]
    v_cndmask_b32 v36, 0, v36, s[92:93]
    v_cndmask_b32 v37, 0, v37, s[92:93]
    s_and_b64 s[90:91], s[90:91], s[94:95]
    s_and_b64 s[94:95], s[94:95], s[34:35]
    v_cndmask_b32 v40, 0, v40, s[94:95]
    v_cndmask_b32 v41, 0, v41, s[94:95]
    v_max_u32 v33, v33, v37
    v_med3_u32 v33, v32, v36, v33
    v_max_u32 v32, v32, v36
    v_max_u32 v33, v33, v41
    v_med3_u32 v33, v32, v40, v33
    v_max_u32 v32, v32, v40
    v_cmp_eq_u32 vcc, s30, v32
    s_nop 1
    v_cndmask_b32 v34, v32, v33, vcc
    v_cmp_lt_u32 vcc, s31, v34
    s_cbranch_vccnz Lpfn_145
    s_waitcnt vmcnt(0)
    v_cmp_eq_u32 vcc, s72, v27
    s_nop 0
    s_and_b64 s[90:91], s[90:91], vcc
    s_cmp_eq_u64 s[90:91], -1
    s_cbranch_scc1 Lpfd_144
    s_sub_u32 s39, s39, 1
    s_cbranch_scc0 Lpf_143
    s_branch Lpfd_144
Lpfn_145:
    v_max_u32_dpp v33, v33, v33 quad_perm:[1,0,3,2] row_mask:0xf bank_mask:0xf
    v_mov_b32_dpp v34, v32 quad_perm:[1,0,3,2] row_mask:0xf bank_mask:0xf
    v_med3_u32 v33, v32, v34, v33
    v_max_u32 v32, v32, v34
    s_nop 0
    v_max_u32_dpp v33, v33, v33 quad_perm:[2,3,0,1] row_mask:0xf bank_mask:0xf
    v_mov_b32_dpp v34, v32 quad_perm:[2,3,0,1] row_mask:0xf bank_mask:0xf
    v_med3_u32 v33, v32, v34, v33
    v_max_u32 v32, v32, v34
    s_nop 0
    v_max_u32_dpp v33, v33, v33 row_half_mirror row_mask:0xf bank_mask:0xf
    v_mov_b32_dpp v34, v32 row_half_mirror row_mask:0xf bank_mask:0xf
    v_med3_u32 v33, v32, v34, v33
    v_max_u32 v32, v32, v34
    s_nop 0
    v_max_u32_dpp v33, v33, v33 row_mirror row_mask:0xf bank_mask:0xf
    v_mov_b32_dpp v34, v32 row_mirror row_mask:0xf bank_mask:0xf
    v_med3_u32 v33, v32, v34, v33
    v_max_u32 v32, v32, v34
    v_mov_b32 v34, v32
    v_mov_b32 v35, v33
    s_nop 0
    v_permlane16_swap_b32 v32, v34
    v_permlane16_swap_b32 v33, v35
    v_max_u32 v33, v33, v35
    v_med3_u32 v33, v32, v34, v33
    v_max_u32 v32, v32, v34
    v_mov_b32 v34, v32
    v_mov_b32 v35, v33
    s_nop 0
    v_permlane32_swap_b32 v32, v34
    v_permlane32_swap_b32 v33, v35
    v_max_u32 v33, v33, v35
    v_med3_u32 v33, v32, v34, v33
    v_max_u32 v32, v32, v34
    s_nop 0
    v_readfirstlane_b32 s30, v32
    v_readfirstlane_b32 s31, v33
    s_not_b32 s80, s30
    s_and_b32 s80, s80, 0xfff
    s_not_b32 s81, s31
    s_and_b32 s81, s81, 0xfff
    s_lshr_b32 s16, s80, 4
    s_lshr_b32 s17, s81, 4
    s_cmp_eq_u32 s16, s17
    s_cselect_b32 s18, 2048, 0
    s_lshl_b32 s16, s16, 12
    s_lshl_b32 s17, s17, 12
    s_add_u32 s17, s17, s18
    v_add_u32 v21, s16, v14
    v_add_u32 v22, s17, v14
    v_cndmask_b32 v23, v21, v22, s[66:67]
    s_sub_u32 s39, s39, 1
    s_cbranch_scc0 Lpf_143
    s_waitcnt vmcnt(0)
Lpfd_144:
    v_mov_b32 v32, s30
    v_mov_b32 v33, s31
    v_mov_b32 v35, s72
    s_mov_b32 s16, 20480
    buffer_store_dwordx4 v[32:35], v155, s[52:55], s16 offen sc1
    v_and_b32 v21, 0xffff0000, v26
    v_rcp_f32 v21, v21
    v_lshlrev_b32 v20, 16, v26
    v_lshlrev_b32 v36, 16, v24
    v_and_b32 v37, 0xffff0000, v24
    v_lshlrev_b32 v38, 16, v25
    v_and_b32 v39, 0xffff0000, v25
    v_pk_add_f32 v[36:37], v[36:37], v[20:21] op_sel_hi:[1,0] neg_lo:[0,1] neg_hi:[0,1]
    v_pk_add_f32 v[38:39], v[38:39], v[20:21] op_sel_hi:[1,0] neg_lo:[0,1] neg_hi:[0,1]
    v_pk_mul_f32 v[36:37], v[36:37], v[20:21] op_sel:[0,1] op_sel_hi:[1,1]
    v_pk_mul_f32 v[38:39], v[38:39], v[20:21] op_sel:[0,1] op_sel_hi:[1,1]
    v_cvt_pk_bf16_f32 v30, v36, v37
    v_cvt_pk_bf16_f32 v31, v38, v39
    ds_write_b64 v10, v[30:31]
    ds_write_b64 v10, v[24:25] offset:2048
    s_waitcnt lgkmcnt(0)
    s_barrier
    ds_read_b128 v[64:67], v11 offset:0
    ds_read_b128 v[68:71], v11 offset:128
    ds_read_b128 v[72:75], v11 offset:256
    ds_read_b128 v[76:79], v11 offset:384
    ds_read_b128 v[80:83], v11 offset:512
    ds_read_b128 v[84:87], v11 offset:640
    ds_read_b128 v[88:91], v11 offset:768
    ds_read_b128 v[92:95], v11 offset:896
    s_waitcnt lgkmcnt(6)
    v_mfma_f32_16x16x32_bf16 v[44:47], a[0:3], v[64:67], 0
    s_lshr_b32 s16, s80, 4
    s_mul_i32 s16, s16, 205
    ds_read_b128 v[96:99], v11 offset:1024
    v_mfma_f32_16x16x32_bf16 v[48:51], a[64:67], v[64:67], 0
    s_lshr_b32 s16, s16, 10
    s_mul_i32 s16, s16, 7
    v_mfma_f32_16x16x32_bf16 v[44:47], a[4:7], v[68:71], v[44:47]
    s_sub_u32 s82, s80, s16
    s_bitcmp1_b32 s80, 3
    ds_read_b128 v[100:103], v11 offset:1152
    v_mfma_f32_16x16x32_bf16 v[48:51], a[68:71], v[68:71], v[48:51]
    s_cselect_b32 s16, s75, s74
    s_and_b32 s17, s80, 7
    s_waitcnt lgkmcnt(6)
    v_mfma_f32_16x16x32_bf16 v[44:47], a[8:11], v[72:75], v[44:47]
    s_add_u32 s16, s16, s17
    s_cmp_ge_u32 s80, 2240
    ds_read_b128 v[104:107], v11 offset:1280
    v_mfma_f32_16x16x32_bf16 v[48:51], a[72:75], v[72:75], v[48:51]
    s_cselect_b32 s82, s16, s82
    s_lshr_b32 s16, s81, 4
    v_mfma_f32_16x16x32_bf16 v[44:47], a[12:15], v[76:79], v[44:47]
    s_mul_i32 s16, s16, 205
    s_lshr_b32 s16, s16, 10
    ds_read_b128 v[108:111], v11 offset:1408
    v_mfma_f32_16x16x32_bf16 v[48:51], a[76:79], v[76:79], v[48:51]
    s_mul_i32 s16, s16, 7
    s_sub_u32 s83, s81, s16
    s_bitcmp1_b32 s81, 3
    s_waitcnt lgkmcnt(6)
    v_mfma_f32_16x16x32_bf16 v[44:47], a[16:19], v[80:83], v[44:47]
    s_cselect_b32 s16, s75, s74
    s_and_b32 s17, s81, 7
    ds_read_b128 v[112:115], v11 offset:1536
    v_mfma_f32_16x16x32_bf16 v[48:51], a[80:83], v[80:83], v[48:51]
    s_add_u32 s16, s16, s17
    s_cmp_ge_u32 s81, 2240
    v_mfma_f32_16x16x32_bf16 v[44:47], a[20:23], v[84:87], v[44:47]
    s_cselect_b32 s83, s16, s83
    ds_read_b64 v[138:139], v132
    ds_read_b128 v[116:119], v11 offset:1664
    v_mfma_f32_16x16x32_bf16 v[48:51], a[84:87], v[84:87], v[48:51]
    ds_read_b64 v[140:141], v132 offset:2048
    s_waitcnt lgkmcnt(8)
    v_mfma_f32_16x16x32_bf16 v[44:47], a[24:27], v[88:91], v[44:47]
    v_mov_b32 v142, s30
    v_mov_b32 v143, s31
    ds_read_b128 v[120:123], v11 offset:1792
    v_mfma_f32_16x16x32_bf16 v[48:51], a[88:91], v[88:91], v[48:51]
    v_cndmask_b32 v142, v142, v143, s[68:69]
    v_ashrrev_i32 v143, 31, v142
    v_mfma_f32_16x16x32_bf16 v[44:47], a[28:31], v[92:95], v[44:47]
    v_not_b32 v143, v143
    v_or_b32 v143, 0x80000000, v143
    ds_read_b128 v[124:127], v11 offset:1920
    v_mfma_f32_16x16x32_bf16 v[48:51], a[92:95], v[92:95], v[48:51]
    v_xor_b32 v137, v142, v143
    v_cvt_pk_bf16_f32 v137, v137, v137
    s_waitcnt lgkmcnt(8)
    v_mfma_f32_16x16x32_bf16 v[44:47], a[32:35], v[96:99], v[44:47]
    v_and_b32 v137, 0xffff0000, v137
    v_mfma_f32_16x16x32_bf16 v[48:51], a[96:99], v[96:99], v[48:51]
    v_mul_f32 v137, 0xbfb8aa3b, v137
    v_exp_f32 v137, v137
    v_mfma_f32_16x16x32_bf16 v[44:47], a[36:39], v[100:103], v[44:47]
    v_add_f32 v137, 1.0, v137
    v_mfma_f32_16x16x32_bf16 v[48:51], a[100:103], v[100:103], v[48:51]
    v_rcp_f32 v137, v137
    s_waitcnt lgkmcnt(6)
    v_mfma_f32_16x16x32_bf16 v[44:47], a[40:43], v[104:107], v[44:47]
    v_cvt_pk_bf16_f32 v137, v137, v137
    v_and_b32 v137, 0xffff0000, v137
    v_mfma_f32_16x16x32_bf16 v[48:51], a[104:107], v[104:107], v[48:51]
    v_mov_b32 v142, s82
    v_mov_b32 v143, s83
    v_mfma_f32_16x16x32_bf16 v[44:47], a[44:47], v[108:111], v[44:47]
    v_cndmask_b32 v142, v142, v143, s[68:69]
    v_and_b32 v143, 1023, v142
    v_mfma_f32_16x16x32_bf16 v[48:51], a[108:111], v[108:111], v[48:51]
    v_lshl_add_u32 v131, v143, 11, v131
    s_waitcnt lgkmcnt(3)
    v_mfma_f32_16x16x32_bf16 v[44:47], a[48:51], v[112:115], v[44:47]
    v_bfe_u32 v142, v142, 10, 1
    v_lshl_add_u32 v131, v142, 10, v131
    v_mfma_f32_16x16x32_bf16 v[48:51], a[112:115], v[112:115], v[48:51]
    s_waitcnt lgkmcnt(2)
    v_lshlrev_b32 v144, 16, v140
    v_mfma_f32_16x16x32_bf16 v[44:47], a[52:55], v[116:119], v[44:47]
    v_and_b32 v145, 0xffff0000, v140
    v_lshlrev_b32 v146, 16, v138
    v_mfma_f32_16x16x32_bf16 v[48:51], a[116:119], v[116:119], v[48:51]
    v_and_b32 v147, 0xffff0000, v138
    s_waitcnt lgkmcnt(0)
    v_mfma_f32_16x16x32_bf16 v[44:47], a[56:59], v[120:123], v[44:47]
    v_lshlrev_b32 v148, 16, v141
    v_and_b32 v149, 0xffff0000, v141
    v_mfma_f32_16x16x32_bf16 v[48:51], a[120:123], v[120:123], v[48:51]
    v_lshlrev_b32 v150, 16, v139
    v_and_b32 v151, 0xffff0000, v139
    v_mfma_f32_16x16x32_bf16 v[44:47], a[60:63], v[124:127], v[44:47]
    v_add_f32 v144, v144, v146
    v_add_f32 v145, v145, v147
    v_mfma_f32_16x16x32_bf16 v[48:51], a[124:127], v[124:127], v[48:51]
    v_add_f32 v146, v148, v150
    v_add_f32 v147, v149, v151
    s_nop 2
    v_mul_f32 v56, 0xbfb8aa3b, v44
    v_mul_f32 v57, 0xbfb8aa3b, v45
    v_mul_f32 v58, 0xbfb8aa3b, v46
    v_mul_f32 v59, 0xbfb8aa3b, v47
    v_exp_f32 v56, v56
    v_exp_f32 v57, v57
    v_exp_f32 v58, v58
    v_exp_f32 v59, v59
    v_pk_mul_f32 v[44:45], v[44:45], v[48:49]
    v_pk_mul_f32 v[46:47], v[46:47], v[50:51]
    v_add_f32 v56, 1.0, v56
    v_add_f32 v57, 1.0, v57
    v_add_f32 v58, 1.0, v58
    v_add_f32 v59, 1.0, v59
    v_rcp_f32 v56, v56
    v_rcp_f32 v57, v57
    v_rcp_f32 v58, v58
    v_rcp_f32 v59, v59
    v_pk_mul_f32 v[44:45], v[44:45], v[56:57]
    v_pk_mul_f32 v[46:47], v[46:47], v[58:59]
    v_cvt_pk_bf16_f32 v52, v44, v45
    v_cvt_pk_bf16_f32 v53, v46, v47
    s_mov_b64 exec, s[64:65]
    ds_write_b64 v12, v[52:53]
    s_mov_b64 exec, -1
    s_waitcnt lgkmcnt(0)
    s_barrier
    ds_read_b128 v[64:67], v13 offset:224
    ds_read_b128 v[68:71], v13 offset:2272
    ds_read_b128 v[72:75], v13 offset:192
    ds_read_b128 v[76:79], v13 offset:2240
    ds_read_b128 v[80:83], v13 offset:160
    ds_read_b128 v[84:87], v13 offset:2208
    ds_read_b128 v[88:91], v13 offset:128
    ds_read_b128 v[92:95], v13 offset:2176
    s_waitcnt lgkmcnt(6)
    v_mfma_f32_16x16x32_bf16 v[44:47], a[128:131], v[64:67], 0
    ds_read_b128 v[96:99], v13 offset:96
    v_mfma_f32_16x16x32_bf16 v[44:47], a[132:135], v[68:71], v[44:47]
    ds_read_b128 v[100:103], v13 offset:2144
    s_waitcnt lgkmcnt(6)
    v_mfma_f32_16x16x32_bf16 v[44:47], a[136:139], v[72:75], v[44:47]
    ds_read_b128 v[104:107], v13 offset:64
    v_mfma_f32_16x16x32_bf16 v[44:47], a[140:143], v[76:79], v[44:47]
    ds_read_b128 v[108:111], v13 offset:2112
    s_waitcnt lgkmcnt(6)
    v_mfma_f32_16x16x32_bf16 v[44:47], a[144:147], v[80:83], v[44:47]
    ds_read_b128 v[112:115], v13 offset:32
    v_mfma_f32_16x16x32_bf16 v[44:47], a[148:151], v[84:87], v[44:47]
    ds_read_b128 v[116:119], v13 offset:2080
    s_waitcnt lgkmcnt(6)
    v_mfma_f32_16x16x32_bf16 v[44:47], a[152:155], v[88:91], v[44:47]
    ds_read_b128 v[120:123], v13 offset:0
    v_mfma_f32_16x16x32_bf16 v[44:47], a[156:159], v[92:95], v[44:47]
    ds_read_b128 v[124:127], v13 offset:2048
    s_waitcnt lgkmcnt(6)
    v_mfma_f32_16x16x32_bf16 v[44:47], a[160:163], v[96:99], v[44:47]
    v_mfma_f32_16x16x32_bf16 v[44:47], a[164:167], v[100:103], v[44:47]
    s_waitcnt lgkmcnt(4)
    v_mfma_f32_16x16x32_bf16 v[44:47], a[168:171], v[104:107], v[44:47]
    v_mfma_f32_16x16x32_bf16 v[44:47], a[172:175], v[108:111], v[44:47]
    s_waitcnt lgkmcnt(2)
    v_mfma_f32_16x16x32_bf16 v[44:47], a[176:179], v[112:115], v[44:47]
    v_mfma_f32_16x16x32_bf16 v[44:47], a[180:183], v[116:119], v[44:47]
    s_waitcnt lgkmcnt(0)
    v_mfma_f32_16x16x32_bf16 v[44:47], a[184:187], v[120:123], v[44:47]
    v_mfma_f32_16x16x32_bf16 v[44:47], a[188:191], v[124:127], v[44:47]
    s_add_u32 s16, s23, 393216
    s_nop 6
    v_min_u32 v44, -2, v44
    s_cmp_lg_u32 s71, 0
    s_cbranch_scc1 Lwt_146
    buffer_store_dwordx4 v[44:47], v5, s[52:55], s16 offen
Lst_147:
    s_lshl_b32 s16, s8, 8
    s_add_u32 s16, s16, s7
    s_cmp_ge_u32 s16, 16
    s_cbranch_scc1 L_fin
    s_lshl_b32 s33, s7, 8
    s_add_u32 s33, s33, 393216
    s_mov_b32 s39, 200000
Lspin_148:
    s_add_u32 s16, s33, 0
    buffer_load_dwordx4 v[64:67], v134, s[52:55], s16 offen sc1
    s_add_u32 s16, s33, 16384
    buffer_load_dwordx4 v[68:71], v134, s[52:55], s16 offen sc1
    s_add_u32 s16, s33, 32768
    buffer_load_dwordx4 v[72:75], v134, s[52:55], s16 offen sc1
    s_add_u32 s16, s33, 49152
    buffer_load_dwordx4 v[76:79], v134, s[52:55], s16 offen sc1
    s_add_u32 s16, s33, 65536
    buffer_load_dwordx4 v[80:83], v134, s[52:55], s16 offen sc1
    s_add_u32 s16, s33, 81920
    buffer_load_dwordx4 v[84:87], v135, s[52:55], s16 offen sc1
    s_waitcnt vmcnt(0)
    v_max3_u32 v32, v64, v68, v72
    v_max3_u32 v32, v32, v76, v80
    v_max_u32 v32, v32, v84
    v_cmp_eq_u32 vcc, -1, v32
    s_cbranch_vccz Ldone_149
    s_sub_u32 s39, s39, 1
    s_cbranch_scc0 Lspin_148
Ldone_149:
    v_pk_add_f32 v[64:65], v[64:65], v[68:69]
    v_pk_add_f32 v[66:67], v[66:67], v[70:71]
    v_pk_add_f32 v[72:73], v[72:73], v[76:77]
    v_pk_add_f32 v[74:75], v[74:75], v[78:79]
    v_pk_add_f32 v[80:81], v[80:81], v[84:85]
    v_pk_add_f32 v[82:83], v[82:83], v[86:87]
    v_pk_add_f32 v[64:65], v[64:65], v[72:73]
    v_pk_add_f32 v[66:67], v[66:67], v[74:75]
    v_pk_add_f32 v[64:65], v[64:65], v[80:81]
    v_pk_add_f32 v[66:67], v[66:67], v[82:83]
    v_mov_b32 v68, v64
    v_mov_b32 v69, v65
    v_mov_b32 v70, v66
    v_mov_b32 v71, v67
    v_permlane16_swap_b32 v64, v68
    v_permlane16_swap_b32 v65, v69
    v_permlane16_swap_b32 v66, v70
    v_permlane16_swap_b32 v67, v71
    v_pk_add_f32 v[64:65], v[64:65], v[68:69]
    v_pk_add_f32 v[66:67], v[66:67], v[70:71]
    v_mov_b32 v68, v64
    v_mov_b32 v69, v65
    v_mov_b32 v70, v66
    v_mov_b32 v71, v67
    v_permlane32_swap_b32 v64, v68
    v_permlane32_swap_b32 v65, v69
    v_permlane32_swap_b32 v66, v70
    v_permlane32_swap_b32 v67, v71
    v_pk_add_f32 v[64:65], v[64:65], v[68:69]
    v_pk_add_f32 v[66:67], v[66:67], v[70:71]
    v_pk_fma_f32 v[64:65], v[64:65], v[136:137], v[144:145] op_sel:[0,1,0] op_sel_hi:[1,1,1]
    v_pk_fma_f32 v[66:67], v[66:67], v[136:137], v[146:147] op_sel:[0,1,0] op_sel_hi:[1,1,1]
    v_cvt_pk_bf16_f32 v32, v64, v65
    v_cvt_pk_bf16_f32 v33, v66, v67
    buffer_store_dwordx2 v[32:33], v131, s[56:59], 0 offen sc1
    v_mov_b32 v20, s72
    buffer_store_dword v20, v19, s[52:55], 0 offen sc1
L_fin:
L_end:
    s_endpgm
L_aexit:
    s_branch L_fin
L_idle:
    s_waitcnt lgkmcnt(0)
    s_load_dwordx2 s[48:49], s[0:1], 56
    s_mov_b32 s50, 1409024
    s_sub_u32 s16, s7, 22
    s_lshl_b32 s16, s16, 15
    v_lshlrev_b32 v5, 7, v0
    v_add_u32 v5, s16, v5
    s_waitcnt lgkmcnt(0)
    s_endpgm
Lslow_3:
    s_mov_b32 s39, 200000
Lsl_5:
    buffer_load_dwordx4 v[236:239], v249, s[52:55], s87 offen offset:0 sc1
    buffer_load_dwordx4 v[240:243], v249, s[52:55], s87 offen offset:1024 sc1
    buffer_load_dwordx4 v[244:247], v17, s[52:55], s87 offen offset:2048 sc1
    s_waitcnt vmcnt(0)
    v_xor_b32 v252, s72, v239
    v_xor_b32 v253, s72, v243
    v_xor_b32 v248, s72, v247
    v_or3_b32 v252, v252, v253, v248
    v_cmp_ne_u32 vcc, 0, v252
    s_cbranch_vccz Lback_4
    s_sub_u32 s39, s39, 1
    s_cbranch_scc0 Lsl_5
    s_branch Lback_4
L_safeclr:
    v_mov_b32 v246, -1
    v_mov_b32 v247, -1
    v_mov_b32 v248, -1
    v_mov_b32 v249, -1
    s_add_u32 s18, s23, 1048576
    buffer_store_dwordx4 v[246:249], v24, s[52:55], s18 offen sc1
    s_add_u32 s18, s23, 1081344
    buffer_store_dwordx4 v[246:249], v24, s[52:55], s18 offen sc1
    s_add_u32 s18, s23, 1114112
    buffer_store_dwordx4 v[246:249], v25, s[52:55], s18 offen sc1
    s_add_u32 s18, s23, 3506176
    buffer_store_dwordx4 v[246:249], v24, s[52:55], s18 offen sc1
    s_add_u32 s18, s23, 3538944
    buffer_store_dwordx4 v[246:249], v24, s[52:55], s18 offen sc1
    s_add_u32 s18, s23, 3571712
    buffer_store_dwordx4 v[246:249], v25, s[52:55], s18 offen sc1
    s_waitcnt vmcnt(0)
    s_barrier
    s_add_u32 s18, s10, 983040
    v_mov_b32 v250, s5
    v_lshlrev_b32 v251, 24, v0
    buffer_store_dword v250, v251, s[52:55], s18 offen sc1
    v_and_b32 v251, 7, v2
    s_lshl_b32 s38, s6, 10
    v_lshlrev_b32 v251, 7, v251
    s_add_u32 s38, s38, 983040
    buffer_load_dword v250, v251, s[52:55], s38 offen sc1
    s_mov_b32 s39, 200000
Lspin_6:
    buffer_load_dword v250, v251, s[52:55], s38 offen sc1
    s_waitcnt vmcnt(0)
    v_subrev_u32 v252, s72, v250
    v_cmp_lt_u32 vcc, 15, v252
    s_cbranch_vccz Ldone_7
    s_sub_u32 s39, s39, 1
    s_cbranch_scc0 Lspin_6
Ldone_7:
    s_branch L_safeclr_done
Lslow_8:
    s_mov_b32 s39, 200000
Lsl_10:
    buffer_load_dword v250, v251, s[52:55], s38 offen sc1
    s_waitcnt vmcnt(0)
    v_subrev_u32 v252, s72, v250
    v_cmp_lt_u32 vcc, 15, v252
    s_cbranch_vccz Lback_9
    s_sub_u32 s39, s39, 1
    s_cbranch_scc0 Lsl_10
    s_branch Lback_9
Lwt_11:
    buffer_store_dwordx4 v[152:155], v25, s[52:55], s18 offen sc1
    s_branch Lst_12
Lwt_13:
    buffer_store_dwordx4 v[104:107], v24, s[52:55], s18 offen sc1
    s_branch Lst_14
Lwt_15:
    buffer_store_dwordx4 v[128:131], v24, s[52:55], s18 offen sc1
    s_branch Lst_16
Lslow_17:
    s_mov_b32 s39, 200000
Lsl_19:
    s_add_u32 s24, s23, 1114112
    buffer_load_dwordx4 v[96:99], v20, s[52:55], s24 offen offset:0 sc1
    buffer_load_dwordx4 v[100:103], v20, s[52:55], s24 offen offset:1024 sc1
    buffer_load_dwordx4 v[104:107], v20, s[52:55], s24 offen offset:2048 sc1
    buffer_load_dwordx4 v[108:111], v20, s[52:55], s24 offen offset:3072 sc1
    s_add_u32 s24, s23, 1048576
    buffer_load_dwordx4 v[112:115], v20, s[52:55], s24 offen offset:0 sc1
    buffer_load_dwordx4 v[116:119], v20, s[52:55], s24 offen offset:1024 sc1
    buffer_load_dwordx4 v[144:147], v20, s[52:55], s24 offen offset:2048 sc1
    buffer_load_dwordx4 v[148:151], v20, s[52:55], s24 offen offset:3072 sc1
    s_add_u32 s24, s23, 1064960
    buffer_load_dwordx4 v[152:155], v20, s[52:55], s24 offen offset:0 sc1
    buffer_load_dwordx4 v[196:199], v20, s[52:55], s24 offen offset:1024 sc1
    buffer_load_dwordx4 v[200:203], v20, s[52:55], s24 offen offset:2048 sc1
    buffer_load_dwordx4 v[190:193], v20, s[52:55], s24 offen offset:3072 sc1
    s_waitcnt vmcnt(0)
    v_max3_u32 v252, v96, v100, v104
    v_max_u32 v252, v252, v108
    v_cmp_eq_u32 vcc, -1, v252
    s_cbranch_vccz Lback_18
    s_sub_u32 s39, s39, 1
    s_cbranch_scc0 Lsl_19
    s_branch Lback_18
Lslow_20:
    s_mov_b32 s39, 200000
Lsl_22:
    s_add_u32 s24, s23, 1048576
    buffer_load_dwordx4 v[112:115], v20, s[52:55], s24 offen offset:0 sc1
    buffer_load_dwordx4 v[116:119], v20, s[52:55], s24 offen offset:1024 sc1
    buffer_load_dwordx4 v[144:147], v20, s[52:55], s24 offen offset:2048 sc1
    buffer_load_dwordx4 v[148:151], v20, s[52:55], s24 offen offset:3072 sc1
    s_add_u32 s24, s23, 1064960
    buffer_load_dwordx4 v[152:155], v20, s[52:55], s24 offen offset:0 sc1
    buffer_load_dwordx4 v[196:199], v20, s[52:55], s24 offen offset:1024 sc1
    buffer_load_dwordx4 v[200:203], v20, s[52:55], s24 offen offset:2048 sc1
    buffer_load_dwordx4 v[190:193], v20, s[52:55], s24 offen offset:3072 sc1
    s_waitcnt vmcnt(0)
    v_max3_u32 v252, v112, v116, v144
    v_max_u32 v252, v252, v148
    v_cmp_eq_u32 vcc, -1, v252
    s_cbranch_vccz Lback_21
    s_sub_u32 s39, s39, 1
    s_cbranch_scc0 Lsl_22
    s_branch Lback_21
Lslow_23:
    s_mov_b32 s39, 200000
Lsl_25:
    s_add_u32 s24, s23, 1064960
    buffer_load_dwordx4 v[152:155], v20, s[52:55], s24 offen offset:0 sc1
    buffer_load_dwordx4 v[196:199], v20, s[52:55], s24 offen offset:1024 sc1
    buffer_load_dwordx4 v[200:203], v20, s[52:55], s24 offen offset:2048 sc1
    buffer_load_dwordx4 v[190:193], v20, s[52:55], s24 offen offset:3072 sc1
    s_waitcnt vmcnt(0)
    v_max3_u32 v252, v152, v196, v200
    v_max_u32 v252, v252, v190
    v_cmp_eq_u32 vcc, -1, v252
    s_cbranch_vccz Lback_24
    s_sub_u32 s39, s39, 1
    s_cbranch_scc0 Lsl_25
    s_branch Lback_24
Lwt_26:
    buffer_store_dwordx4 v[236:239], v25, s[52:55], s18 offen sc1
    s_branch Lst_27
Lslow_28:
    s_mov_b32 s39, 200000
Lsl_30:
    s_add_u32 s24, s23, 1081344
    buffer_load_dwordx4 v[120:123], v20, s[52:55], s24 offen offset:0 sc1
    buffer_load_dwordx4 v[124:127], v20, s[52:55], s24 offen offset:1024 sc1
    buffer_load_dwordx4 v[128:131], v20, s[52:55], s24 offen offset:2048 sc1
    buffer_load_dwordx4 v[132:135], v20, s[52:55], s24 offen offset:3072 sc1
    s_add_u32 s24, s23, 1097728
    buffer_load_dwordx4 v[156:159], v20, s[52:55], s24 offen offset:0 sc1
    buffer_load_dwordx4 v[160:163], v20, s[52:55], s24 offen offset:1024 sc1
    buffer_load_dwordx4 v[164:167], v20, s[52:55], s24 offen offset:2048 sc1
    buffer_load_dwordx4 v[168:171], v20, s[52:55], s24 offen offset:3072 sc1
    s_waitcnt vmcnt(0)
    v_max3_u32 v252, v120, v124, v128
    v_max_u32 v252, v252, v132
    v_cmp_eq_u32 vcc, -1, v252
    s_cbranch_vccz Lback_29
    s_sub_u32 s39, s39, 1
    s_cbranch_scc0 Lsl_30
    s_branch Lback_29
Lwt_31:
    buffer_store_dwordx4 v[240:243], v25, s[52:55], s18 offen sc1
    s_branch Lst_32
Lslow_33:
    s_mov_b32 s39, 200000
Lsl_35:
    s_add_u32 s24, s23, 1097728
    buffer_load_dwordx4 v[156:159], v20, s[52:55], s24 offen offset:0 sc1
    buffer_load_dwordx4 v[160:163], v20, s[52:55], s24 offen offset:1024 sc1
    buffer_load_dwordx4 v[164:167], v20, s[52:55], s24 offen offset:2048 sc1
    buffer_load_dwordx4 v[168:171], v20, s[52:55], s24 offen offset:3072 sc1
    s_waitcnt vmcnt(0)
    v_max3_u32 v252, v156, v160, v164
    v_max_u32 v252, v252, v168
    v_cmp_eq_u32 vcc, -1, v252
    s_cbranch_vccz Lback_34
    s_sub_u32 s39, s39, 1
    s_cbranch_scc0 Lsl_35
    s_branch Lback_34
Lwt_36:
    buffer_store_dwordx4 v[244:247], v25, s[52:55], s18 offen sc1
    s_branch Lst_37
Lwt_38:
    buffer_store_dwordx4 v[248:251], v25, s[52:55], s18 offen sc1
    s_branch Lst_39
Lwt_40:
    buffer_store_dwordx4 v[140:143], v25, s[52:55], s18 offen sc1
    s_branch Lst_41
Lslow_42:
    s_mov_b32 s39, 200000
Lsl_44:
    s_add_u32 m0, s88, 65536
    s_add_u32 s24, s34, 3571712
    s_add_u32 s25, s35, 3571712
    buffer_load_dwordx4 v20, s[52:55], s24 offen offset:0 sc1 lds
    buffer_load_dwordx4 v20, s[52:55], s24 offen offset:1024 sc1 lds
    buffer_load_dwordx4 v20, s[52:55], s25 offen offset:2048 sc1 lds
    buffer_load_dwordx4 v20, s[52:55], s25 offen offset:3072 sc1 lds
    s_waitcnt vmcnt(0)
    ds_read2st64_b32 v[228:229], v21 offset0:0 offset1:4
    ds_read2st64_b32 v[230:231], v21 offset0:8 offset1:12
    s_waitcnt lgkmcnt(0)
    s_waitcnt vmcnt(0)
    v_max3_u32 v228, v228, v229, v230
    v_max_u32 v228, v228, v231
    v_cmp_eq_u32 vcc, -1, v228
    s_cbranch_vccz Lback_43
    s_sub_u32 s39, s39, 1
    s_cbranch_scc0 Lsl_44
    s_branch Lback_43
Lslow_45:
    s_mov_b32 s39, 200000
Lsl_47:
    s_add_u32 m0, s88, 49152
    s_add_u32 s24, s28, 3506176
    s_add_u32 s25, s24, s89
    s_add_u32 s24, s24, s84
    buffer_load_dwordx4 v20, s[52:55], s24 offen offset:0 sc1 lds
    buffer_load_dwordx4 v20, s[52:55], s24 offen offset:1024 sc1 lds
    buffer_load_dwordx4 v20, s[52:55], s25 offen offset:2048 sc1 lds
    buffer_load_dwordx4 v20, s[52:55], s25 offen offset:3072 sc1 lds
    s_waitcnt vmcnt(0)
    ds_read_b128 v[176:179], v20 offset:49152
    ds_read_b128 v[180:183], v20 offset:50176
    ds_read_b128 v[184:187], v20 offset:51200
    ds_read_b128 v[188:191], v20 offset:52224
    s_waitcnt lgkmcnt(0)
    s_waitcnt vmcnt(0)
    v_max3_u32 v252, v176, v180, v184
    v_max_u32 v252, v252, v188
    v_cmp_eq_u32 vcc, -1, v252
    s_cbranch_vccz Lback_46
    s_sub_u32 s39, s39, 1
    s_cbranch_scc0 Lsl_47
    s_branch Lback_46
Lslow_48:
    s_mov_b32 s39, 200000
Lsl_50:
    s_add_u32 m0, s88, 98304
    s_add_u32 s24, s34, 3522560
    s_add_u32 s25, s35, 3522560
    buffer_load_dwordx4 v20, s[52:55], s24 offen offset:0 sc1 lds
    buffer_load_dwordx4 v20, s[52:55], s24 offen offset:1024 sc1 lds
    buffer_load_dwordx4 v20, s[52:55], s25 offen offset:2048 sc1 lds
    buffer_load_dwordx4 v20, s[52:55], s25 offen offset:3072 sc1 lds
    s_waitcnt vmcnt(0)
    ds_read2st64_b32 v[228:229], v21 offset0:128 offset1:132
    ds_read2st64_b32 v[230:231], v21 offset0:136 offset1:140
    s_waitcnt lgkmcnt(0)
    s_waitcnt vmcnt(0)
    v_max3_u32 v228, v228, v229, v230
    v_max_u32 v228, v228, v231
    v_cmp_eq_u32 vcc, -1, v228
    s_cbranch_vccz Lback_49
    s_sub_u32 s39, s39, 1
    s_cbranch_scc0 Lsl_50
    s_branch Lback_49
Lwt_51:
    buffer_store_dwordx4 v[220:223], v215, s[52:55], s18 offen sc1
    s_branch Lst_52
Lslow_53:
    s_mov_b32 s39, 200000
Lsl_55:
    s_add_u32 m0, s88, 81920
    s_add_u32 s24, s34, 3506176
    s_add_u32 s25, s35, 3506176
    buffer_load_dwordx4 v10, s[52:55], s24 offen offset:0 sc1 lds
    buffer_load_dwordx4 v10, s[52:55], s24 offen offset:1024 sc1 lds
    buffer_load_dwordx4 v10, s[52:55], s25 offen offset:2048 sc1 lds
    buffer_load_dwordx4 v10, s[52:55], s25 offen offset:3072 sc1 lds
    s_waitcnt vmcnt(0)
    ds_read2st64_b32 v[228:229], v21 offset0:64 offset1:68
    ds_read2st64_b32 v[230:231], v21 offset0:72 offset1:76
    s_waitcnt lgkmcnt(0)
    s_waitcnt vmcnt(0)
    v_max3_u32 v228, v228, v229, v230
    v_max_u32 v228, v228, v231
    v_cmp_eq_u32 vcc, -1, v228
    s_cbranch_vccz Lback_54
    s_sub_u32 s39, s39, 1
    s_cbranch_scc0 Lsl_55
    s_branch Lback_54
Lwt_56:
    buffer_store_dwordx4 v[244:247], v24, s[52:55], s16 offen sc1
    buffer_store_dwordx4 v[244:247], v24, s[52:55], s17 offen sc1
    buffer_store_dwordx4 v[244:247], v25, s[52:55], s18 offen sc1
    s_branch Lst_57
Lslow_58:
    s_mov_b32 s39, 200000
Lsl_60:
    s_add_u32 m0, s88, 114688
    s_add_u32 s24, s34, 3538944
    s_add_u32 s25, s35, 3538944
    buffer_load_dwordx4 v20, s[52:55], s24 offen offset:0 sc1 lds
    buffer_load_dwordx4 v20, s[52:55], s24 offen offset:1024 sc1 lds
    buffer_load_dwordx4 v20, s[52:55], s25 offen offset:2048 sc1 lds
    buffer_load_dwordx4 v20, s[52:55], s25 offen offset:3072 sc1 lds
    s_add_u32 m0, s88, 131072
    s_add_u32 s24, s34, 3555328
    s_add_u32 s25, s35, 3555328
    buffer_load_dwordx4 v20, s[52:55], s24 offen offset:0 sc1 lds
    buffer_load_dwordx4 v20, s[52:55], s24 offen offset:1024 sc1 lds
    buffer_load_dwordx4 v20, s[52:55], s25 offen offset:2048 sc1 lds
    buffer_load_dwordx4 v20, s[52:55], s25 offen offset:3072 sc1 lds
    s_waitcnt vmcnt(0)
    ds_read2st64_b32 v[248:249], v21 offset0:192 offset1:196
    ds_read2st64_b32 v[250:251], v21 offset0:200 offset1:204
    ds_read2st64_b32 v[228:229], v22 offset0:0 offset1:4
    ds_read2st64_b32 v[230:231], v22 offset0:8 offset1:12
    s_waitcnt lgkmcnt(0)
    s_waitcnt vmcnt(0)
    v_max3_u32 v248, v248, v249, v250
    v_max3_u32 v228, v228, v229, v230
    v_max3_u32 v248, v248, v251, v231
    v_max_u32 v248, v248, v228
    v_cmp_eq_u32 vcc, -1, v248
    s_cbranch_vccz Lback_59
    s_sub_u32 s39, s39, 1
    s_cbranch_scc0 Lsl_60
    s_branch Lback_59
Lslow_61:
    s_mov_b32 s39, 200000
Lsl_63:
    s_mov_b32 m0, s32
    s_mov_b32 exec_lo, 0xffffff80
    buffer_load_dwordx4 v17, s[52:55], s33 offen sc1 lds
    s_mov_b64 exec, 0xffff
    buffer_load_dwordx4 v17, s[52:55], s33 offen offset:1024 sc1 lds
    s_mov_b64 exec, -1
    s_waitcnt vmcnt(0)
    ds_read_b32 v248, v236 offset:12
    ds_read_b32 v249, v237 offset:1036
    s_waitcnt lgkmcnt(0)
    s_waitcnt vmcnt(0)
    v_xor_b32 v248, s72, v248
    v_xor_b32 v249, s72, v249
    v_or_b32 v248, v248, v249
    v_cmp_ne_u32 vcc, 0, v248
    s_cbranch_vccz Lback_62
    s_sub_u32 s39, s39, 1
    s_cbranch_scc0 Lsl_63
    s_branch Lback_62
Lslow_64:
    s_mov_b32 s39, 200000
Lsl_66:
    s_mov_b32 m0, s32
    s_mov_b64 exec, 0x7f
    buffer_load_dwordx4 v15, s[52:55], s33 offen sc1 lds
    s_mov_b64 exec, -1
    s_waitcnt vmcnt(0)
    ds_read_b32 v248, v237 offset:12
    s_waitcnt lgkmcnt(0)
    s_waitcnt vmcnt(0)
    v_cmp_ne_u32 vcc, s72, v248
    s_cbranch_vccz Lback_65
    s_sub_u32 s39, s39, 1
    s_cbranch_scc0 Lsl_66
    s_branch Lback_65
Lwt_67:
    buffer_store_dwordx4 v[104:107], v24, s[52:55], s18 offen sc1
    s_branch Lst_68
Lslow_69:
    s_mov_b32 s39, 200000
Lsl_71:
    buffer_load_dword v240, v241, s[52:55], s38 offen sc1
    s_waitcnt vmcnt(0)
    v_subrev_u32 v242, s72, v240
    v_cmp_lt_u32 vcc, 15, v242
    s_cbranch_vccz Lback_70
    s_sub_u32 s39, s39, 1
    s_cbranch_scc0 Lsl_71
    s_branch Lback_70
Lwt_72:
    buffer_store_dwordx4 v[244:247], v24, s[52:55], s16 offen sc1
    buffer_store_dwordx4 v[244:247], v24, s[52:55], s17 offen sc1
    buffer_store_dwordx4 v[244:247], v25, s[52:55], s18 offen sc1
    s_branch Lst_73
Lwt_74:
    buffer_store_dwordx4 v[128:131], v24, s[52:55], s18 offen sc1
    s_branch Lst_75
Lwt_76:
    buffer_store_dwordx4 v[152:155], v25, s[52:55], s18 offen sc1
    s_branch Lst_77
Lslow_78:
    s_mov_b32 s39, 200000
Lsl_80:
    s_add_u32 s24, s23, 1048576
    buffer_load_dwordx4 v[96:99], v20, s[52:55], s24 offen offset:0 sc1
    buffer_load_dwordx4 v[100:103], v20, s[52:55], s24 offen offset:1024 sc1
    buffer_load_dwordx4 v[104:107], v20, s[52:55], s24 offen offset:2048 sc1
    buffer_load_dwordx4 v[108:111], v20, s[52:55], s24 offen offset:3072 sc1
    s_add_u32 s24, s23, 1064960
    buffer_load_dwordx4 v[156:159], v20, s[52:55], s24 offen offset:0 sc1
    buffer_load_dwordx4 v[160:163], v20, s[52:55], s24 offen offset:1024 sc1
    buffer_load_dwordx4 v[164:167], v20, s[52:55], s24 offen offset:2048 sc1
    buffer_load_dwordx4 v[168:171], v20, s[52:55], s24 offen offset:3072 sc1
    s_waitcnt vmcnt(0)
    v_max3_u32 v252, v96, v100, v104
    v_max_u32 v252, v252, v108
    v_cmp_eq_u32 vcc, -1, v252
    s_cbranch_vccz Lback_79
    s_sub_u32 s39, s39, 1
    s_cbranch_scc0 Lsl_80
    s_branch Lback_79
Lslow_81:
    s_mov_b32 s39, 200000
Lsl_83:
    s_add_u32 s24, s23, 1064960
    buffer_load_dwordx4 v[156:159], v20, s[52:55], s24 offen offset:0 sc1
    buffer_load_dwordx4 v[160:163], v20, s[52:55], s24 offen offset:1024 sc1
    buffer_load_dwordx4 v[164:167], v20, s[52:55], s24 offen offset:2048 sc1
    buffer_load_dwordx4 v[168:171], v20, s[52:55], s24 offen offset:3072 sc1
    s_waitcnt vmcnt(0)
    v_max3_u32 v252, v156, v160, v164
    v_max_u32 v252, v252, v168
    v_cmp_eq_u32 vcc, -1, v252
    s_cbranch_vccz Lback_82
    s_sub_u32 s39, s39, 1
    s_cbranch_scc0 Lsl_83
    s_branch Lback_82
Lslow_84:
    s_mov_b32 s39, 200000
Lsl_86:
    s_add_u32 s24, s23, 1081344
    buffer_load_dwordx4 v[124:127], v20, s[52:55], s24 offen offset:0 sc1
    buffer_load_dwordx4 v[128:131], v20, s[52:55], s24 offen offset:1024 sc1
    buffer_load_dwordx4 v[132:135], v20, s[52:55], s24 offen offset:2048 sc1
    buffer_load_dwordx4 v[136:139], v20, s[52:55], s24 offen offset:3072 sc1
    s_add_u32 s24, s23, 1097728
    buffer_load_dwordx4 v[140:143], v20, s[52:55], s24 offen offset:0 sc1
    buffer_load_dwordx4 v[144:147], v20, s[52:55], s24 offen offset:1024 sc1
    buffer_load_dwordx4 v[148:151], v20, s[52:55], s24 offen offset:2048 sc1
    buffer_load_dwordx4 v[152:155], v20, s[52:55], s24 offen offset:3072 sc1
    s_waitcnt vmcnt(0)
    v_max3_u32 v252, v124, v128, v132
    v_max_u32 v252, v252, v136
    v_cmp_eq_u32 vcc, -1, v252
    s_cbranch_vccz Lback_85
    s_sub_u32 s39, s39, 1
    s_cbranch_scc0 Lsl_86
    s_branch Lback_85
Lwt_87:
    buffer_store_dwordx4 v[196:199], v25, s[52:55], s18 offen sc1
    s_branch Lst_88
Lslow_89:
    s_mov_b32 s39, 200000
Lsl_91:
    s_add_u32 s24, s23, 1097728
    buffer_load_dwordx4 v[140:143], v20, s[52:55], s24 offen offset:0 sc1
    buffer_load_dwordx4 v[144:147], v20, s[52:55], s24 offen offset:1024 sc1
    buffer_load_dwordx4 v[148:151], v20, s[52:55], s24 offen offset:2048 sc1
    buffer_load_dwordx4 v[152:155], v20, s[52:55], s24 offen offset:3072 sc1
    s_add_u32 s24, s23, 1114112
    buffer_load_dwordx4 v[172:175], v20, s[52:55], s24 offen offset:0 sc1
    buffer_load_dwordx4 v[176:179], v20, s[52:55], s24 offen offset:1024 sc1
    buffer_load_dwordx4 v[180:183], v20, s[52:55], s24 offen offset:2048 sc1
    buffer_load_dwordx4 v[184:187], v20, s[52:55], s24 offen offset:3072 sc1
    s_waitcnt vmcnt(0)
    v_max3_u32 v252, v140, v144, v148
    v_max_u32 v252, v252, v152
    v_cmp_eq_u32 vcc, -1, v252
    s_cbranch_vccz Lback_90
    s_sub_u32 s39, s39, 1
    s_cbranch_scc0 Lsl_91
    s_branch Lback_90
Lwt_92:
    buffer_store_dwordx4 v[200:203], v25, s[52:55], s18 offen sc1
    s_branch Lst_93
Lslow_94:
    s_mov_b32 s39, 200000
Lsl_96:
    s_add_u32 s24, s23, 1114112
    buffer_load_dwordx4 v[172:175], v20, s[52:55], s24 offen offset:0 sc1
    buffer_load_dwordx4 v[176:179], v20, s[52:55], s24 offen offset:1024 sc1
    buffer_load_dwordx4 v[180:183], v20, s[52:55], s24 offen offset:2048 sc1
    buffer_load_dwordx4 v[184:187], v20, s[52:55], s24 offen offset:3072 sc1
    s_waitcnt vmcnt(0)
    v_max3_u32 v252, v172, v176, v180
    v_max_u32 v252, v252, v184
    v_cmp_eq_u32 vcc, -1, v252
    s_cbranch_vccz Lback_95
    s_sub_u32 s39, s39, 1
    s_cbranch_scc0 Lsl_96
    s_branch Lback_95
Lwt_97:
    buffer_store_dwordx4 v[204:207], v25, s[52:55], s18 offen sc1
    s_branch Lst_98
Lwt_99:
    buffer_store_dwordx4 v[208:211], v25, s[52:55], s18 offen sc1
    s_branch Lst_100
Lwt_101:
    buffer_store_dwordx4 v[212:215], v25, s[52:55], s18 offen sc1
    s_branch Lst_102
Lslow_103:
    s_mov_b32 s39, 200000
Lsl_105:
    buffer_load_dwordx4 v[112:115], v116, s[52:55], s33 offen sc1
    s_waitcnt vmcnt(0)
    v_cmp_ne_u32 vcc, s72, v115
    s_cbranch_vccz Lback_104
    s_sub_u32 s39, s39, 1
    s_cbranch_scc0 Lsl_105
    s_branch Lback_104
Lwt_108:
    buffer_store_dwordx4 v[184:187], v183, s[52:55], s27 offen sc1
    s_branch Lst_109
Lwt_110:
    buffer_store_dwordx4 v[172:175], v117, s[52:55], s18 offen sc1
    s_branch Lst_111
Lslow_118:
    s_mov_b32 s39, 200000
Lsl_120:
    buffer_load_dwordx4 v[212:215], v203, s[52:55], s32 offen sc1
    s_waitcnt vmcnt(0)
    v_cmp_ne_u32 vcc, s72, v215
    s_cbranch_vccz Lback_119
    s_sub_u32 s39, s39, 1
    s_cbranch_scc0 Lsl_120
    s_branch Lback_119
L_fix_redo:
    ds_write_b64 v243, v[204:205]
    s_waitcnt lgkmcnt(0)
    s_barrier
    ds_read_b128 v[156:159], v17 offset:0
    ds_read_b128 v[160:163], v17 offset:1024
    ds_read_b128 v[164:167], v17 offset:2048
    ds_read_b128 v[168:171], v17 offset:3072
    s_waitcnt lgkmcnt(2)
    v_mfma_f32_16x16x32_bf16 v[100:103], a[4:7], v[156:159], 0
    ds_read_b128 v[172:175], v17 offset:4096
    v_mfma_f32_16x16x32_bf16 v[104:107], v[156:159], a[8:11], 0
    v_mfma_f32_16x16x32_bf16 v[100:103], a[16:19], v[160:163], v[100:103]
    ds_read_b128 v[156:159], v17 offset:5120
    v_mfma_f32_16x16x32_bf16 v[104:107], v[160:163], a[20:23], v[104:107]
    s_waitcnt lgkmcnt(2)
    v_mfma_f32_16x16x32_bf16 v[100:103], a[28:31], v[164:167], v[100:103]
    ds_read_b128 v[160:163], v17 offset:6144
    v_mfma_f32_16x16x32_bf16 v[104:107], v[164:167], a[32:35], v[104:107]
    v_mfma_f32_16x16x32_bf16 v[100:103], a[40:43], v[168:171], v[100:103]
    ds_read_b128 v[164:167], v17 offset:7168
    v_mfma_f32_16x16x32_bf16 v[104:107], v[168:171], a[44:47], v[104:107]
    s_waitcnt lgkmcnt(2)
    v_mfma_f32_16x16x32_bf16 v[100:103], a[52:55], v[172:175], v[100:103]
    ds_read_b128 v[168:171], v17 offset:8192
    v_mfma_f32_16x16x32_bf16 v[104:107], v[172:175], a[56:59], v[104:107]
    v_mfma_f32_16x16x32_bf16 v[100:103], a[64:67], v[156:159], v[100:103]
    ds_read_b128 v[172:175], v17 offset:9216
    v_mfma_f32_16x16x32_bf16 v[104:107], v[156:159], a[68:71], v[104:107]
    s_waitcnt lgkmcnt(2)
    v_mfma_f32_16x16x32_bf16 v[100:103], a[76:79], v[160:163], v[100:103]
    ds_read_b128 v[156:159], v17 offset:10240
    v_mfma_f32_16x16x32_bf16 v[104:107], v[160:163], a[80:83], v[104:107]
    v_mfma_f32_16x16x32_bf16 v[100:103], a[88:91], v[164:167], v[100:103]
    ds_read_b128 v[160:163], v17 offset:11264
    v_mfma_f32_16x16x32_bf16 v[104:107], v[164:167], a[92:95], v[104:107]
    s_waitcnt lgkmcnt(2)
    v_mfma_f32_16x16x32_bf16 v[100:103], a[100:103], v[168:171], v[100:103]
    ds_read_b128 v[164:167], v17 offset:12288
    v_mfma_f32_16x16x32_bf16 v[104:107], v[168:171], a[104:107], v[104:107]
    v_mfma_f32_16x16x32_bf16 v[100:103], a[112:115], v[172:175], v[100:103]
    ds_read_b128 v[168:171], v17 offset:13312
    v_mfma_f32_16x16x32_bf16 v[104:107], v[172:175], a[116:119], v[104:107]
    s_waitcnt lgkmcnt(2)
    v_mfma_f32_16x16x32_bf16 v[100:103], a[124:127], v[156:159], v[100:103]
    ds_read_b128 v[172:175], v17 offset:14336
    v_mfma_f32_16x16x32_bf16 v[104:107], v[156:159], a[128:131], v[104:107]
    v_mfma_f32_16x16x32_bf16 v[100:103], a[136:139], v[160:163], v[100:103]
    ds_read_b128 v[156:159], v17 offset:15360
    v_mfma_f32_16x16x32_bf16 v[104:107], v[160:163], a[140:143], v[104:107]
    s_waitcnt lgkmcnt(2)
    v_mfma_f32_16x16x32_bf16 v[100:103], a[148:151], v[164:167], v[100:103]
    v_mfma_f32_16x16x32_bf16 v[104:107], v[164:167], a[152:155], v[104:107]
    v_mfma_f32_16x16x32_bf16 v[100:103], a[160:163], v[168:171], v[100:103]
    v_mfma_f32_16x16x32_bf16 v[104:107], v[168:171], a[164:167], v[104:107]
    s_waitcnt lgkmcnt(0)
    v_mfma_f32_16x16x32_bf16 v[100:103], a[172:175], v[172:175], v[100:103]
    v_mfma_f32_16x16x32_bf16 v[104:107], v[172:175], a[176:179], v[104:107]
    v_mfma_f32_16x16x32_bf16 v[100:103], a[184:187], v[156:159], v[100:103]
    v_mfma_f32_16x16x32_bf16 v[104:107], v[156:159], a[188:191], v[104:107]
    s_branch L_fix_noredo
Lwt_125:
    buffer_store_dwordx4 v[116:119], v25, s[52:55], s18 offen sc1
    s_branch Lst_126
Lwt_129:
    buffer_store_dwordx4 v[196:199], v25, s[52:55], s18 offen sc1
    s_branch Lst_130
Lwt_137:
    buffer_store_dwordx4 v[44:47], v5, s[52:55], s16 offen sc1
    s_branch Lst_138
Lwt_141:
    buffer_store_dwordx4 v[32:35], v136, s[52:55], s16 offen sc1
    s_branch Lst_142
Lwt_146:
    buffer_store_dwordx4 v[44:47], v5, s[52:55], s16 offen sc1
    s_branch Lst_147
.fill 16640, 4, 0xbf810000
.section .rodata,"a"
.p2align 6
.amdhsa_kernel interleave_layers__sliding_local_dilated__moe_arch_mod__prompt_kernel
  .amdhsa_next_free_vgpr 512
  .amdhsa_next_free_sgpr 102
  .amdhsa_accum_offset 256
  .amdhsa_group_segment_fixed_size 0
  .amdhsa_kernarg_size 88
  .amdhsa_user_sgpr_count 2
  .amdhsa_user_sgpr_kernarg_segment_ptr 1
  .amdhsa_system_sgpr_workgroup_id_x 1
.end_amdhsa_kernel
```
